```python
import torch

def _softmax(x, axis=-1):
    return torch.softmax(x, dim=axis)
def _gelu(x):
    return torch.nn.functional.gelu(x, approximate="tanh")
def _silu(x):
    return torch.nn.functional.silu(x)
def _sigmoid(x):
    return torch.sigmoid(x)
def _layernorm(x, axis=-1, eps=1e-5):
    m = x.mean(dim=axis, keepdim=True)
    v = x.var(dim=axis, keepdim=True, unbiased=False)
    return (x - m) / torch.sqrt(v + eps)
def _scatter_add(tgt, idx, src, axis=0):
    return tgt.clone().index_add_(axis, idx, src)
def _segment_sum(src, seg, n):
    out = torch.zeros((n,) + src.shape[1:], dtype=src.dtype)
    return out.index_add_(0, seg, src)
def _pad(x, pw):
    flat = tuple(v for pair in reversed(pw) for v in pair)
    return torch.nn.functional.pad(x, flat)

kernel_name = 'concat_heads__gqa_block_cached__mha_block_cached__near_ridge'

def setup_inputs():

    _w = (lambda a: (lambda t: t.to(torch.bfloat16) if t.is_floating_point() else t)(torch.as_tensor(a)))
    def _A_setup():
        B, Sq, D = 16, 64, 576
        Hq, Hkv, Sk, Dh = 32, 16, 512, 128
        assert Hq % Hkv == 0, (Hq, Hkv)
        return {
            "x": _w((lambda *s: torch.randn(*s, dtype=torch.bfloat16) * 0.8)(B, Sq, D)),
            "k_cache": _w((lambda *s: torch.randn(*s, dtype=torch.bfloat16) * 0.8)(B, Hkv, Sk, Dh)),
            "v_cache": _w((lambda *s: torch.randn(*s, dtype=torch.bfloat16) * 0.05)(B, Hkv, Sk, Dh)),
            "wq": _w((lambda *s: torch.randn(*s, dtype=torch.bfloat16) * 0.8)(D, Hq * Dh) * (D ** -0.5)),
            "wo": _w((lambda *s: torch.randn(*s, dtype=torch.bfloat16) * 0.05)(Hq * Dh, D) * ((Hq * Dh) ** -0.5)),
        }
    _A_in = _A_setup()

    def _B_setup():
        B, Sq, D = 16, 64, 576
        H, Sk, Dh = 32, 512, 128
        return {
            "x": _w((lambda *s: torch.randn(*s, dtype=torch.bfloat16) * 0.8)(B, Sq, D)),
            "k_cache": _w((lambda *s: torch.randn(*s, dtype=torch.bfloat16) * 0.8)(B, H, Sk, Dh)),
            "v_cache": _w((lambda *s: torch.randn(*s, dtype=torch.bfloat16) * 0.05)(B, H, Sk, Dh)),
            "wq": _w((lambda *s: torch.randn(*s, dtype=torch.bfloat16) * 0.8)(D, H * Dh) * (D ** -0.5)),
            "wo": _w((lambda *s: torch.randn(*s, dtype=torch.bfloat16) * 0.05)(H * Dh, D) * ((H * Dh) ** -0.5)),
        }
    _B_in = _B_setup()

    return {
        "A_x": _A_in["x"],
        "A_k_cache": _A_in["k_cache"],
        "A_v_cache": _A_in["v_cache"],
        "A_wq": _A_in["wq"],
        "A_wo": _A_in["wo"],
        "B_x": _B_in["x"],
        "B_k_cache": _B_in["k_cache"],
        "B_v_cache": _B_in["v_cache"],
        "B_wq": _B_in["wq"],
        "B_wo": _B_in["wo"],
    }

def reference(A_x, A_k_cache, A_v_cache, A_wq, A_wo, B_x, B_k_cache, B_v_cache, B_wq, B_wo):
    def _A_ref(x, k_cache, v_cache, wq, wo):
        B, Sq, D = x.shape
        Hq, Dh = 32, 128
        Hkv = k_cache.shape[1]
        rep = Hq // Hkv
        q = (lambda x, *d: x.permute(*d))((x @ wq).reshape(B, Sq, Hq, Dh), 0, 2, 1, 3)
        k = (lambda x, n, axis: torch.repeat_interleave(x, n, dim=axis))(k_cache, rep, axis=1)
        v = (lambda x, n, axis: torch.repeat_interleave(x, n, dim=axis))(v_cache, rep, axis=1)
        scores = torch.einsum("bhqd,bhkd->bhqk", q, k) * (Dh ** -0.5)
        p = _softmax(scores, axis=-1)
        o = torch.einsum("bhqk,bhkd->bhqd", p, v)
        return (lambda x, *d: x.permute(*d))(o, 0, 2, 1, 3).reshape(B, Sq, Hq * Dh) @ wo

    def _B_ref(x, k_cache, v_cache, wq, wo):
        B, Sq, D = x.shape
        H, Dh = 32, 128
        q = (lambda x, *d: x.permute(*d))((x @ wq).reshape(B, Sq, H, Dh), 0, 2, 1, 3)
        scores = torch.einsum("bhqd,bhkd->bhqk", q, k_cache) * (Dh ** -0.5)
        p = _softmax(scores, axis=-1)
        o = torch.einsum("bhqk,bhkd->bhqd", p, v_cache)
        return (lambda x, *d: x.permute(*d))(o, 0, 2, 1, 3).reshape(B, Sq, H * Dh) @ wo

    a = _A_ref(A_x, A_k_cache, A_v_cache, A_wq, A_wo)
    b = _B_ref(B_x, B_k_cache, B_v_cache, B_wq, B_wo)
    return torch.concatenate([a, b], axis=-1)
```

```asm
; @launch grid=(256,1,1) block=(512,1,1) lds=163840
.amdgcn_target "amdgcn-amd-amdhsa--gfx950"
.text
.globl concat_heads__gqa_block_cached__mha_block_cached__near_ridge_kernel
.p2align 8
.type concat_heads__gqa_block_cached__mha_block_cached__near_ridge_kernel,@function
concat_heads__gqa_block_cached__mha_block_cached__near_ridge_kernel:
  s_cmp_ge_u32 s2, 256
  s_cbranch_scc1 L_exit
  s_load_dwordx8 s[52:59], s[0:1], 0
  s_load_dwordx2 s[60:61], s[0:1], 32
  s_load_dwordx8 s[88:95], s[0:1], 40
  s_load_dwordx2 s[96:97], s[0:1], 72
  s_load_dwordx2 s[62:63], s[0:1], 96
  s_load_dwordx2 s[100:101], s[0:1], 88
  v_lshrrev_b32 v2, 6, v0
  v_and_b32 v1, 63, v0
  v_readfirstlane_b32 s3, v2
  s_and_b32 s7, s2, 7
  s_lshr_b32 s36, s2, 3
  s_lshr_b32 s5, s36, 4
  s_and_b32 s6, s36, 15
  s_mul_i32 s8, s6, 9
  s_lshr_b32 s8, s8, 4
  s_and_b32 s4, s3, 3
  s_getpc_b64 s[64:65]
L_pc:
  s_mov_b32 s66, 49016
  s_mov_b32 s67, 0x20000
  s_cmp_eq_u32 s3, 7
  s_cbranch_scc0 L_cp234
  s_mul_i32 s37, s6, 3072
  v_lshlrev_b32 v2, 7, v1
  s_mov_b32 exec_hi, 0
  buffer_load_dword v0, v2, s[64:67], s37 offen
  s_mov_b32 exec_hi, -1
L_cp234:
  v_lshrrev_b32 v2, 5, v1
  v_and_b32 v3, 31, v1
  s_and_b32 s36, s4, 1
  s_lshl_b32 s36, s36, 3
  v_xor_b32 v3, s36, v3
  s_lshl_b32 s36, s4, 16
  v_lshlrev_b32 v5, 13, v2
  v_add_u32 v5, s36, v5
  v_add_u32 v6, 0, v2
  v_lshlrev_b32 v6, 1, v6
  v_xor_b32 v6, v6, v3
  v_lshl_add_u32 v6, v6, 4, v5
  v_add_u32 v25, 0, v6
  v_add_u32 v6, 2, v2
  v_lshlrev_b32 v6, 1, v6
  v_xor_b32 v6, v6, v3
  v_lshl_add_u32 v6, v6, 4, v5
  v_add_u32 v26, 15360, v6
  v_add_u32 v6, 0, v2
  v_lshlrev_b32 v6, 1, v6
  v_xor_b32 v6, v6, v3
  v_lshl_add_u32 v6, v6, 4, v5
  v_add_u32 v27, 30720, v6
  v_add_u32 v6, 2, v2
  v_lshlrev_b32 v6, 1, v6
  v_xor_b32 v6, v6, v3
  v_lshl_add_u32 v6, v6, 4, v5
  v_add_u32 v28, 46080, v6
  v_lshrrev_b32 v2, 2, v1
  s_lshl_b32 s36, s4, 4
  v_add_u32 v2, s36, v2
  v_and_b32 v3, 3, v1
  v_mul_u32_u24 v4, 1152, v2
  v_lshl_add_u32 v23, v3, 4, v4
  s_lshl_b32 s48, s8, 7
  s_lshl_b32 s44, s4, 12
  s_mul_i32 s42, s8, 524288
  s_waitcnt lgkmcnt(0)
  s_cmp_eq_u32 s5, 0
  s_cselect_b64 s[52:53], s[52:53], s[88:89]
  s_cselect_b64 s[54:55], s[54:55], s[90:91]
  s_cselect_b64 s[56:57], s[56:57], s[92:93]
  s_cselect_b64 s[58:59], s[58:59], s[94:95]
  s_cselect_b64 s[60:61], s[60:61], s[96:97]
  s_lshl_b32 s36, s7, 10
  s_add_u32 s20, s58, s36
  s_addc_u32 s21, s59, 0
  s_sub_u32 s22, 4718592, s36
  s_mov_b32 s23, 0x20000
  s_mul_i32 s36, s6, 73728
  s_add_u32 s28, s52, s36
  s_addc_u32 s29, s53, 0
  s_mov_b32 s30, 73728
  s_mov_b32 s31, 0x20000
  s_cmp_ge_u32 s3, 4
  s_cbranch_scc1 L_prole
L_arole:
  s_mov_b32 s47, 0
  s_add_u32 m0, s44, 65536
  s_add_u32 s36, s42, s47
  buffer_load_dwordx4 v25, s[20:23], s36 offen offset:0  lds
  buffer_load_dwordx4 v26, s[20:23], s36 offen offset:1024  lds
  buffer_load_dwordx4 v27, s[20:23], s36 offen offset:2048  lds
  buffer_load_dwordx4 v28, s[20:23], s36 offen offset:3072  lds
  s_add_u32 s42, s42, 262144
  s_cmp_eq_u32 s42, 4718592
  s_cselect_b32 s42, 0, s42
  s_add_u32 m0, s44, 81920
  s_add_u32 s36, s42, s47
  buffer_load_dwordx4 v25, s[20:23], s36 offen offset:0  lds
  buffer_load_dwordx4 v26, s[20:23], s36 offen offset:1024  lds
  buffer_load_dwordx4 v27, s[20:23], s36 offen offset:2048  lds
  buffer_load_dwordx4 v28, s[20:23], s36 offen offset:3072  lds
  s_add_u32 s42, s42, 262144
  s_cmp_eq_u32 s42, 4718592
  s_cselect_b32 s42, 0, s42
  s_lshl_b32 s36, s6, 3
  s_add_u32 s36, s36, s7
  s_lshl_b32 s36, s36, 18
  s_lshl_b32 s36, s36, s5
  s_lshl_b32 s37, 262144, s5
  s_add_u32 s12, s54, s36
  s_addc_u32 s13, s55, 0
  s_mov_b32 s14, s37
  s_mov_b32 s15, 0x20000
  s_add_u32 s16, s56, s36
  s_addc_u32 s17, s57, 0
  s_mov_b32 s18, s37
  s_mov_b32 s19, 0x20000
  s_mul_i32 s36, s7, 589824
  s_add_u32 s24, s60, s36
  s_addc_u32 s25, s61, 0
  s_mov_b32 s26, 589824
  s_mov_b32 s27, 0x20000
  s_mul_i32 s36, s2, 73728
  s_add_u32 s32, s62, s36
  s_addc_u32 s33, s63, 0
  s_mov_b32 s34, 73728
  s_mov_b32 s35, 0x20000
  s_add_u32 s98, s62, 20971520
  s_addc_u32 s99, s63, 0
  s_cmp_eq_u32 s3, 0
  s_cbranch_scc0 L_nombx
  s_lshl_b32 s36, s2, 7
  v_lshl_add_u32 v6, v1, 2, s36
  v_mov_b32 v8, 0
  s_mov_b32 exec_hi, 0
  global_store_dword v6, v8, s[98:99] sc1
  s_mov_b64 exec, -1
L_nombx:
  s_cmp_eq_u32 s3, 1
  s_cbranch_scc0 L_notlb
  v_mov_b32 v6, 0
  s_mov_b64 exec, 1
  buffer_load_dword v0, v6, s[12:15], 0 offen nt
  buffer_load_dword v0, v6, s[16:19], 0 offen nt
  buffer_load_dword v0, v6, s[24:27], 0 offen nt
  s_mov_b64 exec, -1
L_notlb:
  v_and_b32 v2, 15, v1
  v_lshrrev_b32 v3, 4, v1
  s_lshr_b32 s36, s4, 1
  s_and_b32 s37, s4, 1
  s_mul_i32 s38, s36, s5
  s_lshl_b32 s38, s38, 13
  v_xor_b32 v5, v3, v2
  v_lshlrev_b32 v5, 4, v5
  v_lshl_add_u32 v5, v2, 8, v5
  v_add_u32 v5, s38, v5
  v_xor_b32 v10, 0, v5
  v_xor_b32 v11, 64, v5
  v_xor_b32 v12, 128, v5
  v_xor_b32 v13, 192, v5
  s_lshl_b32 s39, s36, 14
  s_lshl_b32 s37, s37, 13
  s_add_u32 s39, s39, s37
  s_add_u32 s39, s39, 131072
  s_sub_u32 s45, s39, s38
  v_bfe_u32 v6, v1, 4, 1
  v_lshrrev_b32 v7, 5, v1
  v_lshl_add_u32 v6, v6, 1, v7
  v_and_b32 v7, 15, v1
  v_xor_b32 v6, v6, v7
  v_lshlrev_b32 v6, 4, v6
  v_lshl_add_u32 v6, v7, 8, v6
  v_add_u32 v32, s39, v6
  v_bfe_u32 v5, v1, 2, 4
  v_and_b32 v7, 3, v1
  v_lshlrev_b32 v7, 3, v7
  v_lshl_add_u32 v6, v5, 8, v7
  v_add_u32 v6, s38, v6
  v_and_b32 v5, 7, v5
  v_xor_b32 v7, 0, v5
  v_lshl_add_u32 v14, v7, 5, v6
  v_xor_b32 v7, 1, v5
  v_lshl_add_u32 v15, v7, 5, v6
  v_xor_b32 v7, 2, v5
  v_lshl_add_u32 v16, v7, 5, v6
  v_xor_b32 v7, 3, v5
  v_lshl_add_u32 v17, v7, 5, v6
  v_xor_b32 v7, 4, v5
  v_lshl_add_u32 v18, v7, 5, v6
  v_xor_b32 v7, 5, v5
  v_lshl_add_u32 v19, v7, 5, v6
  v_xor_b32 v7, 6, v5
  v_lshl_add_u32 v20, v7, 5, v6
  v_xor_b32 v7, 7, v5
  v_lshl_add_u32 v21, v7, 5, v6
  v_and_b32 v4, 15, v1
  v_lshrrev_b32 v5, 4, v1
  s_lshl_b32 s36, s4, 3
  v_add_u32 v6, s36, v5
  v_add_u32 v7, 0, v6
  v_and_b32 v7, 15, v7
  v_xor_b32 v7, v7, v4
  v_lshlrev_b32 v7, 4, v7
  v_lshl_add_u32 v22, v6, 8, v7
  v_add_u32 v7, 4, v6
  v_and_b32 v7, 15, v7
  v_xor_b32 v7, v7, v4
  v_lshlrev_b32 v7, 4, v7
  v_lshl_add_u32 v23, v6, 8, v7
  v_add_u32 v7, 0, v5
  v_lshlrev_b32 v7, 1, v7
  v_xor_b32 v7, v7, v4
  v_lshlrev_b32 v7, 4, v7
  v_lshl_add_u32 v248, v6, 8, v7
  v_add_u32 v7, 4, v5
  v_lshlrev_b32 v7, 1, v7
  v_xor_b32 v7, v7, v4
  v_lshlrev_b32 v7, 4, v7
  v_lshl_add_u32 v249, v6, 8, v7
  s_lshl_b32 s49, s4, 11
  s_lshl_b32 s68, 131072, s5
  s_mov_b32 s69, 0
  s_mov_b32 s41, 0x41000000
  v_mov_b64 v[30:31], 0
  v_mov_b64 v[240:241], 0
  v_mov_b64 v[242:243], 0
  v_mov_b64 v[244:245], 0
  v_mov_b64 v[246:247], 0
  v_mov_b64 v[160:161], 0
  v_mov_b64 v[162:163], 0
  v_mov_b64 v[164:165], 0
  v_mov_b64 v[166:167], 0
  v_mov_b64 v[168:169], 0
  v_mov_b64 v[170:171], 0
  v_mov_b64 v[172:173], 0
  v_mov_b64 v[174:175], 0
  v_mov_b64 v[176:177], 0
  v_mov_b64 v[178:179], 0
  v_mov_b64 v[180:181], 0
  v_mov_b64 v[182:183], 0
  v_mov_b64 v[184:185], 0
  v_mov_b64 v[186:187], 0
  v_mov_b64 v[188:189], 0
  v_mov_b64 v[190:191], 0
  v_mov_b64 v[192:193], 0
  v_mov_b64 v[194:195], 0
  v_mov_b64 v[196:197], 0
  v_mov_b64 v[198:199], 0
  v_mov_b64 v[200:201], 0
  v_mov_b64 v[202:203], 0
  v_mov_b64 v[204:205], 0
  v_mov_b64 v[206:207], 0
  v_mov_b64 v[208:209], 0
  v_mov_b64 v[210:211], 0
  v_mov_b64 v[212:213], 0
  v_mov_b64 v[214:215], 0
  v_mov_b64 v[216:217], 0
  v_mov_b64 v[218:219], 0
  v_mov_b64 v[220:221], 0
  v_mov_b64 v[222:223], 0
  s_waitcnt vmcnt(4)
  s_barrier
  s_add_u32 m0, s44, 98304
  s_add_u32 s36, s42, s47
  buffer_load_dwordx4 v25, s[20:23], s36 offen offset:0  lds
  buffer_load_dwordx4 v26, s[20:23], s36 offen offset:1024  lds
  buffer_load_dwordx4 v27, s[20:23], s36 offen offset:2048  lds
  buffer_load_dwordx4 v28, s[20:23], s36 offen offset:3072  lds
  s_add_u32 s42, s42, 262144
  s_cmp_eq_u32 s42, 4718592
  s_cselect_b32 s42, 0, s42
  s_add_u32 m0, s44, 114688
  s_add_u32 s36, s42, s47
  buffer_load_dwordx4 v25, s[20:23], s36 offen offset:0  lds
  buffer_load_dwordx4 v26, s[20:23], s36 offen offset:1024  lds
  buffer_load_dwordx4 v27, s[20:23], s36 offen offset:2048  lds
  buffer_load_dwordx4 v28, s[20:23], s36 offen offset:3072  lds
  s_add_u32 s42, s42, 262144
  s_cmp_eq_u32 s42, 4718592
  s_cselect_b32 s42, 0, s42
  s_waitcnt vmcnt(8)
  s_cmp_eq_u32 s3, 0
  s_cbranch_scc0 L_noann
  s_lshr_b32 s36, s2, 3
  s_lshl_b32 s36, s36, 2
  v_mov_b32 v6, s36
  v_mov_b32 v8, 1
  s_mov_b64 exec, 1
  global_atomic_add v6, v8, s[100:101] offset:128 sc1
  s_mov_b64 exec, -1
L_noann:
  s_barrier
  s_add_u32 m0, s44, 0
  s_add_u32 s36, s42, s47
  buffer_load_dwordx4 v25, s[20:23], s36 offen offset:0  lds
  buffer_load_dwordx4 v26, s[20:23], s36 offen offset:1024  lds
  buffer_load_dwordx4 v27, s[20:23], s36 offen offset:2048  lds
  buffer_load_dwordx4 v28, s[20:23], s36 offen offset:3072  lds
  s_add_u32 s42, s42, 262144
  s_cmp_eq_u32 s42, 4718592
  s_cselect_b32 s42, 0, s42
  s_add_u32 m0, s44, 16384
  s_add_u32 s36, s42, s47
  buffer_load_dwordx4 v25, s[20:23], s36 offen offset:0  lds
  buffer_load_dwordx4 v26, s[20:23], s36 offen offset:1024  lds
  buffer_load_dwordx4 v27, s[20:23], s36 offen offset:2048  lds
  buffer_load_dwordx4 v28, s[20:23], s36 offen offset:3072  lds
  s_add_u32 s42, s42, 262144
  s_cmp_eq_u32 s42, 4718592
  s_cselect_b32 s42, 0, s42
  s_waitcnt vmcnt(12)
  s_barrier
  s_add_u32 m0, s44, 32768
  s_add_u32 s36, s42, s47
  buffer_load_dwordx4 v25, s[20:23], s36 offen offset:0  lds
  buffer_load_dwordx4 v26, s[20:23], s36 offen offset:1024  lds
  buffer_load_dwordx4 v27, s[20:23], s36 offen offset:2048  lds
  buffer_load_dwordx4 v28, s[20:23], s36 offen offset:3072  lds
  s_add_u32 s42, s42, 262144
  s_cmp_eq_u32 s42, 4718592
  s_cselect_b32 s42, 0, s42
  s_add_u32 m0, s44, 49152
  s_add_u32 s36, s42, s47
  buffer_load_dwordx4 v25, s[20:23], s36 offen offset:0  lds
  buffer_load_dwordx4 v26, s[20:23], s36 offen offset:1024  lds
  buffer_load_dwordx4 v27, s[20:23], s36 offen offset:2048  lds
  buffer_load_dwordx4 v28, s[20:23], s36 offen offset:3072  lds
  s_add_u32 s42, s42, 262144
  s_cmp_eq_u32 s42, 4718592
  s_cselect_b32 s42, 0, s42
  s_waitcnt vmcnt(16)
  s_barrier
  s_waitcnt vmcnt(12)
  s_barrier
  s_waitcnt vmcnt(8)
  s_barrier
  s_waitcnt vmcnt(4)
  s_barrier
  s_add_u32 m0, s44, 65536
  s_add_u32 s36, s42, s47
  buffer_load_dwordx4 v25, s[20:23], s36 offen offset:0  lds
  buffer_load_dwordx4 v26, s[20:23], s36 offen offset:1024  lds
  buffer_load_dwordx4 v27, s[20:23], s36 offen offset:2048  lds
  buffer_load_dwordx4 v28, s[20:23], s36 offen offset:3072  lds
  s_add_u32 s42, s42, 262144
  s_cmp_eq_u32 s42, 4718592
  s_cselect_b32 s42, 0, s42
  s_waitcnt vmcnt(4)
  s_barrier
  s_add_u32 m0, s44, 81920
  s_add_u32 s36, s42, s47
  buffer_load_dwordx4 v25, s[20:23], s36 offen offset:0  lds
  buffer_load_dwordx4 v26, s[20:23], s36 offen offset:1024  lds
  buffer_load_dwordx4 v27, s[20:23], s36 offen offset:2048  lds
  buffer_load_dwordx4 v28, s[20:23], s36 offen offset:3072  lds
  s_add_u32 s42, s42, 262144
  s_cmp_eq_u32 s42, 4718592
  s_cselect_b32 s42, 0, s42
  s_add_u32 m0, s44, 98304
  s_add_u32 s36, s42, s47
  buffer_load_dwordx4 v25, s[20:23], s36 offen offset:0  lds
  buffer_load_dwordx4 v26, s[20:23], s36 offen offset:1024  lds
  buffer_load_dwordx4 v27, s[20:23], s36 offen offset:2048  lds
  buffer_load_dwordx4 v28, s[20:23], s36 offen offset:3072  lds
  s_add_u32 s42, s42, 262144
  s_cmp_eq_u32 s42, 4718592
  s_cselect_b32 s42, 0, s42
  s_waitcnt vmcnt(8)
  s_barrier
  s_add_u32 m0, s44, 114688
  s_add_u32 s36, s42, s47
  buffer_load_dwordx4 v25, s[20:23], s36 offen offset:0  lds
  buffer_load_dwordx4 v26, s[20:23], s36 offen offset:1024  lds
  buffer_load_dwordx4 v27, s[20:23], s36 offen offset:2048  lds
  buffer_load_dwordx4 v28, s[20:23], s36 offen offset:3072  lds
  s_add_u32 s42, s42, 262144
  s_cmp_eq_u32 s42, 4718592
  s_cselect_b32 s42, 0, s42
  s_waitcnt vmcnt(8)
  s_barrier
  s_add_u32 m0, s44, 32768
  s_add_u32 s36, s42, s47
  buffer_load_dwordx4 v25, s[20:23], s36 offen offset:0  lds
  buffer_load_dwordx4 v26, s[20:23], s36 offen offset:1024  lds
  buffer_load_dwordx4 v27, s[20:23], s36 offen offset:2048  lds
  buffer_load_dwordx4 v28, s[20:23], s36 offen offset:3072  lds
  s_add_u32 s42, s42, 262144
  s_cmp_eq_u32 s42, 4718592
  s_cselect_b32 s42, 0, s42
  s_add_u32 m0, s44, 49152
  s_add_u32 s36, s42, s47
  buffer_load_dwordx4 v25, s[20:23], s36 offen offset:0  lds
  buffer_load_dwordx4 v26, s[20:23], s36 offen offset:1024  lds
  buffer_load_dwordx4 v27, s[20:23], s36 offen offset:2048  lds
  buffer_load_dwordx4 v28, s[20:23], s36 offen offset:3072  lds
  s_add_u32 s42, s42, 262144
  s_cmp_eq_u32 s42, 4718592
  s_cselect_b32 s42, 0, s42
  s_waitcnt vmcnt(12)
  s_barrier
  s_add_u32 m0, s44, 65536
  s_add_u32 s36, s42, s47
  buffer_load_dwordx4 v25, s[20:23], s36 offen offset:0  lds
  buffer_load_dwordx4 v26, s[20:23], s36 offen offset:1024  lds
  buffer_load_dwordx4 v27, s[20:23], s36 offen offset:2048  lds
  buffer_load_dwordx4 v28, s[20:23], s36 offen offset:3072  lds
  s_add_u32 s42, s42, 262144
  s_cmp_eq_u32 s42, 4718592
  s_cselect_b32 s42, 0, s42
  s_waitcnt vmcnt(12)
  s_barrier
  s_add_u32 m0, s44, 81920
  s_add_u32 s36, s42, s47
  buffer_load_dwordx4 v25, s[20:23], s36 offen offset:0  lds
  buffer_load_dwordx4 v26, s[20:23], s36 offen offset:1024  lds
  buffer_load_dwordx4 v27, s[20:23], s36 offen offset:2048  lds
  buffer_load_dwordx4 v28, s[20:23], s36 offen offset:3072  lds
  s_add_u32 s42, s42, 262144
  s_cmp_eq_u32 s42, 4718592
  s_cselect_b32 s42, 0, s42
  s_add_u32 m0, s44, 98304
  s_add_u32 s36, s42, s47
  buffer_load_dwordx4 v25, s[20:23], s36 offen offset:0  lds
  buffer_load_dwordx4 v26, s[20:23], s36 offen offset:1024  lds
  buffer_load_dwordx4 v27, s[20:23], s36 offen offset:2048  lds
  buffer_load_dwordx4 v28, s[20:23], s36 offen offset:3072  lds
  s_add_u32 s42, s42, 262144
  s_cmp_eq_u32 s42, 4718592
  s_cselect_b32 s42, 0, s42
  s_waitcnt vmcnt(16)
  s_barrier
  s_add_u32 m0, s44, 114688
  s_add_u32 s36, s42, s47
  buffer_load_dwordx4 v25, s[20:23], s36 offen offset:0  lds
  buffer_load_dwordx4 v26, s[20:23], s36 offen offset:1024  lds
  buffer_load_dwordx4 v27, s[20:23], s36 offen offset:2048  lds
  buffer_load_dwordx4 v28, s[20:23], s36 offen offset:3072  lds
  s_add_u32 s42, s42, 262144
  s_cmp_eq_u32 s42, 4718592
  s_cselect_b32 s42, 0, s42
  s_waitcnt vmcnt(16)
  s_barrier
  s_add_u32 s36, s69, 0
  s_and_b32 s36, s36, 0x1ffff
  s_add_u32 m0, s49, 0
  s_nop 0
  buffer_load_dwordx4 v22, s[12:15], s36 offen offset:0 nt lds
  buffer_load_dwordx4 v23, s[12:15], s36 offen offset:1024 nt lds
  s_add_u32 s36, s69, 16384
  s_and_b32 s36, s36, 0x1ffff
  s_add_u32 m0, s49, 8192
  s_add_u32 s36, s36, 131072
  s_cmp_eq_u32 s5, 0
  s_cbranch_scc1 L_t235
  buffer_load_dwordx4 v22, s[12:15], s36 offen offset:0 nt lds
L_t235:
  s_cmp_eq_u32 s5, 0
  s_cbranch_scc1 L_t236
  buffer_load_dwordx4 v23, s[12:15], s36 offen offset:1024 nt lds
L_t236:
  s_add_u32 s36, s69, 8192
  s_and_b32 s36, s36, 0x1ffff
  s_add_u32 m0, s49, 16384
  s_nop 0
  buffer_load_dwordx4 v22, s[12:15], s36 offen offset:0 nt lds
  buffer_load_dwordx4 v23, s[12:15], s36 offen offset:1024 nt lds
  s_add_u32 s36, s69, 24576
  s_and_b32 s36, s36, 0x1ffff
  s_add_u32 m0, s49, 24576
  s_add_u32 s36, s36, 131072
  s_cmp_eq_u32 s5, 0
  s_cbranch_scc1 L_t237
  buffer_load_dwordx4 v22, s[12:15], s36 offen offset:0 nt lds
L_t237:
  s_cmp_eq_u32 s5, 0
  s_cbranch_scc1 L_t238
  buffer_load_dwordx4 v23, s[12:15], s36 offen offset:1024 nt lds
L_t238:
  s_waitcnt vmcnt(20)
  s_cmp_eq_u32 s5, 0
  s_cbranch_scc0 L_w239
  s_waitcnt vmcnt(16)
L_w239:
  s_barrier
  s_waitcnt vmcnt(16)
  s_cmp_eq_u32 s5, 0
  s_cbranch_scc0 L_w240
  s_waitcnt vmcnt(12)
L_w240:
  s_barrier
  s_waitcnt vmcnt(12)
  s_cmp_eq_u32 s5, 0
  s_cbranch_scc0 L_w241
  s_waitcnt vmcnt(8)
L_w241:
  s_barrier
  s_add_u32 s36, s69, 0
  s_and_b32 s36, s36, 0x1ffff
  s_add_u32 m0, s49, 32768
  s_nop 0
  buffer_load_dwordx4 v248, s[16:19], s36 offen offset:0 nt lds
  buffer_load_dwordx4 v249, s[16:19], s36 offen offset:1024 nt lds
  s_add_u32 s36, s69, 16384
  s_and_b32 s36, s36, 0x1ffff
  s_add_u32 m0, s49, 40960
  s_add_u32 s36, s36, 131072
  s_cmp_eq_u32 s5, 0
  s_cbranch_scc1 L_t242
  buffer_load_dwordx4 v248, s[16:19], s36 offen offset:0 nt lds
L_t242:
  s_cmp_eq_u32 s5, 0
  s_cbranch_scc1 L_t243
  buffer_load_dwordx4 v249, s[16:19], s36 offen offset:1024 nt lds
L_t243:
  s_waitcnt vmcnt(12)
  s_cmp_eq_u32 s5, 0
  s_cbranch_scc0 L_w244
  s_waitcnt vmcnt(6)
L_w244:
  s_barrier
  s_add_u32 s36, s69, 16384
  s_and_b32 s36, s36, 0x1ffff
  s_add_u32 m0, s49, 49152
  s_nop 0
  buffer_load_dwordx4 v22, s[12:15], s36 offen offset:0 nt lds
  buffer_load_dwordx4 v23, s[12:15], s36 offen offset:1024 nt lds
  s_add_u32 s36, s69, 32768
  s_and_b32 s36, s36, 0x1ffff
  s_add_u32 m0, s49, 57344
  s_add_u32 s36, s36, 131072
  s_cmp_eq_u32 s5, 0
  s_cbranch_scc1 L_t245
  buffer_load_dwordx4 v22, s[12:15], s36 offen offset:0 nt lds
L_t245:
  s_cmp_eq_u32 s5, 0
  s_cbranch_scc1 L_t246
  buffer_load_dwordx4 v23, s[12:15], s36 offen offset:1024 nt lds
L_t246:
  s_waitcnt vmcnt(12)
  s_cmp_eq_u32 s5, 0
  s_cbranch_scc0 L_w247
  s_waitcnt vmcnt(6)
L_w247:
  s_barrier
  ds_read_b128 v[96:99], v10 offset:0
  ds_read_b128 v[100:103], v10 offset:4096
  ds_read_b128 v[104:107], v11 offset:0
  ds_read_b128 v[108:111], v11 offset:4096
  ds_read_b128 v[112:115], v12 offset:0
  ds_read_b128 v[116:119], v12 offset:4096
  ds_read_b128 v[120:123], v13 offset:0
  ds_read_b128 v[124:127], v13 offset:4096
  s_waitcnt vmcnt(8)
  s_cmp_eq_u32 s5, 0
  s_cbranch_scc0 L_w248
  s_waitcnt vmcnt(4)
L_w248:
  s_waitcnt lgkmcnt(0)
  s_barrier
  s_mov_b32 s43, 0
  v_add_u32 v2, s45, v10
  ds_read_b128 v[40:43], v2 offset:0
  ds_read_b128 v[44:47], v2 offset:4096
  v_add_u32 v3, s45, v11
  ds_read_b128 v[48:51], v3 offset:0
  ds_read_b128 v[52:55], v3 offset:4096
  v_add_u32 v4, s45, v12
  ds_read_b128 v[56:59], v4 offset:0
  ds_read_b128 v[60:63], v4 offset:4096
  v_add_u32 v5, s45, v13
  ds_read_b128 v[64:67], v5 offset:0
  ds_read_b128 v[68:71], v5 offset:4096
  s_waitcnt lgkmcnt(7)
  v_mfma_f32_16x16x32_bf16 v[72:75], v[96:99], v[40:43], v[240:243]
  s_waitcnt lgkmcnt(6)
  v_mfma_f32_16x16x32_bf16 v[80:83], v[96:99], v[44:47], v[244:247]
  v_mfma_f32_16x16x32_bf16 v[76:79], v[100:103], v[40:43], v[240:243]
  v_mfma_f32_16x16x32_bf16 v[84:87], v[100:103], v[44:47], v[244:247]
  s_waitcnt lgkmcnt(5)
  v_mfma_f32_16x16x32_bf16 v[72:75], v[104:107], v[48:51], v[72:75]
  s_waitcnt lgkmcnt(4)
  v_mfma_f32_16x16x32_bf16 v[80:83], v[104:107], v[52:55], v[80:83]
  v_mfma_f32_16x16x32_bf16 v[76:79], v[108:111], v[48:51], v[76:79]
  v_mfma_f32_16x16x32_bf16 v[84:87], v[108:111], v[52:55], v[84:87]
  s_waitcnt lgkmcnt(3)
  v_mfma_f32_16x16x32_bf16 v[72:75], v[112:115], v[56:59], v[72:75]
  s_waitcnt lgkmcnt(2)
  v_mfma_f32_16x16x32_bf16 v[80:83], v[112:115], v[60:63], v[80:83]
  v_mfma_f32_16x16x32_bf16 v[76:79], v[116:119], v[56:59], v[76:79]
  v_mfma_f32_16x16x32_bf16 v[84:87], v[116:119], v[60:63], v[84:87]
  s_waitcnt lgkmcnt(1)
  v_mfma_f32_16x16x32_bf16 v[72:75], v[120:123], v[64:67], v[72:75]
  s_waitcnt lgkmcnt(0)
  v_mfma_f32_16x16x32_bf16 v[80:83], v[120:123], v[68:71], v[80:83]
  v_mfma_f32_16x16x32_bf16 v[76:79], v[124:127], v[64:67], v[76:79]
  v_mfma_f32_16x16x32_bf16 v[84:87], v[124:127], v[68:71], v[84:87]
  ds_read_b128 v[96:99], v10 offset:16384
  ds_read_b128 v[100:103], v10 offset:20480
  ds_read_b128 v[104:107], v11 offset:16384
  ds_read_b128 v[108:111], v11 offset:20480
  ds_read_b128 v[112:115], v12 offset:16384
  ds_read_b128 v[116:119], v12 offset:20480
  ds_read_b128 v[120:123], v13 offset:16384
  ds_read_b128 v[124:127], v13 offset:20480
  v_max3_f32 v250, v72, v73, v74
  v_max3_f32 v251, v80, v81, v82
  v_max3_f32 v250, v250, v75, v76
  v_max3_f32 v251, v251, v83, v84
  v_max3_f32 v250, v250, v77, v78
  v_max3_f32 v251, v251, v85, v86
  v_max_f32 v250, v250, v79
  v_max_f32 v251, v251, v87
  s_nop 1
  v_permlane32_swap_b32 v250, v251
  v_max_f32 v250, v250, v251
  v_mov_b32 v251, v250
  s_nop 1
  v_permlane16_swap_b32 v250, v251
  v_max_f32 v250, v250, v251
  v_mov_b32 v251, v250
  s_nop 1
  v_permlane32_swap_b32 v250, v251
  v_sub_f32 v72, v72, v250
  v_sub_f32 v73, v73, v250
  v_sub_f32 v74, v74, v250
  v_sub_f32 v75, v75, v250
  v_sub_f32 v76, v76, v250
  v_sub_f32 v77, v77, v250
  v_sub_f32 v78, v78, v250
  v_sub_f32 v79, v79, v250
  v_sub_f32 v80, v80, v251
  v_sub_f32 v81, v81, v251
  v_sub_f32 v82, v82, v251
  v_sub_f32 v83, v83, v251
  v_sub_f32 v84, v84, v251
  v_sub_f32 v85, v85, v251
  v_sub_f32 v86, v86, v251
  v_sub_f32 v87, v87, v251
  v_sub_f32 v240, v240, v250
  v_sub_f32 v241, v241, v250
  v_sub_f32 v242, v242, v250
  v_sub_f32 v243, v243, v250
  v_sub_f32 v244, v244, v251
  v_sub_f32 v245, v245, v251
  v_sub_f32 v246, v246, v251
  v_sub_f32 v247, v247, v251
  s_waitcnt lgkmcnt(0)
  s_waitcnt vmcnt(0)
  s_barrier
L_aloop:
  v_mfma_f32_16x16x32_bf16 v[224:227], v[96:99], v[40:43], v[240:243]
  v_mfma_f32_16x16x32_bf16 v[232:235], v[96:99], v[44:47], v[244:247]
  v_mfma_f32_16x16x32_bf16 v[228:231], v[100:103], v[40:43], v[240:243]
  v_exp_f32 v72, v72
  v_exp_f32 v73, v73
  v_mfma_f32_16x16x32_bf16 v[236:239], v[100:103], v[44:47], v[244:247]
  v_exp_f32 v74, v74
  v_mfma_f32_16x16x32_bf16 v[224:227], v[104:107], v[48:51], v[224:227]
  v_exp_f32 v75, v75
  ds_read_b64_tr_b16 v[128:129], v14 offset:32768
  ds_read_b64_tr_b16 v[130:131], v14 offset:36864
  v_mfma_f32_16x16x32_bf16 v[232:235], v[104:107], v[52:55], v[232:235]
  v_exp_f32 v76, v76
  ds_read_b64_tr_b16 v[132:133], v15 offset:32768
  v_mfma_f32_16x16x32_bf16 v[228:231], v[108:111], v[48:51], v[228:231]
  v_exp_f32 v77, v77
  ds_read_b64_tr_b16 v[134:135], v15 offset:36864
  ds_read_b64_tr_b16 v[136:137], v16 offset:32768
  v_mfma_f32_16x16x32_bf16 v[236:239], v[108:111], v[52:55], v[236:239]
  v_exp_f32 v78, v78
  ds_read_b64_tr_b16 v[138:139], v16 offset:36864
  v_mfma_f32_16x16x32_bf16 v[224:227], v[112:115], v[56:59], v[224:227]
  v_exp_f32 v79, v79
  ds_read_b64_tr_b16 v[140:141], v17 offset:32768
  ds_read_b64_tr_b16 v[142:143], v17 offset:36864
  v_mfma_f32_16x16x32_bf16 v[232:235], v[112:115], v[60:63], v[232:235]
  v_exp_f32 v80, v80
  v_exp_f32 v81, v81
  ds_read_b64_tr_b16 v[144:145], v18 offset:32768
  v_mfma_f32_16x16x32_bf16 v[228:231], v[116:119], v[56:59], v[228:231]
  v_exp_f32 v82, v82
  ds_read_b64_tr_b16 v[146:147], v18 offset:36864
  ds_read_b64_tr_b16 v[148:149], v19 offset:32768
  v_mfma_f32_16x16x32_bf16 v[236:239], v[116:119], v[60:63], v[236:239]
  v_exp_f32 v83, v83
  ds_read_b64_tr_b16 v[150:151], v19 offset:36864
  v_mfma_f32_16x16x32_bf16 v[224:227], v[120:123], v[64:67], v[224:227]
  v_exp_f32 v84, v84
  ds_read_b64_tr_b16 v[152:153], v20 offset:32768
  ds_read_b64_tr_b16 v[154:155], v20 offset:36864
  v_mfma_f32_16x16x32_bf16 v[232:235], v[120:123], v[68:71], v[232:235]
  v_exp_f32 v85, v85
  ds_read_b64_tr_b16 v[156:157], v21 offset:32768
  v_mfma_f32_16x16x32_bf16 v[228:231], v[124:127], v[64:67], v[228:231]
  v_exp_f32 v86, v86
  ds_read_b64_tr_b16 v[158:159], v21 offset:36864
  v_mfma_f32_16x16x32_bf16 v[236:239], v[124:127], v[68:71], v[236:239]
  v_exp_f32 v87, v87
  s_nop 0
  v_cvt_pk_bf16_f32 v88, v72, v73
  v_cvt_pk_bf16_f32 v89, v74, v75
  v_cvt_pk_bf16_f32 v90, v76, v77
  v_cvt_pk_bf16_f32 v91, v78, v79
  v_cvt_pk_bf16_f32 v92, v80, v81
  v_cvt_pk_bf16_f32 v93, v82, v83
  v_cvt_pk_bf16_f32 v94, v84, v85
  v_cvt_pk_bf16_f32 v95, v86, v87
  s_waitcnt lgkmcnt(0)
  s_barrier
  s_cmp_eq_u32 s43, 15
  s_cbranch_scc1 L_alast
  v_mfma_f32_16x16x32_bf16 v[160:163], v[128:131], v[88:91], v[160:163]
  v_mfma_f32_16x16x32_bf16 v[164:167], v[132:135], v[88:91], v[164:167]
  v_mfma_f32_16x16x32_bf16 v[168:171], v[128:131], v[92:95], v[168:171]
  v_max3_f32 v250, v224, v225, v226
  v_max3_f32 v251, v232, v233, v234
  v_mfma_f32_16x16x32_bf16 v[172:175], v[132:135], v[92:95], v[172:175]
  v_max3_f32 v250, v250, v227, v228
  v_max3_f32 v251, v251, v235, v236
  v_mfma_f32_16x16x32_bf16 v[176:179], v[136:139], v[88:91], v[176:179]
  v_max3_f32 v250, v250, v229, v230
  v_max3_f32 v251, v251, v237, v238
  ds_read_b128 v[96:99], v10 offset:49152
  v_mfma_f32_16x16x32_bf16 v[180:183], v[140:143], v[88:91], v[180:183]
  v_max_f32 v250, v250, v231
  v_max_f32 v251, v251, v239
  ds_read_b128 v[100:103], v10 offset:53248
  v_mfma_f32_16x16x32_bf16 v[184:187], v[136:139], v[92:95], v[184:187]
  v_max_f32 v252, v250, v251
  v_cmp_lt_f32 vcc, s41, v252
  ds_read_b128 v[104:107], v11 offset:49152
  v_mfma_f32_16x16x32_bf16 v[188:191], v[140:143], v[92:95], v[188:191]
  v_add_f32 v30, v30, v72
  v_add_f32 v31, v31, v80
  ds_read_b128 v[108:111], v11 offset:53248
  v_mfma_f32_16x16x32_bf16 v[192:195], v[144:147], v[88:91], v[192:195]
  v_add_f32 v30, v30, v73
  ds_read_b128 v[112:115], v12 offset:49152
  v_mfma_f32_16x16x32_bf16 v[196:199], v[148:151], v[88:91], v[196:199]
  v_add_f32 v31, v31, v81
  v_add_f32 v30, v30, v74
  ds_read_b128 v[116:119], v12 offset:53248
  v_mfma_f32_16x16x32_bf16 v[200:203], v[144:147], v[92:95], v[200:203]
  v_add_f32 v31, v31, v82
  v_add_f32 v30, v30, v75
  ds_read_b128 v[120:123], v13 offset:49152
  v_mfma_f32_16x16x32_bf16 v[204:207], v[148:151], v[92:95], v[204:207]
  v_add_f32 v31, v31, v83
  v_add_f32 v30, v30, v76
  ds_read_b128 v[124:127], v13 offset:53248
  v_mfma_f32_16x16x32_bf16 v[208:211], v[152:155], v[88:91], v[208:211]
  v_add_f32 v31, v31, v84
  v_add_f32 v30, v30, v77
  v_mfma_f32_16x16x32_bf16 v[212:215], v[156:159], v[88:91], v[212:215]
  v_add_f32 v31, v31, v85
  v_add_f32 v30, v30, v78
  v_mfma_f32_16x16x32_bf16 v[216:219], v[152:155], v[92:95], v[216:219]
  v_add_f32 v31, v31, v86
  v_add_f32 v30, v30, v79
  v_mfma_f32_16x16x32_bf16 v[220:223], v[156:159], v[92:95], v[220:223]
  v_add_f32 v31, v31, v87
  s_waitcnt lgkmcnt(0)
  s_cbranch_vccz L_nors1
  s_nop 7
  s_nop 1
  v_permlane32_swap_b32 v250, v251
  v_max_f32 v250, v250, v251
  v_mov_b32 v251, v250
  s_nop 1
  v_permlane16_swap_b32 v250, v251
  v_max_f32 v250, v250, v251
  v_mov_b32 v251, v250
  s_nop 1
  v_permlane32_swap_b32 v250, v251
  v_max_f32 v250, 0, v250
  v_max_f32 v251, 0, v251
  v_exp_f32 v34, -v250
  v_exp_f32 v35, -v251
  v_sub_f32 v224, v224, v250
  v_sub_f32 v225, v225, v250
  v_sub_f32 v226, v226, v250
  v_sub_f32 v227, v227, v250
  v_sub_f32 v228, v228, v250
  v_sub_f32 v229, v229, v250
  v_sub_f32 v230, v230, v250
  v_sub_f32 v231, v231, v250
  v_sub_f32 v232, v232, v251
  v_sub_f32 v233, v233, v251
  v_sub_f32 v234, v234, v251
  v_sub_f32 v235, v235, v251
  v_sub_f32 v236, v236, v251
  v_sub_f32 v237, v237, v251
  v_sub_f32 v238, v238, v251
  v_sub_f32 v239, v239, v251
  v_sub_f32 v240, v240, v250
  v_sub_f32 v241, v241, v250
  v_sub_f32 v242, v242, v250
  v_sub_f32 v243, v243, v250
  v_sub_f32 v244, v244, v251
  v_sub_f32 v245, v245, v251
  v_sub_f32 v246, v246, v251
  v_sub_f32 v247, v247, v251
  v_mul_f32 v30, v30, v34
  v_mul_f32 v31, v31, v35
  v_mul_f32 v160, v34, v160
  v_mul_f32 v161, v34, v161
  v_mul_f32 v162, v34, v162
  v_mul_f32 v163, v34, v163
  v_mul_f32 v164, v34, v164
  v_mul_f32 v165, v34, v165
  v_mul_f32 v166, v34, v166
  v_mul_f32 v167, v34, v167
  v_mul_f32 v168, v35, v168
  v_mul_f32 v169, v35, v169
  v_mul_f32 v170, v35, v170
  v_mul_f32 v171, v35, v171
  v_mul_f32 v172, v35, v172
  v_mul_f32 v173, v35, v173
  v_mul_f32 v174, v35, v174
  v_mul_f32 v175, v35, v175
  v_mul_f32 v176, v34, v176
  v_mul_f32 v177, v34, v177
  v_mul_f32 v178, v34, v178
  v_mul_f32 v179, v34, v179
  v_mul_f32 v180, v34, v180
  v_mul_f32 v181, v34, v181
  v_mul_f32 v182, v34, v182
  v_mul_f32 v183, v34, v183
  v_mul_f32 v184, v35, v184
  v_mul_f32 v185, v35, v185
  v_mul_f32 v186, v35, v186
  v_mul_f32 v187, v35, v187
  v_mul_f32 v188, v35, v188
  v_mul_f32 v189, v35, v189
  v_mul_f32 v190, v35, v190
  v_mul_f32 v191, v35, v191
  v_mul_f32 v192, v34, v192
  v_mul_f32 v193, v34, v193
  v_mul_f32 v194, v34, v194
  v_mul_f32 v195, v34, v195
  v_mul_f32 v196, v34, v196
  v_mul_f32 v197, v34, v197
  v_mul_f32 v198, v34, v198
  v_mul_f32 v199, v34, v199
  v_mul_f32 v200, v35, v200
  v_mul_f32 v201, v35, v201
  v_mul_f32 v202, v35, v202
  v_mul_f32 v203, v35, v203
  v_mul_f32 v204, v35, v204
  v_mul_f32 v205, v35, v205
  v_mul_f32 v206, v35, v206
  v_mul_f32 v207, v35, v207
  v_mul_f32 v208, v34, v208
  v_mul_f32 v209, v34, v209
  v_mul_f32 v210, v34, v210
  v_mul_f32 v211, v34, v211
  v_mul_f32 v212, v34, v212
  v_mul_f32 v213, v34, v213
  v_mul_f32 v214, v34, v214
  v_mul_f32 v215, v34, v215
  v_mul_f32 v216, v35, v216
  v_mul_f32 v217, v35, v217
  v_mul_f32 v218, v35, v218
  v_mul_f32 v219, v35, v219
  v_mul_f32 v220, v35, v220
  v_mul_f32 v221, v35, v221
  v_mul_f32 v222, v35, v222
  v_mul_f32 v223, v35, v223
L_nors1:
  s_cmp_eq_u32 s43, 7
  s_cbranch_scc0 L_anoq
  v_add_u32 v2, s45, v10
  ds_read_b128 v[40:43], v2 offset:0
  ds_read_b128 v[44:47], v2 offset:4096
  v_add_u32 v3, s45, v11
  ds_read_b128 v[48:51], v3 offset:0
  ds_read_b128 v[52:55], v3 offset:4096
  v_add_u32 v4, s45, v12
  ds_read_b128 v[56:59], v4 offset:0
  ds_read_b128 v[60:63], v4 offset:4096
  v_add_u32 v5, s45, v13
  ds_read_b128 v[64:67], v5 offset:0
  ds_read_b128 v[68:71], v5 offset:4096
  v_mov_b64 v[240:241], 0
  v_mov_b64 v[242:243], 0
  v_mov_b64 v[244:245], 0
  v_mov_b64 v[246:247], 0
  s_waitcnt lgkmcnt(0)
L_anoq:
  s_barrier
  v_mfma_f32_16x16x32_bf16 v[72:75], v[96:99], v[40:43], v[240:243]
  v_mfma_f32_16x16x32_bf16 v[80:83], v[96:99], v[44:47], v[244:247]
  v_mfma_f32_16x16x32_bf16 v[76:79], v[100:103], v[40:43], v[240:243]
  v_exp_f32 v224, v224
  v_exp_f32 v225, v225
  v_mfma_f32_16x16x32_bf16 v[84:87], v[100:103], v[44:47], v[244:247]
  v_exp_f32 v226, v226
  v_mfma_f32_16x16x32_bf16 v[72:75], v[104:107], v[48:51], v[72:75]
  v_exp_f32 v227, v227
  ds_read_b64_tr_b16 v[128:129], v14 offset:0
  ds_read_b64_tr_b16 v[130:131], v14 offset:4096
  v_mfma_f32_16x16x32_bf16 v[80:83], v[104:107], v[52:55], v[80:83]
  v_exp_f32 v228, v228
  ds_read_b64_tr_b16 v[132:133], v15 offset:0
  v_mfma_f32_16x16x32_bf16 v[76:79], v[108:111], v[48:51], v[76:79]
  v_exp_f32 v229, v229
  ds_read_b64_tr_b16 v[134:135], v15 offset:4096
  ds_read_b64_tr_b16 v[136:137], v16 offset:0
  v_mfma_f32_16x16x32_bf16 v[84:87], v[108:111], v[52:55], v[84:87]
  v_exp_f32 v230, v230
  ds_read_b64_tr_b16 v[138:139], v16 offset:4096
  v_mfma_f32_16x16x32_bf16 v[72:75], v[112:115], v[56:59], v[72:75]
  v_exp_f32 v231, v231
  ds_read_b64_tr_b16 v[140:141], v17 offset:0
  ds_read_b64_tr_b16 v[142:143], v17 offset:4096
  v_mfma_f32_16x16x32_bf16 v[80:83], v[112:115], v[60:63], v[80:83]
  v_exp_f32 v232, v232
  v_exp_f32 v233, v233
  ds_read_b64_tr_b16 v[144:145], v18 offset:0
  v_mfma_f32_16x16x32_bf16 v[76:79], v[116:119], v[56:59], v[76:79]
  v_exp_f32 v234, v234
  ds_read_b64_tr_b16 v[146:147], v18 offset:4096
  ds_read_b64_tr_b16 v[148:149], v19 offset:0
  v_mfma_f32_16x16x32_bf16 v[84:87], v[116:119], v[60:63], v[84:87]
  v_exp_f32 v235, v235
  ds_read_b64_tr_b16 v[150:151], v19 offset:4096
  v_mfma_f32_16x16x32_bf16 v[72:75], v[120:123], v[64:67], v[72:75]
  v_exp_f32 v236, v236
  ds_read_b64_tr_b16 v[152:153], v20 offset:0
  ds_read_b64_tr_b16 v[154:155], v20 offset:4096
  v_mfma_f32_16x16x32_bf16 v[80:83], v[120:123], v[68:71], v[80:83]
  v_exp_f32 v237, v237
  ds_read_b64_tr_b16 v[156:157], v21 offset:0
  v_mfma_f32_16x16x32_bf16 v[76:79], v[124:127], v[64:67], v[76:79]
  v_exp_f32 v238, v238
  ds_read_b64_tr_b16 v[158:159], v21 offset:4096
  v_mfma_f32_16x16x32_bf16 v[84:87], v[124:127], v[68:71], v[84:87]
  v_exp_f32 v239, v239
  s_nop 0
  v_cvt_pk_bf16_f32 v88, v224, v225
  v_cvt_pk_bf16_f32 v89, v226, v227
  v_cvt_pk_bf16_f32 v90, v228, v229
  v_cvt_pk_bf16_f32 v91, v230, v231
  v_cvt_pk_bf16_f32 v92, v232, v233
  v_cvt_pk_bf16_f32 v93, v234, v235
  v_cvt_pk_bf16_f32 v94, v236, v237
  v_cvt_pk_bf16_f32 v95, v238, v239
  s_waitcnt lgkmcnt(0)
  s_barrier
  s_cmp_eq_u32 s43, 7
  s_cbranch_scc1 L_apair
  v_mfma_f32_16x16x32_bf16 v[160:163], v[128:131], v[88:91], v[160:163]
  v_mfma_f32_16x16x32_bf16 v[164:167], v[132:135], v[88:91], v[164:167]
  v_mfma_f32_16x16x32_bf16 v[168:171], v[128:131], v[92:95], v[168:171]
  v_max3_f32 v250, v72, v73, v74
  v_max3_f32 v251, v80, v81, v82
  v_mfma_f32_16x16x32_bf16 v[172:175], v[132:135], v[92:95], v[172:175]
  v_max3_f32 v250, v250, v75, v76
  v_max3_f32 v251, v251, v83, v84
  v_mfma_f32_16x16x32_bf16 v[176:179], v[136:139], v[88:91], v[176:179]
  v_max3_f32 v250, v250, v77, v78
  v_max3_f32 v251, v251, v85, v86
  ds_read_b128 v[96:99], v10 offset:16384
  v_mfma_f32_16x16x32_bf16 v[180:183], v[140:143], v[88:91], v[180:183]
  v_max_f32 v250, v250, v79
  v_max_f32 v251, v251, v87
  ds_read_b128 v[100:103], v10 offset:20480
  v_mfma_f32_16x16x32_bf16 v[184:187], v[136:139], v[92:95], v[184:187]
  v_max_f32 v252, v250, v251
  v_cmp_lt_f32 vcc, s41, v252
  ds_read_b128 v[104:107], v11 offset:16384
  v_mfma_f32_16x16x32_bf16 v[188:191], v[140:143], v[92:95], v[188:191]
  v_add_f32 v30, v30, v224
  v_add_f32 v31, v31, v232
  ds_read_b128 v[108:111], v11 offset:20480
  v_mfma_f32_16x16x32_bf16 v[192:195], v[144:147], v[88:91], v[192:195]
  v_add_f32 v30, v30, v225
  ds_read_b128 v[112:115], v12 offset:16384
  v_mfma_f32_16x16x32_bf16 v[196:199], v[148:151], v[88:91], v[196:199]
  v_add_f32 v31, v31, v233
  v_add_f32 v30, v30, v226
  ds_read_b128 v[116:119], v12 offset:20480
  v_mfma_f32_16x16x32_bf16 v[200:203], v[144:147], v[92:95], v[200:203]
  v_add_f32 v31, v31, v234
  v_add_f32 v30, v30, v227
  ds_read_b128 v[120:123], v13 offset:16384
  v_mfma_f32_16x16x32_bf16 v[204:207], v[148:151], v[92:95], v[204:207]
  v_add_f32 v31, v31, v235
  v_add_f32 v30, v30, v228
  ds_read_b128 v[124:127], v13 offset:20480
  v_mfma_f32_16x16x32_bf16 v[208:211], v[152:155], v[88:91], v[208:211]
  v_add_f32 v31, v31, v236
  v_add_f32 v30, v30, v229
  v_mfma_f32_16x16x32_bf16 v[212:215], v[156:159], v[88:91], v[212:215]
  v_add_f32 v31, v31, v237
  v_add_f32 v30, v30, v230
  v_mfma_f32_16x16x32_bf16 v[216:219], v[152:155], v[92:95], v[216:219]
  v_add_f32 v31, v31, v238
  v_add_f32 v30, v30, v231
  v_mfma_f32_16x16x32_bf16 v[220:223], v[156:159], v[92:95], v[220:223]
  v_add_f32 v31, v31, v239
  s_waitcnt lgkmcnt(0)
  s_cbranch_vccz L_nors2
  s_nop 7
  s_nop 1
  v_permlane32_swap_b32 v250, v251
  v_max_f32 v250, v250, v251
  v_mov_b32 v251, v250
  s_nop 1
  v_permlane16_swap_b32 v250, v251
  v_max_f32 v250, v250, v251
  v_mov_b32 v251, v250
  s_nop 1
  v_permlane32_swap_b32 v250, v251
  v_max_f32 v250, 0, v250
  v_max_f32 v251, 0, v251
  v_exp_f32 v34, -v250
  v_exp_f32 v35, -v251
  v_sub_f32 v72, v72, v250
  v_sub_f32 v73, v73, v250
  v_sub_f32 v74, v74, v250
  v_sub_f32 v75, v75, v250
  v_sub_f32 v76, v76, v250
  v_sub_f32 v77, v77, v250
  v_sub_f32 v78, v78, v250
  v_sub_f32 v79, v79, v250
  v_sub_f32 v80, v80, v251
  v_sub_f32 v81, v81, v251
  v_sub_f32 v82, v82, v251
  v_sub_f32 v83, v83, v251
  v_sub_f32 v84, v84, v251
  v_sub_f32 v85, v85, v251
  v_sub_f32 v86, v86, v251
  v_sub_f32 v87, v87, v251
  v_sub_f32 v240, v240, v250
  v_sub_f32 v241, v241, v250
  v_sub_f32 v242, v242, v250
  v_sub_f32 v243, v243, v250
  v_sub_f32 v244, v244, v251
  v_sub_f32 v245, v245, v251
  v_sub_f32 v246, v246, v251
  v_sub_f32 v247, v247, v251
  v_mul_f32 v30, v30, v34
  v_mul_f32 v31, v31, v35
  v_mul_f32 v160, v34, v160
  v_mul_f32 v161, v34, v161
  v_mul_f32 v162, v34, v162
  v_mul_f32 v163, v34, v163
  v_mul_f32 v164, v34, v164
  v_mul_f32 v165, v34, v165
  v_mul_f32 v166, v34, v166
  v_mul_f32 v167, v34, v167
  v_mul_f32 v168, v35, v168
  v_mul_f32 v169, v35, v169
  v_mul_f32 v170, v35, v170
  v_mul_f32 v171, v35, v171
  v_mul_f32 v172, v35, v172
  v_mul_f32 v173, v35, v173
  v_mul_f32 v174, v35, v174
  v_mul_f32 v175, v35, v175
  v_mul_f32 v176, v34, v176
  v_mul_f32 v177, v34, v177
  v_mul_f32 v178, v34, v178
  v_mul_f32 v179, v34, v179
  v_mul_f32 v180, v34, v180
  v_mul_f32 v181, v34, v181
  v_mul_f32 v182, v34, v182
  v_mul_f32 v183, v34, v183
  v_mul_f32 v184, v35, v184
  v_mul_f32 v185, v35, v185
  v_mul_f32 v186, v35, v186
  v_mul_f32 v187, v35, v187
  v_mul_f32 v188, v35, v188
  v_mul_f32 v189, v35, v189
  v_mul_f32 v190, v35, v190
  v_mul_f32 v191, v35, v191
  v_mul_f32 v192, v34, v192
  v_mul_f32 v193, v34, v193
  v_mul_f32 v194, v34, v194
  v_mul_f32 v195, v34, v195
  v_mul_f32 v196, v34, v196
  v_mul_f32 v197, v34, v197
  v_mul_f32 v198, v34, v198
  v_mul_f32 v199, v34, v199
  v_mul_f32 v200, v35, v200
  v_mul_f32 v201, v35, v201
  v_mul_f32 v202, v35, v202
  v_mul_f32 v203, v35, v203
  v_mul_f32 v204, v35, v204
  v_mul_f32 v205, v35, v205
  v_mul_f32 v206, v35, v206
  v_mul_f32 v207, v35, v207
  v_mul_f32 v208, v34, v208
  v_mul_f32 v209, v34, v209
  v_mul_f32 v210, v34, v210
  v_mul_f32 v211, v34, v211
  v_mul_f32 v212, v34, v212
  v_mul_f32 v213, v34, v213
  v_mul_f32 v214, v34, v214
  v_mul_f32 v215, v34, v215
  v_mul_f32 v216, v35, v216
  v_mul_f32 v217, v35, v217
  v_mul_f32 v218, v35, v218
  v_mul_f32 v219, v35, v219
  v_mul_f32 v220, v35, v220
  v_mul_f32 v221, v35, v221
  v_mul_f32 v222, v35, v222
  v_mul_f32 v223, v35, v223
L_nors2:
  s_add_u32 s43, s43, 1
  s_barrier
  s_branch L_aloop
L_apair:
  v_mfma_f32_16x16x32_bf16 v[160:163], v[128:131], v[88:91], v[160:163]
  v_add_f32 v30, v30, v224
  v_add_f32 v31, v31, v232
  v_mfma_f32_16x16x32_bf16 v[164:167], v[132:135], v[88:91], v[164:167]
  v_add_f32 v30, v30, v225
  v_add_f32 v31, v31, v233
  v_mfma_f32_16x16x32_bf16 v[168:171], v[128:131], v[92:95], v[168:171]
  v_add_f32 v30, v30, v226
  v_add_f32 v31, v31, v234
  v_mfma_f32_16x16x32_bf16 v[172:175], v[132:135], v[92:95], v[172:175]
  v_add_f32 v30, v30, v227
  v_add_f32 v31, v31, v235
  v_mfma_f32_16x16x32_bf16 v[176:179], v[136:139], v[88:91], v[176:179]
  v_add_f32 v30, v30, v228
  v_add_f32 v31, v31, v236
  v_mfma_f32_16x16x32_bf16 v[180:183], v[140:143], v[88:91], v[180:183]
  v_add_f32 v30, v30, v229
  v_mfma_f32_16x16x32_bf16 v[184:187], v[136:139], v[92:95], v[184:187]
  v_add_f32 v31, v31, v237
  v_add_f32 v30, v30, v230
  v_mfma_f32_16x16x32_bf16 v[188:191], v[140:143], v[92:95], v[188:191]
  v_add_f32 v31, v31, v238
  v_add_f32 v30, v30, v231
  v_mfma_f32_16x16x32_bf16 v[192:195], v[144:147], v[88:91], v[192:195]
  v_add_f32 v31, v31, v239
  s_nop 1
  v_mfma_f32_16x16x32_bf16 v[196:199], v[148:151], v[88:91], v[196:199]
  v_permlane32_swap_b32 v30, v31
  v_add_f32 v30, v30, v31
  v_mfma_f32_16x16x32_bf16 v[200:203], v[144:147], v[92:95], v[200:203]
  v_mov_b32 v31, v30
  v_mfma_f32_16x16x32_bf16 v[204:207], v[148:151], v[92:95], v[204:207]
  s_nop 1
  v_permlane16_swap_b32 v30, v31
  v_mfma_f32_16x16x32_bf16 v[208:211], v[152:155], v[88:91], v[208:211]
  v_add_f32 v30, v30, v31
  v_mov_b32 v31, v30
  v_mfma_f32_16x16x32_bf16 v[212:215], v[156:159], v[88:91], v[212:215]
  s_nop 1
  v_permlane32_swap_b32 v30, v31
  v_mfma_f32_16x16x32_bf16 v[216:219], v[152:155], v[92:95], v[216:219]
  v_rcp_f32 v34, v30
  v_rcp_f32 v35, v31
  v_mfma_f32_16x16x32_bf16 v[220:223], v[156:159], v[92:95], v[220:223]
  s_nop 0
  v_mul_f32 v160, v34, v160
  v_mul_f32 v161, v34, v161
  v_mul_f32 v162, v34, v162
  v_mul_f32 v163, v34, v163
  v_mul_f32 v164, v34, v164
  v_mul_f32 v165, v34, v165
  v_mul_f32 v166, v34, v166
  v_mul_f32 v167, v34, v167
  v_cvt_pk_bf16_f32 v160, v160, v161
  v_cvt_pk_bf16_f32 v161, v162, v163
  v_cvt_pk_bf16_f32 v162, v164, v165
  v_cvt_pk_bf16_f32 v163, v166, v167
  v_xor_b32 v2, 0, v32
  s_nop 0
  v_permlane16_swap_b32 v160, v162
  v_permlane16_swap_b32 v161, v163
  v_mul_f32 v168, v35, v168
  v_mul_f32 v169, v35, v169
  v_mul_f32 v170, v35, v170
  v_mul_f32 v171, v35, v171
  v_mul_f32 v172, v35, v172
  v_mul_f32 v173, v35, v173
  v_mul_f32 v174, v35, v174
  v_mul_f32 v175, v35, v175
  v_cvt_pk_bf16_f32 v164, v168, v169
  v_cvt_pk_bf16_f32 v165, v170, v171
  v_cvt_pk_bf16_f32 v166, v172, v173
  v_cvt_pk_bf16_f32 v167, v174, v175
  v_xor_b32 v3, 0, v32
  ds_write_b128 v2, v[160:163] offset:0
  v_permlane16_swap_b32 v164, v166
  v_permlane16_swap_b32 v165, v167
  v_mul_f32 v176, v34, v176
  v_mul_f32 v177, v34, v177
  v_mul_f32 v178, v34, v178
  v_mul_f32 v179, v34, v179
  v_mul_f32 v180, v34, v180
  v_mul_f32 v181, v34, v181
  v_mul_f32 v182, v34, v182
  v_mul_f32 v183, v34, v183
  v_cvt_pk_bf16_f32 v168, v176, v177
  v_cvt_pk_bf16_f32 v169, v178, v179
  v_cvt_pk_bf16_f32 v170, v180, v181
  v_cvt_pk_bf16_f32 v171, v182, v183
  v_xor_b32 v2, 64, v32
  ds_write_b128 v3, v[164:167] offset:4096
  v_permlane16_swap_b32 v168, v170
  v_permlane16_swap_b32 v169, v171
  v_mul_f32 v184, v35, v184
  v_mul_f32 v185, v35, v185
  v_mul_f32 v186, v35, v186
  v_mul_f32 v187, v35, v187
  v_mul_f32 v188, v35, v188
  v_mul_f32 v189, v35, v189
  v_mul_f32 v190, v35, v190
  v_mul_f32 v191, v35, v191
  v_cvt_pk_bf16_f32 v172, v184, v185
  v_cvt_pk_bf16_f32 v173, v186, v187
  v_cvt_pk_bf16_f32 v174, v188, v189
  v_cvt_pk_bf16_f32 v175, v190, v191
  v_xor_b32 v3, 64, v32
  ds_write_b128 v2, v[168:171] offset:0
  v_permlane16_swap_b32 v172, v174
  v_permlane16_swap_b32 v173, v175
  v_mul_f32 v192, v34, v192
  v_mul_f32 v193, v34, v193
  v_mul_f32 v194, v34, v194
  v_mul_f32 v195, v34, v195
  v_mul_f32 v196, v34, v196
  v_mul_f32 v197, v34, v197
  v_mul_f32 v198, v34, v198
  v_mul_f32 v199, v34, v199
  v_cvt_pk_bf16_f32 v176, v192, v193
  v_cvt_pk_bf16_f32 v177, v194, v195
  v_cvt_pk_bf16_f32 v178, v196, v197
  v_cvt_pk_bf16_f32 v179, v198, v199
  v_xor_b32 v2, 128, v32
  ds_write_b128 v3, v[172:175] offset:4096
  v_permlane16_swap_b32 v176, v178
  v_permlane16_swap_b32 v177, v179
  v_mul_f32 v200, v35, v200
  v_mul_f32 v201, v35, v201
  v_mul_f32 v202, v35, v202
  v_mul_f32 v203, v35, v203
  v_mul_f32 v204, v35, v204
  v_mul_f32 v205, v35, v205
  v_mul_f32 v206, v35, v206
  v_mul_f32 v207, v35, v207
  v_cvt_pk_bf16_f32 v180, v200, v201
  v_cvt_pk_bf16_f32 v181, v202, v203
  v_cvt_pk_bf16_f32 v182, v204, v205
  v_cvt_pk_bf16_f32 v183, v206, v207
  v_xor_b32 v3, 128, v32
  ds_write_b128 v2, v[176:179] offset:0
  v_permlane16_swap_b32 v180, v182
  v_permlane16_swap_b32 v181, v183
  v_mul_f32 v208, v34, v208
  v_mul_f32 v209, v34, v209
  v_mul_f32 v210, v34, v210
  v_mul_f32 v211, v34, v211
  v_mul_f32 v212, v34, v212
  v_mul_f32 v213, v34, v213
  v_mul_f32 v214, v34, v214
  v_mul_f32 v215, v34, v215
  v_cvt_pk_bf16_f32 v184, v208, v209
  v_cvt_pk_bf16_f32 v185, v210, v211
  v_cvt_pk_bf16_f32 v186, v212, v213
  v_cvt_pk_bf16_f32 v187, v214, v215
  v_xor_b32 v2, 192, v32
  ds_write_b128 v3, v[180:183] offset:4096
  v_permlane16_swap_b32 v184, v186
  v_permlane16_swap_b32 v185, v187
  v_mul_f32 v216, v35, v216
  v_mul_f32 v217, v35, v217
  v_mul_f32 v218, v35, v218
  v_mul_f32 v219, v35, v219
  v_mul_f32 v220, v35, v220
  v_mul_f32 v221, v35, v221
  v_mul_f32 v222, v35, v222
  v_mul_f32 v223, v35, v223
  v_cvt_pk_bf16_f32 v188, v216, v217
  v_cvt_pk_bf16_f32 v189, v218, v219
  v_cvt_pk_bf16_f32 v190, v220, v221
  v_cvt_pk_bf16_f32 v191, v222, v223
  v_xor_b32 v3, 192, v32
  ds_write_b128 v2, v[184:187] offset:0
  v_permlane16_swap_b32 v188, v190
  v_permlane16_swap_b32 v189, v191
  ds_write_b128 v3, v[188:191] offset:4096
  ds_read_b128 v[96:99], v10 offset:16384
  ds_read_b128 v[100:103], v10 offset:20480
  ds_read_b128 v[104:107], v11 offset:16384
  ds_read_b128 v[108:111], v11 offset:20480
  ds_read_b128 v[112:115], v12 offset:16384
  ds_read_b128 v[116:119], v12 offset:20480
  ds_read_b128 v[120:123], v13 offset:16384
  ds_read_b128 v[124:127], v13 offset:20480
  v_max3_f32 v250, v72, v73, v74
  v_max3_f32 v251, v80, v81, v82
  v_max3_f32 v250, v250, v75, v76
  v_max3_f32 v251, v251, v83, v84
  v_max3_f32 v250, v250, v77, v78
  v_max3_f32 v251, v251, v85, v86
  v_max_f32 v250, v250, v79
  v_max_f32 v251, v251, v87
  s_nop 1
  v_permlane32_swap_b32 v250, v251
  v_max_f32 v250, v250, v251
  v_mov_b32 v251, v250
  s_nop 1
  v_permlane16_swap_b32 v250, v251
  v_max_f32 v250, v250, v251
  v_mov_b32 v251, v250
  s_nop 1
  v_permlane32_swap_b32 v250, v251
  v_sub_f32 v72, v72, v250
  v_sub_f32 v73, v73, v250
  v_sub_f32 v74, v74, v250
  v_sub_f32 v75, v75, v250
  v_sub_f32 v76, v76, v250
  v_sub_f32 v77, v77, v250
  v_sub_f32 v78, v78, v250
  v_sub_f32 v79, v79, v250
  v_sub_f32 v80, v80, v251
  v_sub_f32 v81, v81, v251
  v_sub_f32 v82, v82, v251
  v_sub_f32 v83, v83, v251
  v_sub_f32 v84, v84, v251
  v_sub_f32 v85, v85, v251
  v_sub_f32 v86, v86, v251
  v_sub_f32 v87, v87, v251
  v_sub_f32 v240, v240, v250
  v_sub_f32 v241, v241, v250
  v_sub_f32 v242, v242, v250
  v_sub_f32 v243, v243, v250
  v_sub_f32 v244, v244, v251
  v_sub_f32 v245, v245, v251
  v_sub_f32 v246, v246, v251
  v_sub_f32 v247, v247, v251
  v_mov_b64 v[30:31], 0
  s_waitcnt lgkmcnt(8)
  v_mov_b64 v[160:161], 0
  v_mov_b64 v[162:163], 0
  v_mov_b64 v[164:165], 0
  v_mov_b64 v[166:167], 0
  v_mov_b64 v[168:169], 0
  v_mov_b64 v[170:171], 0
  v_mov_b64 v[172:173], 0
  v_mov_b64 v[174:175], 0
  v_mov_b64 v[176:177], 0
  v_mov_b64 v[178:179], 0
  v_mov_b64 v[180:181], 0
  v_mov_b64 v[182:183], 0
  v_mov_b64 v[184:185], 0
  v_mov_b64 v[186:187], 0
  v_mov_b64 v[188:189], 0
  v_mov_b64 v[190:191], 0
  v_mov_b64 v[192:193], 0
  v_mov_b64 v[194:195], 0
  v_mov_b64 v[196:197], 0
  v_mov_b64 v[198:199], 0
  v_mov_b64 v[200:201], 0
  v_mov_b64 v[202:203], 0
  v_mov_b64 v[204:205], 0
  v_mov_b64 v[206:207], 0
  v_mov_b64 v[208:209], 0
  v_mov_b64 v[210:211], 0
  v_mov_b64 v[212:213], 0
  v_mov_b64 v[214:215], 0
  v_mov_b64 v[216:217], 0
  v_mov_b64 v[218:219], 0
  v_mov_b64 v[220:221], 0
  v_mov_b64 v[222:223], 0
  s_waitcnt lgkmcnt(0)
  s_branch L_nors2
L_alast:
  v_mfma_f32_16x16x32_bf16 v[160:163], v[128:131], v[88:91], v[160:163]
  ds_read_b64_tr_b16 v[96:97], v14 offset:49152
  ds_read_b64_tr_b16 v[98:99], v14 offset:53248
  v_mfma_f32_16x16x32_bf16 v[164:167], v[132:135], v[88:91], v[164:167]
  ds_read_b64_tr_b16 v[100:101], v15 offset:49152
  ds_read_b64_tr_b16 v[102:103], v15 offset:53248
  v_mfma_f32_16x16x32_bf16 v[168:171], v[128:131], v[92:95], v[168:171]
  ds_read_b64_tr_b16 v[104:105], v16 offset:49152
  ds_read_b64_tr_b16 v[106:107], v16 offset:53248
  v_mfma_f32_16x16x32_bf16 v[172:175], v[132:135], v[92:95], v[172:175]
  ds_read_b64_tr_b16 v[108:109], v17 offset:49152
  ds_read_b64_tr_b16 v[110:111], v17 offset:53248
  v_max3_f32 v250, v224, v225, v226
  v_max3_f32 v251, v232, v233, v234
  v_mfma_f32_16x16x32_bf16 v[176:179], v[136:139], v[88:91], v[176:179]
  v_max3_f32 v250, v250, v227, v228
  v_max3_f32 v251, v251, v235, v236
  v_mfma_f32_16x16x32_bf16 v[180:183], v[140:143], v[88:91], v[180:183]
  v_max3_f32 v250, v250, v229, v230
  v_max3_f32 v251, v251, v237, v238
  v_mfma_f32_16x16x32_bf16 v[184:187], v[136:139], v[92:95], v[184:187]
  v_max_f32 v250, v250, v231
  v_max_f32 v251, v251, v239
  v_mfma_f32_16x16x32_bf16 v[188:191], v[140:143], v[92:95], v[188:191]
  v_max_f32 v252, v250, v251
  v_cmp_lt_f32 vcc, s41, v252
  s_cbranch_vccnz L_lrare
  v_mfma_f32_16x16x32_bf16 v[192:195], v[144:147], v[88:91], v[192:195]
  ds_read_b64_tr_b16 v[112:113], v18 offset:49152
  v_exp_f32 v224, v224
  v_mfma_f32_16x16x32_bf16 v[196:199], v[148:151], v[88:91], v[196:199]
  ds_read_b64_tr_b16 v[114:115], v18 offset:53248
  v_exp_f32 v225, v225
  v_mfma_f32_16x16x32_bf16 v[200:203], v[144:147], v[92:95], v[200:203]
  ds_read_b64_tr_b16 v[116:117], v19 offset:49152
  v_exp_f32 v226, v226
  v_mfma_f32_16x16x32_bf16 v[204:207], v[148:151], v[92:95], v[204:207]
  ds_read_b64_tr_b16 v[118:119], v19 offset:53248
  v_exp_f32 v227, v227
  v_mfma_f32_16x16x32_bf16 v[208:211], v[152:155], v[88:91], v[208:211]
  ds_read_b64_tr_b16 v[120:121], v20 offset:49152
  v_exp_f32 v228, v228
  v_mfma_f32_16x16x32_bf16 v[212:215], v[156:159], v[88:91], v[212:215]
  ds_read_b64_tr_b16 v[122:123], v20 offset:53248
  v_exp_f32 v229, v229
  v_mfma_f32_16x16x32_bf16 v[216:219], v[152:155], v[92:95], v[216:219]
  ds_read_b64_tr_b16 v[124:125], v21 offset:49152
  v_exp_f32 v230, v230
  v_mfma_f32_16x16x32_bf16 v[220:223], v[156:159], v[92:95], v[220:223]
  ds_read_b64_tr_b16 v[126:127], v21 offset:53248
  v_exp_f32 v231, v231
  v_exp_f32 v232, v232
  v_exp_f32 v233, v233
  v_exp_f32 v234, v234
  v_exp_f32 v235, v235
  v_exp_f32 v236, v236
  v_exp_f32 v237, v237
  v_exp_f32 v238, v238
  v_exp_f32 v239, v239
  v_add_f32 v30, v30, v72
  v_add_f32 v31, v31, v80
  v_add_f32 v30, v30, v73
  v_add_f32 v31, v31, v81
  v_add_f32 v30, v30, v74
  v_add_f32 v31, v31, v82
  v_add_f32 v30, v30, v75
  v_add_f32 v31, v31, v83
  v_add_f32 v30, v30, v76
  v_add_f32 v31, v31, v84
  v_add_f32 v30, v30, v77
  v_add_f32 v31, v31, v85
  v_add_f32 v30, v30, v78
  v_add_f32 v31, v31, v86
  v_add_f32 v30, v30, v79
  v_add_f32 v31, v31, v87
L_ljoin:
  v_cvt_pk_bf16_f32 v40, v224, v225
  v_cvt_pk_bf16_f32 v41, v226, v227
  v_cvt_pk_bf16_f32 v42, v228, v229
  v_cvt_pk_bf16_f32 v43, v230, v231
  v_cvt_pk_bf16_f32 v44, v232, v233
  v_cvt_pk_bf16_f32 v45, v234, v235
  v_cvt_pk_bf16_f32 v46, v236, v237
  v_cvt_pk_bf16_f32 v47, v238, v239
  s_waitcnt lgkmcnt(0)
  v_mfma_f32_16x16x32_bf16 v[160:163], v[96:99], v[40:43], v[160:163]
  v_add_f32 v30, v30, v224
  v_add_f32 v31, v31, v232
  v_mfma_f32_16x16x32_bf16 v[164:167], v[100:103], v[40:43], v[164:167]
  v_add_f32 v30, v30, v225
  v_add_f32 v31, v31, v233
  v_mfma_f32_16x16x32_bf16 v[168:171], v[96:99], v[44:47], v[168:171]
  v_add_f32 v30, v30, v226
  v_add_f32 v31, v31, v234
  v_mfma_f32_16x16x32_bf16 v[172:175], v[100:103], v[44:47], v[172:175]
  v_add_f32 v30, v30, v227
  v_add_f32 v31, v31, v235
  v_mfma_f32_16x16x32_bf16 v[176:179], v[104:107], v[40:43], v[176:179]
  v_add_f32 v30, v30, v228
  v_add_f32 v31, v31, v236
  v_mfma_f32_16x16x32_bf16 v[180:183], v[108:111], v[40:43], v[180:183]
  v_add_f32 v30, v30, v229
  v_mfma_f32_16x16x32_bf16 v[184:187], v[104:107], v[44:47], v[184:187]
  v_add_f32 v31, v31, v237
  v_add_f32 v30, v30, v230
  v_mfma_f32_16x16x32_bf16 v[188:191], v[108:111], v[44:47], v[188:191]
  v_add_f32 v31, v31, v238
  v_add_f32 v30, v30, v231
  v_mfma_f32_16x16x32_bf16 v[192:195], v[112:115], v[40:43], v[192:195]
  v_add_f32 v31, v31, v239
  s_nop 1
  v_mfma_f32_16x16x32_bf16 v[196:199], v[116:119], v[40:43], v[196:199]
  v_permlane32_swap_b32 v30, v31
  v_add_f32 v30, v30, v31
  v_mfma_f32_16x16x32_bf16 v[200:203], v[112:115], v[44:47], v[200:203]
  v_mov_b32 v31, v30
  v_mfma_f32_16x16x32_bf16 v[204:207], v[116:119], v[44:47], v[204:207]
  s_nop 1
  v_permlane16_swap_b32 v30, v31
  v_mfma_f32_16x16x32_bf16 v[208:211], v[120:123], v[40:43], v[208:211]
  v_add_f32 v30, v30, v31
  v_mov_b32 v31, v30
  v_mfma_f32_16x16x32_bf16 v[212:215], v[124:127], v[40:43], v[212:215]
  s_nop 1
  v_permlane32_swap_b32 v30, v31
  v_mfma_f32_16x16x32_bf16 v[216:219], v[120:123], v[44:47], v[216:219]
  v_rcp_f32 v34, v30
  v_rcp_f32 v35, v31
  v_mfma_f32_16x16x32_bf16 v[220:223], v[124:127], v[44:47], v[220:223]
  s_nop 0
  v_mul_f32 v160, v34, v160
  v_mul_f32 v161, v34, v161
  v_mul_f32 v162, v34, v162
  v_mul_f32 v163, v34, v163
  v_mul_f32 v164, v34, v164
  v_mul_f32 v165, v34, v165
  v_mul_f32 v166, v34, v166
  v_mul_f32 v167, v34, v167
  v_cvt_pk_bf16_f32 v160, v160, v161
  v_cvt_pk_bf16_f32 v161, v162, v163
  v_cvt_pk_bf16_f32 v162, v164, v165
  v_cvt_pk_bf16_f32 v163, v166, v167
  v_xor_b32 v2, 0, v32
  s_nop 0
  v_permlane16_swap_b32 v160, v162
  v_permlane16_swap_b32 v161, v163
  v_mul_f32 v168, v35, v168
  v_mul_f32 v169, v35, v169
  v_mul_f32 v170, v35, v170
  v_mul_f32 v171, v35, v171
  v_mul_f32 v172, v35, v172
  v_mul_f32 v173, v35, v173
  v_mul_f32 v174, v35, v174
  v_mul_f32 v175, v35, v175
  v_cvt_pk_bf16_f32 v164, v168, v169
  v_cvt_pk_bf16_f32 v165, v170, v171
  v_cvt_pk_bf16_f32 v166, v172, v173
  v_cvt_pk_bf16_f32 v167, v174, v175
  v_xor_b32 v3, 0, v32
  ds_write_b128 v2, v[160:163] offset:0
  v_permlane16_swap_b32 v164, v166
  v_permlane16_swap_b32 v165, v167
  v_mul_f32 v176, v34, v176
  v_mul_f32 v177, v34, v177
  v_mul_f32 v178, v34, v178
  v_mul_f32 v179, v34, v179
  v_mul_f32 v180, v34, v180
  v_mul_f32 v181, v34, v181
  v_mul_f32 v182, v34, v182
  v_mul_f32 v183, v34, v183
  v_cvt_pk_bf16_f32 v168, v176, v177
  v_cvt_pk_bf16_f32 v169, v178, v179
  v_cvt_pk_bf16_f32 v170, v180, v181
  v_cvt_pk_bf16_f32 v171, v182, v183
  v_xor_b32 v2, 64, v32
  ds_write_b128 v3, v[164:167] offset:4096
  v_permlane16_swap_b32 v168, v170
  v_permlane16_swap_b32 v169, v171
  v_mul_f32 v184, v35, v184
  v_mul_f32 v185, v35, v185
  v_mul_f32 v186, v35, v186
  v_mul_f32 v187, v35, v187
  v_mul_f32 v188, v35, v188
  v_mul_f32 v189, v35, v189
  v_mul_f32 v190, v35, v190
  v_mul_f32 v191, v35, v191
  v_cvt_pk_bf16_f32 v172, v184, v185
  v_cvt_pk_bf16_f32 v173, v186, v187
  v_cvt_pk_bf16_f32 v174, v188, v189
  v_cvt_pk_bf16_f32 v175, v190, v191
  v_xor_b32 v3, 64, v32
  ds_write_b128 v2, v[168:171] offset:0
  v_permlane16_swap_b32 v172, v174
  v_permlane16_swap_b32 v173, v175
  v_mul_f32 v192, v34, v192
  v_mul_f32 v193, v34, v193
  v_mul_f32 v194, v34, v194
  v_mul_f32 v195, v34, v195
  v_mul_f32 v196, v34, v196
  v_mul_f32 v197, v34, v197
  v_mul_f32 v198, v34, v198
  v_mul_f32 v199, v34, v199
  v_cvt_pk_bf16_f32 v176, v192, v193
  v_cvt_pk_bf16_f32 v177, v194, v195
  v_cvt_pk_bf16_f32 v178, v196, v197
  v_cvt_pk_bf16_f32 v179, v198, v199
  v_xor_b32 v2, 128, v32
  ds_write_b128 v3, v[172:175] offset:4096
  v_permlane16_swap_b32 v176, v178
  v_permlane16_swap_b32 v177, v179
  v_mul_f32 v200, v35, v200
  v_mul_f32 v201, v35, v201
  v_mul_f32 v202, v35, v202
  v_mul_f32 v203, v35, v203
  v_mul_f32 v204, v35, v204
  v_mul_f32 v205, v35, v205
  v_mul_f32 v206, v35, v206
  v_mul_f32 v207, v35, v207
  v_cvt_pk_bf16_f32 v180, v200, v201
  v_cvt_pk_bf16_f32 v181, v202, v203
  v_cvt_pk_bf16_f32 v182, v204, v205
  v_cvt_pk_bf16_f32 v183, v206, v207
  v_xor_b32 v3, 128, v32
  ds_write_b128 v2, v[176:179] offset:0
  v_permlane16_swap_b32 v180, v182
  v_permlane16_swap_b32 v181, v183
  v_mul_f32 v208, v34, v208
  v_mul_f32 v209, v34, v209
  v_mul_f32 v210, v34, v210
  v_mul_f32 v211, v34, v211
  v_mul_f32 v212, v34, v212
  v_mul_f32 v213, v34, v213
  v_mul_f32 v214, v34, v214
  v_mul_f32 v215, v34, v215
  v_cvt_pk_bf16_f32 v184, v208, v209
  v_cvt_pk_bf16_f32 v185, v210, v211
  v_cvt_pk_bf16_f32 v186, v212, v213
  v_cvt_pk_bf16_f32 v187, v214, v215
  v_xor_b32 v2, 192, v32
  ds_write_b128 v3, v[180:183] offset:4096
  v_permlane16_swap_b32 v184, v186
  v_permlane16_swap_b32 v185, v187
  v_mul_f32 v216, v35, v216
  v_mul_f32 v217, v35, v217
  v_mul_f32 v218, v35, v218
  v_mul_f32 v219, v35, v219
  v_mul_f32 v220, v35, v220
  v_mul_f32 v221, v35, v221
  v_mul_f32 v222, v35, v222
  v_mul_f32 v223, v35, v223
  v_cvt_pk_bf16_f32 v188, v216, v217
  v_cvt_pk_bf16_f32 v189, v218, v219
  v_cvt_pk_bf16_f32 v190, v220, v221
  v_cvt_pk_bf16_f32 v191, v222, v223
  v_xor_b32 v3, 192, v32
  ds_write_b128 v2, v[184:187] offset:0
  v_permlane16_swap_b32 v188, v190
  v_permlane16_swap_b32 v189, v191
  ds_write_b128 v3, v[188:191] offset:4096
  s_branch L_ldone
L_lrare:
  v_mfma_f32_16x16x32_bf16 v[192:195], v[144:147], v[88:91], v[192:195]
  v_mfma_f32_16x16x32_bf16 v[196:199], v[148:151], v[88:91], v[196:199]
  v_mfma_f32_16x16x32_bf16 v[200:203], v[144:147], v[92:95], v[200:203]
  v_mfma_f32_16x16x32_bf16 v[204:207], v[148:151], v[92:95], v[204:207]
  v_mfma_f32_16x16x32_bf16 v[208:211], v[152:155], v[88:91], v[208:211]
  v_mfma_f32_16x16x32_bf16 v[212:215], v[156:159], v[88:91], v[212:215]
  v_mfma_f32_16x16x32_bf16 v[216:219], v[152:155], v[92:95], v[216:219]
  v_mfma_f32_16x16x32_bf16 v[220:223], v[156:159], v[92:95], v[220:223]
  ds_read_b64_tr_b16 v[112:113], v18 offset:49152
  ds_read_b64_tr_b16 v[114:115], v18 offset:53248
  ds_read_b64_tr_b16 v[116:117], v19 offset:49152
  ds_read_b64_tr_b16 v[118:119], v19 offset:53248
  ds_read_b64_tr_b16 v[120:121], v20 offset:49152
  ds_read_b64_tr_b16 v[122:123], v20 offset:53248
  ds_read_b64_tr_b16 v[124:125], v21 offset:49152
  ds_read_b64_tr_b16 v[126:127], v21 offset:53248
  v_add_f32 v30, v30, v72
  v_add_f32 v31, v31, v80
  v_add_f32 v30, v30, v73
  v_add_f32 v31, v31, v81
  v_add_f32 v30, v30, v74
  v_add_f32 v31, v31, v82
  v_add_f32 v30, v30, v75
  v_add_f32 v31, v31, v83
  v_add_f32 v30, v30, v76
  v_add_f32 v31, v31, v84
  v_add_f32 v30, v30, v77
  v_add_f32 v31, v31, v85
  v_add_f32 v30, v30, v78
  v_add_f32 v31, v31, v86
  v_add_f32 v30, v30, v79
  v_add_f32 v31, v31, v87
  s_nop 1
  v_permlane32_swap_b32 v250, v251
  v_max_f32 v250, v250, v251
  v_mov_b32 v251, v250
  s_nop 1
  v_permlane16_swap_b32 v250, v251
  v_max_f32 v250, v250, v251
  v_mov_b32 v251, v250
  s_nop 1
  v_permlane32_swap_b32 v250, v251
  v_max_f32 v250, 0, v250
  v_max_f32 v251, 0, v251
  v_exp_f32 v34, -v250
  v_exp_f32 v35, -v251
  v_sub_f32 v224, v224, v250
  v_sub_f32 v225, v225, v250
  v_sub_f32 v226, v226, v250
  v_sub_f32 v227, v227, v250
  v_sub_f32 v228, v228, v250
  v_sub_f32 v229, v229, v250
  v_sub_f32 v230, v230, v250
  v_sub_f32 v231, v231, v250
  v_sub_f32 v232, v232, v251
  v_sub_f32 v233, v233, v251
  v_sub_f32 v234, v234, v251
  v_sub_f32 v235, v235, v251
  v_sub_f32 v236, v236, v251
  v_sub_f32 v237, v237, v251
  v_sub_f32 v238, v238, v251
  v_sub_f32 v239, v239, v251
  v_sub_f32 v240, v240, v250
  v_sub_f32 v241, v241, v250
  v_sub_f32 v242, v242, v250
  v_sub_f32 v243, v243, v250
  v_sub_f32 v244, v244, v251
  v_sub_f32 v245, v245, v251
  v_sub_f32 v246, v246, v251
  v_sub_f32 v247, v247, v251
  v_mul_f32 v30, v30, v34
  v_mul_f32 v31, v31, v35
  v_mul_f32 v160, v34, v160
  v_mul_f32 v161, v34, v161
  v_mul_f32 v162, v34, v162
  v_mul_f32 v163, v34, v163
  v_mul_f32 v164, v34, v164
  v_mul_f32 v165, v34, v165
  v_mul_f32 v166, v34, v166
  v_mul_f32 v167, v34, v167
  v_mul_f32 v168, v35, v168
  v_mul_f32 v169, v35, v169
  v_mul_f32 v170, v35, v170
  v_mul_f32 v171, v35, v171
  v_mul_f32 v172, v35, v172
  v_mul_f32 v173, v35, v173
  v_mul_f32 v174, v35, v174
  v_mul_f32 v175, v35, v175
  v_mul_f32 v176, v34, v176
  v_mul_f32 v177, v34, v177
  v_mul_f32 v178, v34, v178
  v_mul_f32 v179, v34, v179
  v_mul_f32 v180, v34, v180
  v_mul_f32 v181, v34, v181
  v_mul_f32 v182, v34, v182
  v_mul_f32 v183, v34, v183
  v_mul_f32 v184, v35, v184
  v_mul_f32 v185, v35, v185
  v_mul_f32 v186, v35, v186
  v_mul_f32 v187, v35, v187
  v_mul_f32 v188, v35, v188
  v_mul_f32 v189, v35, v189
  v_mul_f32 v190, v35, v190
  v_mul_f32 v191, v35, v191
  v_mul_f32 v192, v34, v192
  v_mul_f32 v193, v34, v193
  v_mul_f32 v194, v34, v194
  v_mul_f32 v195, v34, v195
  v_mul_f32 v196, v34, v196
  v_mul_f32 v197, v34, v197
  v_mul_f32 v198, v34, v198
  v_mul_f32 v199, v34, v199
  v_mul_f32 v200, v35, v200
  v_mul_f32 v201, v35, v201
  v_mul_f32 v202, v35, v202
  v_mul_f32 v203, v35, v203
  v_mul_f32 v204, v35, v204
  v_mul_f32 v205, v35, v205
  v_mul_f32 v206, v35, v206
  v_mul_f32 v207, v35, v207
  v_mul_f32 v208, v34, v208
  v_mul_f32 v209, v34, v209
  v_mul_f32 v210, v34, v210
  v_mul_f32 v211, v34, v211
  v_mul_f32 v212, v34, v212
  v_mul_f32 v213, v34, v213
  v_mul_f32 v214, v34, v214
  v_mul_f32 v215, v34, v215
  v_mul_f32 v216, v35, v216
  v_mul_f32 v217, v35, v217
  v_mul_f32 v218, v35, v218
  v_mul_f32 v219, v35, v219
  v_mul_f32 v220, v35, v220
  v_mul_f32 v221, v35, v221
  v_mul_f32 v222, v35, v222
  v_mul_f32 v223, v35, v223
  v_exp_f32 v224, v224
  v_exp_f32 v225, v225
  v_exp_f32 v226, v226
  v_exp_f32 v227, v227
  v_exp_f32 v228, v228
  v_exp_f32 v229, v229
  v_exp_f32 v230, v230
  v_exp_f32 v231, v231
  v_exp_f32 v232, v232
  v_exp_f32 v233, v233
  v_exp_f32 v234, v234
  v_exp_f32 v235, v235
  v_exp_f32 v236, v236
  v_exp_f32 v237, v237
  v_exp_f32 v238, v238
  v_exp_f32 v239, v239
  s_nop 0
  s_branch L_ljoin
L_ldone:
L_aepi:
  s_waitcnt lgkmcnt(0)
  s_barrier
  v_lshrrev_b32 v2, 3, v1
  v_mul_u32_u24 v2, 1152, v2
  v_bfe_u32 v3, v1, 4, 1
  v_lshlrev_b32 v3, 1, v3
  v_and_b32 v4, 7, v1
  v_xor_b32 v4, v4, v3
  s_mul_i32 s36, s4, 36864
  v_add_u32 v2, s36, v2
  v_xor_b32 v3, 0, v4
  v_lshl_add_u32 v3, v3, 4, v2
  v_add_u32 v25, 0, v3
  v_xor_b32 v3, 4, v4
  v_lshl_add_u32 v3, v3, 4, v2
  v_add_u32 v26, 8192, v3
  v_xor_b32 v3, 0, v4
  v_lshl_add_u32 v3, v3, 4, v2
  v_add_u32 v27, 16384, v3
  v_xor_b32 v3, 4, v4
  v_lshl_add_u32 v3, v3, 4, v2
  v_add_u32 v28, 24576, v3
  s_add_u32 s42, s8, 3
  s_cmp_ge_u32 s42, 9
  s_cselect_b32 s36, 9, 0
  s_sub_u32 s42, s42, s36
  s_lshl_b32 s42, s42, 7
  s_mov_b32 s47, 294912
  s_add_u32 m0, s44, 49152
  s_add_u32 s36, s42, s47
  s_add_u32 s36, s36, 147456
  buffer_load_dwordx4 v25, s[24:27], s36 offen offset:0  lds
  buffer_load_dwordx4 v26, s[24:27], s36 offen offset:1024  lds
  buffer_load_dwordx4 v27, s[24:27], s36 offen offset:2048  lds
  buffer_load_dwordx4 v28, s[24:27], s36 offen offset:3072  lds
  s_add_u32 s42, s42, 128
  s_cmp_eq_u32 s42, 1152
  s_cselect_b32 s42, 0, s42
  s_barrier
  s_add_u32 m0, s44, 131072
  s_add_u32 s36, s42, s47
  buffer_load_dwordx4 v25, s[24:27], s36 offen offset:0  lds
  buffer_load_dwordx4 v26, s[24:27], s36 offen offset:1024  lds
  buffer_load_dwordx4 v27, s[24:27], s36 offen offset:2048  lds
  buffer_load_dwordx4 v28, s[24:27], s36 offen offset:3072  lds
  s_add_u32 m0, s44, 147456
  s_add_u32 s36, s42, s47
  s_add_u32 s36, s36, 147456
  buffer_load_dwordx4 v25, s[24:27], s36 offen offset:0  lds
  buffer_load_dwordx4 v26, s[24:27], s36 offen offset:1024  lds
  buffer_load_dwordx4 v27, s[24:27], s36 offen offset:2048  lds
  buffer_load_dwordx4 v28, s[24:27], s36 offen offset:3072  lds
  s_add_u32 s42, s42, 128
  s_cmp_eq_u32 s42, 1152
  s_cselect_b32 s42, 0, s42
  s_barrier
  s_add_u32 m0, s44, 65536
  s_add_u32 s36, s42, s47
  buffer_load_dwordx4 v25, s[24:27], s36 offen offset:0  lds
  buffer_load_dwordx4 v26, s[24:27], s36 offen offset:1024  lds
  buffer_load_dwordx4 v27, s[24:27], s36 offen offset:2048  lds
  buffer_load_dwordx4 v28, s[24:27], s36 offen offset:3072  lds
  s_waitcnt vmcnt(12)
  s_barrier
  s_add_u32 m0, s44, 81920
  s_add_u32 s36, s42, s47
  s_add_u32 s36, s36, 147456
  buffer_load_dwordx4 v25, s[24:27], s36 offen offset:0  lds
  buffer_load_dwordx4 v26, s[24:27], s36 offen offset:1024  lds
  buffer_load_dwordx4 v27, s[24:27], s36 offen offset:2048  lds
  buffer_load_dwordx4 v28, s[24:27], s36 offen offset:3072  lds
  s_add_u32 s42, s42, 128
  s_cmp_eq_u32 s42, 1152
  s_cselect_b32 s42, 0, s42
  s_add_u32 m0, s44, 98304
  s_add_u32 s36, s42, s47
  buffer_load_dwordx4 v25, s[24:27], s36 offen offset:0  lds
  buffer_load_dwordx4 v26, s[24:27], s36 offen offset:1024  lds
  buffer_load_dwordx4 v27, s[24:27], s36 offen offset:2048  lds
  buffer_load_dwordx4 v28, s[24:27], s36 offen offset:3072  lds
  s_waitcnt vmcnt(12)
  s_barrier
  s_add_u32 m0, s44, 114688
  s_add_u32 s36, s42, s47
  s_add_u32 s36, s36, 147456
  buffer_load_dwordx4 v25, s[24:27], s36 offen offset:0  lds
  buffer_load_dwordx4 v26, s[24:27], s36 offen offset:1024  lds
  buffer_load_dwordx4 v27, s[24:27], s36 offen offset:2048  lds
  buffer_load_dwordx4 v28, s[24:27], s36 offen offset:3072  lds
  s_add_u32 s42, s42, 128
  s_cmp_eq_u32 s42, 1152
  s_cselect_b32 s42, 0, s42
  s_waitcnt vmcnt(8)
  s_barrier
  s_add_u32 m0, s44, 0
  s_add_u32 s36, s42, s47
  buffer_load_dwordx4 v25, s[24:27], s36 offen offset:0  lds
  buffer_load_dwordx4 v26, s[24:27], s36 offen offset:1024  lds
  buffer_load_dwordx4 v27, s[24:27], s36 offen offset:2048  lds
  buffer_load_dwordx4 v28, s[24:27], s36 offen offset:3072  lds
  s_waitcnt vmcnt(4)
  s_barrier
  s_add_u32 m0, s44, 16384
  s_add_u32 s36, s42, s47
  s_add_u32 s36, s36, 147456
  buffer_load_dwordx4 v25, s[24:27], s36 offen offset:0  lds
  buffer_load_dwordx4 v26, s[24:27], s36 offen offset:1024  lds
  buffer_load_dwordx4 v27, s[24:27], s36 offen offset:2048  lds
  buffer_load_dwordx4 v28, s[24:27], s36 offen offset:3072  lds
  s_add_u32 s42, s42, 128
  s_cmp_eq_u32 s42, 1152
  s_cselect_b32 s42, 0, s42
  s_add_u32 m0, s44, 32768
  s_add_u32 s36, s42, s47
  buffer_load_dwordx4 v25, s[24:27], s36 offen offset:0  lds
  buffer_load_dwordx4 v26, s[24:27], s36 offen offset:1024  lds
  buffer_load_dwordx4 v27, s[24:27], s36 offen offset:2048  lds
  buffer_load_dwordx4 v28, s[24:27], s36 offen offset:3072  lds
  s_waitcnt vmcnt(4)
  s_barrier
  s_add_u32 m0, s44, 49152
  s_add_u32 s36, s42, s47
  s_add_u32 s36, s36, 147456
  buffer_load_dwordx4 v25, s[24:27], s36 offen offset:0  lds
  buffer_load_dwordx4 v26, s[24:27], s36 offen offset:1024  lds
  buffer_load_dwordx4 v27, s[24:27], s36 offen offset:2048  lds
  buffer_load_dwordx4 v28, s[24:27], s36 offen offset:3072  lds
  s_add_u32 s42, s42, 128
  s_cmp_eq_u32 s42, 1152
  s_cselect_b32 s42, 0, s42
  s_waitcnt vmcnt(0)
  s_barrier
  s_load_dwordx2 s[52:53], s[0:1], 80
  s_load_dwordx2 s[56:57], s[0:1], 96
  s_lshr_b32 s36, s2, 3
  s_mul_i32 s37, s36, 589824
  s_mul_i32 s38, s6, 147456
  s_lshl_b32 s36, s36, 2
  v_mov_b32 v4, s36
  v_lshlrev_b32 v2, 4, v1
  v_and_b32 v3, 15, v1
  v_mul_u32_u24 v3, 2304, v3
  v_lshrrev_b32 v5, 5, v1
  v_lshl_add_u32 v3, v5, 4, v3
  v_bfe_u32 v5, v1, 4, 1
  v_lshl_add_u32 v3, v5, 5, v3
  s_lshl_b32 s36, s2, 7
  v_lshl_add_u32 v5, v1, 2, s36
  s_waitcnt lgkmcnt(0)
  s_add_u32 s12, s56, s37
  s_addc_u32 s13, s57, 0
  s_mov_b32 s14, 589824
  s_mov_b32 s15, 0x20000
  s_add_u32 s16, s52, s38
  s_addc_u32 s17, s53, 0
  s_mov_b32 s18, 147456
  s_mov_b32 s19, 0x20000
  s_mul_i32 s39, s7, 9
  s_add_u32 s39, s39, s3
  s_lshl_b32 s60, s39, 10
  s_lshr_b32 s36, s39, 3
  s_lshl_b32 s36, s36, 7
  s_bfe_u32 s37, s39, 0x10002
  s_mul_i32 s37, s37, 73728
  s_add_u32 s36, s36, s37
  s_and_b32 s37, s39, 2
  s_lshl_b32 s37, s37, 5
  s_add_u32 s36, s36, s37
  s_and_b32 s37, s39, 1
  s_mul_i32 s37, s37, 36864
  s_add_u32 s36, s36, s37
  s_mul_i32 s37, s5, 1152
  s_add_u32 s64, s36, s37
  s_mul_i32 s39, s7, 9
  s_add_u32 s39, s39, 8
  s_lshl_b32 s61, s39, 10
  s_lshr_b32 s36, s39, 3
  s_lshl_b32 s36, s36, 7
  s_bfe_u32 s37, s39, 0x10002
  s_mul_i32 s37, s37, 73728
  s_add_u32 s36, s36, s37
  s_and_b32 s37, s39, 2
  s_lshl_b32 s37, s37, 5
  s_add_u32 s36, s36, s37
  s_and_b32 s37, s39, 1
  s_mul_i32 s37, s37, 36864
  s_add_u32 s36, s36, s37
  s_mul_i32 s37, s5, 1152
  s_add_u32 s65, s36, s37
  s_mov_b32 s63, 0xffff0000
  s_lshl_b32 s36, s7, 2
  s_lshl_b32 s58, 1, s36
  s_cmp_eq_u32 s3, 0
  s_cbranch_scc0 L_cleared
  s_mov_b64 exec, 1
  s_mov_b32 s39, 0
L_chk:
  global_load_dword v6, v4, s[100:101] offset:128 sc1
  s_add_u32 s39, s39, 1
  s_waitcnt vmcnt(0)
  v_readfirstlane_b32 s37, v6
  s_cmp_ge_u32 s37, 8
  s_cbranch_scc1 L_chkd
  s_sleep 32
  s_cmp_lt_u32 s39, 1048576
  s_cbranch_scc1 L_chk
L_chkd:
  s_mov_b64 exec, -1
L_cleared:
  s_barrier
L_reduce:
  s_mov_b32 exec_hi, 0
  global_load_dword v7, v5, s[98:99] sc1
  s_mov_b32 exec_hi, -1
  s_barrier
  s_cmp_eq_u32 s3, 0
  s_cbranch_scc0 L_own1
L_own0:
  s_mov_b32 s39, 0
  s_lshl_b32 s36, s3, 10
  s_add_u32 s36, s36, 131072
  v_add_u32 v6, s36, v2
  ds_read_b128 v[192:195], v6 offset:0
  ds_read_b128 v[196:199], v6 offset:8192
  s_waitcnt lgkmcnt(0)
  v_lshlrev_b32 v176, 16, v192
  v_and_b32 v177, s63, v192
  v_lshlrev_b32 v178, 16, v193
  v_and_b32 v179, s63, v193
  v_lshlrev_b32 v180, 16, v194
  v_and_b32 v181, s63, v194
  v_lshlrev_b32 v182, 16, v195
  v_and_b32 v183, s63, v195
  v_lshlrev_b32 v184, 16, v196
  v_and_b32 v185, s63, v196
  v_lshlrev_b32 v186, 16, v197
  v_and_b32 v187, s63, v197
  v_lshlrev_b32 v188, 16, v198
  v_and_b32 v189, s63, v198
  v_lshlrev_b32 v190, 16, v199
  v_and_b32 v191, s63, v199
  s_mov_b32 exec_hi, 0
  s_waitcnt vmcnt(0)
  s_cmp_lt_u32 s3, 4
  s_cbranch_scc0 L_have0
  s_branch L_eval0
L_poll0:
  s_mov_b32 exec_hi, 0
  global_load_dword v7, v5, s[98:99] sc1
L_eval0:
  s_mov_b32 exec_hi, 0
  s_add_u32 s39, s39, 1
  s_waitcnt vmcnt(0)
L_have0:
  v_cmp_ne_u32 vcc, 0, v7
  s_mov_b32 exec_hi, -1
  s_lshr_b32 s36, vcc_lo, 1
  s_and_b32 s36, s36, vcc_lo
  s_lshr_b32 s37, s36, 2
  s_and_b32 s36, s36, s37
  s_and_b32 s36, s36, 0x11111111
  s_cmp_ge_u32 s39, 4194304
  s_cselect_b32 s36, 0x11111111, s36
  s_andn2_b32 s59, s36, s58
  s_cbranch_scc1 L_new0
  s_sleep 4
  s_branch L_poll0
L_new0:
  s_bitcmp1_b32 s59, 0
  s_cbranch_scc0 L_nl0_0
  s_add_u32 s37, s60, 0
  buffer_load_dwordx4 v[192:195], v2, s[12:15], s37 offen sc1
  s_add_u32 s37, s61, 0
  buffer_load_dwordx4 v[196:199], v2, s[12:15], s37 offen sc1
L_nl0_0:
  s_bitcmp1_b32 s59, 4
  s_cbranch_scc0 L_nl0_1
  s_add_u32 s37, s60, 73728
  buffer_load_dwordx4 v[200:203], v2, s[12:15], s37 offen sc1
  s_add_u32 s37, s61, 73728
  buffer_load_dwordx4 v[204:207], v2, s[12:15], s37 offen sc1
L_nl0_1:
  s_bitcmp1_b32 s59, 8
  s_cbranch_scc0 L_nl0_2
  s_add_u32 s37, s60, 147456
  buffer_load_dwordx4 v[208:211], v2, s[12:15], s37 offen sc1
  s_add_u32 s37, s61, 147456
  buffer_load_dwordx4 v[212:215], v2, s[12:15], s37 offen sc1
L_nl0_2:
  s_bitcmp1_b32 s59, 12
  s_cbranch_scc0 L_nl0_3
  s_add_u32 s37, s60, 221184
  buffer_load_dwordx4 v[216:219], v2, s[12:15], s37 offen sc1
  s_add_u32 s37, s61, 221184
  buffer_load_dwordx4 v[220:223], v2, s[12:15], s37 offen sc1
L_nl0_3:
  s_bitcmp1_b32 s59, 16
  s_cbranch_scc0 L_nl0_4
  s_add_u32 s37, s60, 294912
  buffer_load_dwordx4 v[224:227], v2, s[12:15], s37 offen sc1
  s_add_u32 s37, s61, 294912
  buffer_load_dwordx4 v[228:231], v2, s[12:15], s37 offen sc1
L_nl0_4:
  s_bitcmp1_b32 s59, 20
  s_cbranch_scc0 L_nl0_5
  s_add_u32 s37, s60, 368640
  buffer_load_dwordx4 v[232:235], v2, s[12:15], s37 offen sc1
  s_add_u32 s37, s61, 368640
  buffer_load_dwordx4 v[236:239], v2, s[12:15], s37 offen sc1
L_nl0_5:
  s_bitcmp1_b32 s59, 24
  s_cbranch_scc0 L_nl0_6
  s_add_u32 s37, s60, 442368
  buffer_load_dwordx4 v[240:243], v2, s[12:15], s37 offen sc1
  s_add_u32 s37, s61, 442368
  buffer_load_dwordx4 v[244:247], v2, s[12:15], s37 offen sc1
L_nl0_6:
  s_bitcmp1_b32 s59, 28
  s_cbranch_scc0 L_nl0_7
  s_add_u32 s37, s60, 516096
  buffer_load_dwordx4 v[248:251], v2, s[12:15], s37 offen sc1
  s_add_u32 s37, s61, 516096
  buffer_load_dwordx4 v[252:255], v2, s[12:15], s37 offen sc1
L_nl0_7:
  s_or_b32 s58, s58, s59
  s_mov_b32 exec_hi, 0
  global_load_dword v7, v5, s[98:99] sc1
  s_mov_b32 exec_hi, -1
  s_waitcnt vmcnt(1)
  s_bitcmp1_b32 s59, 0
  s_cbranch_scc0 L_na0_0
  v_lshlrev_b32 v8, 16, v192
  v_and_b32 v9, s63, v192
  v_add_f32 v176, v176, v8
  v_add_f32 v177, v177, v9
  v_lshlrev_b32 v10, 16, v193
  v_and_b32 v11, s63, v193
  v_add_f32 v178, v178, v10
  v_add_f32 v179, v179, v11
  v_lshlrev_b32 v8, 16, v194
  v_and_b32 v9, s63, v194
  v_add_f32 v180, v180, v8
  v_add_f32 v181, v181, v9
  v_lshlrev_b32 v10, 16, v195
  v_and_b32 v11, s63, v195
  v_add_f32 v182, v182, v10
  v_add_f32 v183, v183, v11
  v_lshlrev_b32 v8, 16, v196
  v_and_b32 v9, s63, v196
  v_add_f32 v184, v184, v8
  v_add_f32 v185, v185, v9
  v_lshlrev_b32 v10, 16, v197
  v_and_b32 v11, s63, v197
  v_add_f32 v186, v186, v10
  v_add_f32 v187, v187, v11
  v_lshlrev_b32 v8, 16, v198
  v_and_b32 v9, s63, v198
  v_add_f32 v188, v188, v8
  v_add_f32 v189, v189, v9
  v_lshlrev_b32 v10, 16, v199
  v_and_b32 v11, s63, v199
  v_add_f32 v190, v190, v10
  v_add_f32 v191, v191, v11
L_na0_0:
  s_bitcmp1_b32 s59, 4
  s_cbranch_scc0 L_na0_1
  v_lshlrev_b32 v8, 16, v200
  v_and_b32 v9, s63, v200
  v_add_f32 v176, v176, v8
  v_add_f32 v177, v177, v9
  v_lshlrev_b32 v10, 16, v201
  v_and_b32 v11, s63, v201
  v_add_f32 v178, v178, v10
  v_add_f32 v179, v179, v11
  v_lshlrev_b32 v8, 16, v202
  v_and_b32 v9, s63, v202
  v_add_f32 v180, v180, v8
  v_add_f32 v181, v181, v9
  v_lshlrev_b32 v10, 16, v203
  v_and_b32 v11, s63, v203
  v_add_f32 v182, v182, v10
  v_add_f32 v183, v183, v11
  v_lshlrev_b32 v8, 16, v204
  v_and_b32 v9, s63, v204
  v_add_f32 v184, v184, v8
  v_add_f32 v185, v185, v9
  v_lshlrev_b32 v10, 16, v205
  v_and_b32 v11, s63, v205
  v_add_f32 v186, v186, v10
  v_add_f32 v187, v187, v11
  v_lshlrev_b32 v8, 16, v206
  v_and_b32 v9, s63, v206
  v_add_f32 v188, v188, v8
  v_add_f32 v189, v189, v9
  v_lshlrev_b32 v10, 16, v207
  v_and_b32 v11, s63, v207
  v_add_f32 v190, v190, v10
  v_add_f32 v191, v191, v11
L_na0_1:
  s_bitcmp1_b32 s59, 8
  s_cbranch_scc0 L_na0_2
  v_lshlrev_b32 v8, 16, v208
  v_and_b32 v9, s63, v208
  v_add_f32 v176, v176, v8
  v_add_f32 v177, v177, v9
  v_lshlrev_b32 v10, 16, v209
  v_and_b32 v11, s63, v209
  v_add_f32 v178, v178, v10
  v_add_f32 v179, v179, v11
  v_lshlrev_b32 v8, 16, v210
  v_and_b32 v9, s63, v210
  v_add_f32 v180, v180, v8
  v_add_f32 v181, v181, v9
  v_lshlrev_b32 v10, 16, v211
  v_and_b32 v11, s63, v211
  v_add_f32 v182, v182, v10
  v_add_f32 v183, v183, v11
  v_lshlrev_b32 v8, 16, v212
  v_and_b32 v9, s63, v212
  v_add_f32 v184, v184, v8
  v_add_f32 v185, v185, v9
  v_lshlrev_b32 v10, 16, v213
  v_and_b32 v11, s63, v213
  v_add_f32 v186, v186, v10
  v_add_f32 v187, v187, v11
  v_lshlrev_b32 v8, 16, v214
  v_and_b32 v9, s63, v214
  v_add_f32 v188, v188, v8
  v_add_f32 v189, v189, v9
  v_lshlrev_b32 v10, 16, v215
  v_and_b32 v11, s63, v215
  v_add_f32 v190, v190, v10
  v_add_f32 v191, v191, v11
L_na0_2:
  s_bitcmp1_b32 s59, 12
  s_cbranch_scc0 L_na0_3
  v_lshlrev_b32 v8, 16, v216
  v_and_b32 v9, s63, v216
  v_add_f32 v176, v176, v8
  v_add_f32 v177, v177, v9
  v_lshlrev_b32 v10, 16, v217
  v_and_b32 v11, s63, v217
  v_add_f32 v178, v178, v10
  v_add_f32 v179, v179, v11
  v_lshlrev_b32 v8, 16, v218
  v_and_b32 v9, s63, v218
  v_add_f32 v180, v180, v8
  v_add_f32 v181, v181, v9
  v_lshlrev_b32 v10, 16, v219
  v_and_b32 v11, s63, v219
  v_add_f32 v182, v182, v10
  v_add_f32 v183, v183, v11
  v_lshlrev_b32 v8, 16, v220
  v_and_b32 v9, s63, v220
  v_add_f32 v184, v184, v8
  v_add_f32 v185, v185, v9
  v_lshlrev_b32 v10, 16, v221
  v_and_b32 v11, s63, v221
  v_add_f32 v186, v186, v10
  v_add_f32 v187, v187, v11
  v_lshlrev_b32 v8, 16, v222
  v_and_b32 v9, s63, v222
  v_add_f32 v188, v188, v8
  v_add_f32 v189, v189, v9
  v_lshlrev_b32 v10, 16, v223
  v_and_b32 v11, s63, v223
  v_add_f32 v190, v190, v10
  v_add_f32 v191, v191, v11
L_na0_3:
  s_bitcmp1_b32 s59, 16
  s_cbranch_scc0 L_na0_4
  v_lshlrev_b32 v8, 16, v224
  v_and_b32 v9, s63, v224
  v_add_f32 v176, v176, v8
  v_add_f32 v177, v177, v9
  v_lshlrev_b32 v10, 16, v225
  v_and_b32 v11, s63, v225
  v_add_f32 v178, v178, v10
  v_add_f32 v179, v179, v11
  v_lshlrev_b32 v8, 16, v226
  v_and_b32 v9, s63, v226
  v_add_f32 v180, v180, v8
  v_add_f32 v181, v181, v9
  v_lshlrev_b32 v10, 16, v227
  v_and_b32 v11, s63, v227
  v_add_f32 v182, v182, v10
  v_add_f32 v183, v183, v11
  v_lshlrev_b32 v8, 16, v228
  v_and_b32 v9, s63, v228
  v_add_f32 v184, v184, v8
  v_add_f32 v185, v185, v9
  v_lshlrev_b32 v10, 16, v229
  v_and_b32 v11, s63, v229
  v_add_f32 v186, v186, v10
  v_add_f32 v187, v187, v11
  v_lshlrev_b32 v8, 16, v230
  v_and_b32 v9, s63, v230
  v_add_f32 v188, v188, v8
  v_add_f32 v189, v189, v9
  v_lshlrev_b32 v10, 16, v231
  v_and_b32 v11, s63, v231
  v_add_f32 v190, v190, v10
  v_add_f32 v191, v191, v11
L_na0_4:
  s_bitcmp1_b32 s59, 20
  s_cbranch_scc0 L_na0_5
  v_lshlrev_b32 v8, 16, v232
  v_and_b32 v9, s63, v232
  v_add_f32 v176, v176, v8
  v_add_f32 v177, v177, v9
  v_lshlrev_b32 v10, 16, v233
  v_and_b32 v11, s63, v233
  v_add_f32 v178, v178, v10
  v_add_f32 v179, v179, v11
  v_lshlrev_b32 v8, 16, v234
  v_and_b32 v9, s63, v234
  v_add_f32 v180, v180, v8
  v_add_f32 v181, v181, v9
  v_lshlrev_b32 v10, 16, v235
  v_and_b32 v11, s63, v235
  v_add_f32 v182, v182, v10
  v_add_f32 v183, v183, v11
  v_lshlrev_b32 v8, 16, v236
  v_and_b32 v9, s63, v236
  v_add_f32 v184, v184, v8
  v_add_f32 v185, v185, v9
  v_lshlrev_b32 v10, 16, v237
  v_and_b32 v11, s63, v237
  v_add_f32 v186, v186, v10
  v_add_f32 v187, v187, v11
  v_lshlrev_b32 v8, 16, v238
  v_and_b32 v9, s63, v238
  v_add_f32 v188, v188, v8
  v_add_f32 v189, v189, v9
  v_lshlrev_b32 v10, 16, v239
  v_and_b32 v11, s63, v239
  v_add_f32 v190, v190, v10
  v_add_f32 v191, v191, v11
L_na0_5:
  s_bitcmp1_b32 s59, 24
  s_cbranch_scc0 L_na0_6
  v_lshlrev_b32 v8, 16, v240
  v_and_b32 v9, s63, v240
  v_add_f32 v176, v176, v8
  v_add_f32 v177, v177, v9
  v_lshlrev_b32 v10, 16, v241
  v_and_b32 v11, s63, v241
  v_add_f32 v178, v178, v10
  v_add_f32 v179, v179, v11
  v_lshlrev_b32 v8, 16, v242
  v_and_b32 v9, s63, v242
  v_add_f32 v180, v180, v8
  v_add_f32 v181, v181, v9
  v_lshlrev_b32 v10, 16, v243
  v_and_b32 v11, s63, v243
  v_add_f32 v182, v182, v10
  v_add_f32 v183, v183, v11
  v_lshlrev_b32 v8, 16, v244
  v_and_b32 v9, s63, v244
  v_add_f32 v184, v184, v8
  v_add_f32 v185, v185, v9
  v_lshlrev_b32 v10, 16, v245
  v_and_b32 v11, s63, v245
  v_add_f32 v186, v186, v10
  v_add_f32 v187, v187, v11
  v_lshlrev_b32 v8, 16, v246
  v_and_b32 v9, s63, v246
  v_add_f32 v188, v188, v8
  v_add_f32 v189, v189, v9
  v_lshlrev_b32 v10, 16, v247
  v_and_b32 v11, s63, v247
  v_add_f32 v190, v190, v10
  v_add_f32 v191, v191, v11
L_na0_6:
  s_bitcmp1_b32 s59, 28
  s_cbranch_scc0 L_na0_7
  v_lshlrev_b32 v8, 16, v248
  v_and_b32 v9, s63, v248
  v_add_f32 v176, v176, v8
  v_add_f32 v177, v177, v9
  v_lshlrev_b32 v10, 16, v249
  v_and_b32 v11, s63, v249
  v_add_f32 v178, v178, v10
  v_add_f32 v179, v179, v11
  v_lshlrev_b32 v8, 16, v250
  v_and_b32 v9, s63, v250
  v_add_f32 v180, v180, v8
  v_add_f32 v181, v181, v9
  v_lshlrev_b32 v10, 16, v251
  v_and_b32 v11, s63, v251
  v_add_f32 v182, v182, v10
  v_add_f32 v183, v183, v11
  v_lshlrev_b32 v8, 16, v252
  v_and_b32 v9, s63, v252
  v_add_f32 v184, v184, v8
  v_add_f32 v185, v185, v9
  v_lshlrev_b32 v10, 16, v253
  v_and_b32 v11, s63, v253
  v_add_f32 v186, v186, v10
  v_add_f32 v187, v187, v11
  v_lshlrev_b32 v8, 16, v254
  v_and_b32 v9, s63, v254
  v_add_f32 v188, v188, v8
  v_add_f32 v189, v189, v9
  v_lshlrev_b32 v10, 16, v255
  v_and_b32 v11, s63, v255
  v_add_f32 v190, v190, v10
  v_add_f32 v191, v191, v11
L_na0_7:
  s_cmp_eq_u32 s58, 0x11111111
  s_cbranch_scc0 L_eval0
  v_cvt_pk_bf16_f32 v192, v176, v177
  v_cvt_pk_bf16_f32 v193, v178, v179
  v_cvt_pk_bf16_f32 v194, v180, v181
  v_cvt_pk_bf16_f32 v195, v182, v183
  v_cvt_pk_bf16_f32 v196, v184, v185
  v_cvt_pk_bf16_f32 v197, v186, v187
  v_cvt_pk_bf16_f32 v198, v188, v189
  v_cvt_pk_bf16_f32 v199, v190, v191
  s_nop 1
  v_permlane16_swap_b32 v192, v194
  v_permlane16_swap_b32 v193, v195
  buffer_store_dwordx4 v[192:195], v3, s[16:19], s64 offen sc1 nt
  v_permlane16_swap_b32 v196, v198
  v_permlane16_swap_b32 v197, v199
  buffer_store_dwordx4 v[196:199], v3, s[16:19], s65 offen sc1 nt
  s_endpgm
L_own1:
  s_mov_b32 s39, 0
  s_lshl_b32 s36, s3, 10
  s_add_u32 s36, s36, 131072
  v_add_u32 v6, s36, v2
  ds_read_b128 v[192:195], v6 offset:0
  s_waitcnt lgkmcnt(0)
  v_lshlrev_b32 v176, 16, v192
  v_and_b32 v177, s63, v192
  v_lshlrev_b32 v178, 16, v193
  v_and_b32 v179, s63, v193
  v_lshlrev_b32 v180, 16, v194
  v_and_b32 v181, s63, v194
  v_lshlrev_b32 v182, 16, v195
  v_and_b32 v183, s63, v195
  s_mov_b32 exec_hi, 0
  s_waitcnt vmcnt(1)
  s_cmp_lt_u32 s3, 4
  s_cbranch_scc0 L_have1
  s_branch L_eval1
L_poll1:
  s_mov_b32 exec_hi, 0
  global_load_dword v7, v5, s[98:99] sc1
L_eval1:
  s_mov_b32 exec_hi, 0
  s_add_u32 s39, s39, 1
  s_waitcnt vmcnt(0)
L_have1:
  v_cmp_ne_u32 vcc, 0, v7
  s_mov_b32 exec_hi, -1
  s_lshr_b32 s36, vcc_lo, 1
  s_and_b32 s36, s36, vcc_lo
  s_lshr_b32 s37, s36, 2
  s_and_b32 s36, s36, s37
  s_and_b32 s36, s36, 0x11111111
  s_cmp_ge_u32 s39, 4194304
  s_cselect_b32 s36, 0x11111111, s36
  s_andn2_b32 s59, s36, s58
  s_cbranch_scc1 L_new1
  s_sleep 4
  s_branch L_poll1
L_new1:
  s_bitcmp1_b32 s59, 0
  s_cbranch_scc0 L_nl1_0
  s_add_u32 s37, s60, 0
  buffer_load_dwordx4 v[192:195], v2, s[12:15], s37 offen sc1
L_nl1_0:
  s_bitcmp1_b32 s59, 4
  s_cbranch_scc0 L_nl1_1
  s_add_u32 s37, s60, 73728
  buffer_load_dwordx4 v[200:203], v2, s[12:15], s37 offen sc1
L_nl1_1:
  s_bitcmp1_b32 s59, 8
  s_cbranch_scc0 L_nl1_2
  s_add_u32 s37, s60, 147456
  buffer_load_dwordx4 v[208:211], v2, s[12:15], s37 offen sc1
L_nl1_2:
  s_bitcmp1_b32 s59, 12
  s_cbranch_scc0 L_nl1_3
  s_add_u32 s37, s60, 221184
  buffer_load_dwordx4 v[216:219], v2, s[12:15], s37 offen sc1
L_nl1_3:
  s_bitcmp1_b32 s59, 16
  s_cbranch_scc0 L_nl1_4
  s_add_u32 s37, s60, 294912
  buffer_load_dwordx4 v[224:227], v2, s[12:15], s37 offen sc1
L_nl1_4:
  s_bitcmp1_b32 s59, 20
  s_cbranch_scc0 L_nl1_5
  s_add_u32 s37, s60, 368640
  buffer_load_dwordx4 v[232:235], v2, s[12:15], s37 offen sc1
L_nl1_5:
  s_bitcmp1_b32 s59, 24
  s_cbranch_scc0 L_nl1_6
  s_add_u32 s37, s60, 442368
  buffer_load_dwordx4 v[240:243], v2, s[12:15], s37 offen sc1
L_nl1_6:
  s_bitcmp1_b32 s59, 28
  s_cbranch_scc0 L_nl1_7
  s_add_u32 s37, s60, 516096
  buffer_load_dwordx4 v[248:251], v2, s[12:15], s37 offen sc1
L_nl1_7:
  s_or_b32 s58, s58, s59
  s_mov_b32 exec_hi, 0
  global_load_dword v7, v5, s[98:99] sc1
  s_mov_b32 exec_hi, -1
  s_waitcnt vmcnt(1)
  s_bitcmp1_b32 s59, 0
  s_cbranch_scc0 L_na1_0
  v_lshlrev_b32 v8, 16, v192
  v_and_b32 v9, s63, v192
  v_add_f32 v176, v176, v8
  v_add_f32 v177, v177, v9
  v_lshlrev_b32 v10, 16, v193
  v_and_b32 v11, s63, v193
  v_add_f32 v178, v178, v10
  v_add_f32 v179, v179, v11
  v_lshlrev_b32 v8, 16, v194
  v_and_b32 v9, s63, v194
  v_add_f32 v180, v180, v8
  v_add_f32 v181, v181, v9
  v_lshlrev_b32 v10, 16, v195
  v_and_b32 v11, s63, v195
  v_add_f32 v182, v182, v10
  v_add_f32 v183, v183, v11
L_na1_0:
  s_bitcmp1_b32 s59, 4
  s_cbranch_scc0 L_na1_1
  v_lshlrev_b32 v8, 16, v200
  v_and_b32 v9, s63, v200
  v_add_f32 v176, v176, v8
  v_add_f32 v177, v177, v9
  v_lshlrev_b32 v10, 16, v201
  v_and_b32 v11, s63, v201
  v_add_f32 v178, v178, v10
  v_add_f32 v179, v179, v11
  v_lshlrev_b32 v8, 16, v202
  v_and_b32 v9, s63, v202
  v_add_f32 v180, v180, v8
  v_add_f32 v181, v181, v9
  v_lshlrev_b32 v10, 16, v203
  v_and_b32 v11, s63, v203
  v_add_f32 v182, v182, v10
  v_add_f32 v183, v183, v11
L_na1_1:
  s_bitcmp1_b32 s59, 8
  s_cbranch_scc0 L_na1_2
  v_lshlrev_b32 v8, 16, v208
  v_and_b32 v9, s63, v208
  v_add_f32 v176, v176, v8
  v_add_f32 v177, v177, v9
  v_lshlrev_b32 v10, 16, v209
  v_and_b32 v11, s63, v209
  v_add_f32 v178, v178, v10
  v_add_f32 v179, v179, v11
  v_lshlrev_b32 v8, 16, v210
  v_and_b32 v9, s63, v210
  v_add_f32 v180, v180, v8
  v_add_f32 v181, v181, v9
  v_lshlrev_b32 v10, 16, v211
  v_and_b32 v11, s63, v211
  v_add_f32 v182, v182, v10
  v_add_f32 v183, v183, v11
L_na1_2:
  s_bitcmp1_b32 s59, 12
  s_cbranch_scc0 L_na1_3
  v_lshlrev_b32 v8, 16, v216
  v_and_b32 v9, s63, v216
  v_add_f32 v176, v176, v8
  v_add_f32 v177, v177, v9
  v_lshlrev_b32 v10, 16, v217
  v_and_b32 v11, s63, v217
  v_add_f32 v178, v178, v10
  v_add_f32 v179, v179, v11
  v_lshlrev_b32 v8, 16, v218
  v_and_b32 v9, s63, v218
  v_add_f32 v180, v180, v8
  v_add_f32 v181, v181, v9
  v_lshlrev_b32 v10, 16, v219
  v_and_b32 v11, s63, v219
  v_add_f32 v182, v182, v10
  v_add_f32 v183, v183, v11
L_na1_3:
  s_bitcmp1_b32 s59, 16
  s_cbranch_scc0 L_na1_4
  v_lshlrev_b32 v8, 16, v224
  v_and_b32 v9, s63, v224
  v_add_f32 v176, v176, v8
  v_add_f32 v177, v177, v9
  v_lshlrev_b32 v10, 16, v225
  v_and_b32 v11, s63, v225
  v_add_f32 v178, v178, v10
  v_add_f32 v179, v179, v11
  v_lshlrev_b32 v8, 16, v226
  v_and_b32 v9, s63, v226
  v_add_f32 v180, v180, v8
  v_add_f32 v181, v181, v9
  v_lshlrev_b32 v10, 16, v227
  v_and_b32 v11, s63, v227
  v_add_f32 v182, v182, v10
  v_add_f32 v183, v183, v11
L_na1_4:
  s_bitcmp1_b32 s59, 20
  s_cbranch_scc0 L_na1_5
  v_lshlrev_b32 v8, 16, v232
  v_and_b32 v9, s63, v232
  v_add_f32 v176, v176, v8
  v_add_f32 v177, v177, v9
  v_lshlrev_b32 v10, 16, v233
  v_and_b32 v11, s63, v233
  v_add_f32 v178, v178, v10
  v_add_f32 v179, v179, v11
  v_lshlrev_b32 v8, 16, v234
  v_and_b32 v9, s63, v234
  v_add_f32 v180, v180, v8
  v_add_f32 v181, v181, v9
  v_lshlrev_b32 v10, 16, v235
  v_and_b32 v11, s63, v235
  v_add_f32 v182, v182, v10
  v_add_f32 v183, v183, v11
L_na1_5:
  s_bitcmp1_b32 s59, 24
  s_cbranch_scc0 L_na1_6
  v_lshlrev_b32 v8, 16, v240
  v_and_b32 v9, s63, v240
  v_add_f32 v176, v176, v8
  v_add_f32 v177, v177, v9
  v_lshlrev_b32 v10, 16, v241
  v_and_b32 v11, s63, v241
  v_add_f32 v178, v178, v10
  v_add_f32 v179, v179, v11
  v_lshlrev_b32 v8, 16, v242
  v_and_b32 v9, s63, v242
  v_add_f32 v180, v180, v8
  v_add_f32 v181, v181, v9
  v_lshlrev_b32 v10, 16, v243
  v_and_b32 v11, s63, v243
  v_add_f32 v182, v182, v10
  v_add_f32 v183, v183, v11
L_na1_6:
  s_bitcmp1_b32 s59, 28
  s_cbranch_scc0 L_na1_7
  v_lshlrev_b32 v8, 16, v248
  v_and_b32 v9, s63, v248
  v_add_f32 v176, v176, v8
  v_add_f32 v177, v177, v9
  v_lshlrev_b32 v10, 16, v249
  v_and_b32 v11, s63, v249
  v_add_f32 v178, v178, v10
  v_add_f32 v179, v179, v11
  v_lshlrev_b32 v8, 16, v250
  v_and_b32 v9, s63, v250
  v_add_f32 v180, v180, v8
  v_add_f32 v181, v181, v9
  v_lshlrev_b32 v10, 16, v251
  v_and_b32 v11, s63, v251
  v_add_f32 v182, v182, v10
  v_add_f32 v183, v183, v11
L_na1_7:
  s_cmp_eq_u32 s58, 0x11111111
  s_cbranch_scc0 L_eval1
  v_cvt_pk_bf16_f32 v192, v176, v177
  v_cvt_pk_bf16_f32 v193, v178, v179
  v_cvt_pk_bf16_f32 v194, v180, v181
  v_cvt_pk_bf16_f32 v195, v182, v183
  s_nop 1
  v_permlane16_swap_b32 v192, v194
  v_permlane16_swap_b32 v193, v195
  buffer_store_dwordx4 v[192:195], v3, s[16:19], s64 offen sc1 nt
  s_endpgm
L_prole:
  buffer_load_dwordx4 v[32:35], v23, s[28:31], s48 offen
  s_add_u32 s48, s48, 64
  buffer_load_dwordx4 v[36:39], v23, s[28:31], s48 offen
  s_add_u32 s48, s48, 64
  s_cmp_eq_u32 s48, 1152
  s_cselect_b32 s48, 0, s48
  buffer_load_dwordx4 v[40:43], v23, s[28:31], s48 offen
  s_add_u32 s48, s48, 64
  buffer_load_dwordx4 v[44:47], v23, s[28:31], s48 offen
  s_add_u32 s48, s48, 64
  s_cmp_eq_u32 s48, 1152
  s_cselect_b32 s48, 0, s48
  buffer_load_dwordx4 v[48:51], v23, s[28:31], s48 offen
  s_add_u32 s48, s48, 64
  buffer_load_dwordx4 v[52:55], v23, s[28:31], s48 offen
  s_add_u32 s48, s48, 64
  s_cmp_eq_u32 s48, 1152
  s_cselect_b32 s48, 0, s48
  buffer_load_dwordx4 v[56:59], v23, s[28:31], s48 offen
  s_add_u32 s48, s48, 64
  buffer_load_dwordx4 v[60:63], v23, s[28:31], s48 offen
  s_add_u32 s48, s48, 64
  s_cmp_eq_u32 s48, 1152
  s_cselect_b32 s48, 0, s48
  s_lshl_b32 s36, s6, 3
  s_add_u32 s36, s36, s7
  s_lshl_b32 s36, s36, 18
  s_lshl_b32 s36, s36, s5
  s_lshl_b32 s37, 262144, s5
  s_add_u32 s12, s54, s36
  s_addc_u32 s13, s55, 0
  s_mov_b32 s14, s37
  s_mov_b32 s15, 0x20000
  s_add_u32 s16, s56, s36
  s_addc_u32 s17, s57, 0
  s_mov_b32 s18, s37
  s_mov_b32 s19, 0x20000
  s_mul_i32 s36, s7, 589824
  s_add_u32 s24, s60, s36
  s_addc_u32 s25, s61, 0
  s_mov_b32 s26, 589824
  s_mov_b32 s27, 0x20000
  s_mul_i32 s36, s2, 73728
  s_add_u32 s32, s62, s36
  s_addc_u32 s33, s63, 0
  s_mov_b32 s34, 73728
  s_mov_b32 s35, 0x20000
  s_add_u32 s98, s62, 20971520
  s_addc_u32 s99, s63, 0
  s_lshl_b32 s36, s6, 3
  s_add_u32 s36, s36, s7
  s_lshl_b32 s36, s36, 19
  s_lshl_b32 s37, s7, 10
  s_mul_i32 s38, s7, 589824
  s_add_u32 s52, s90, s36
  s_addc_u32 s53, s91, 0
  s_mov_b32 s55, 0x20000
  s_add_u32 s56, s94, s37
  s_addc_u32 s57, s95, 0
  s_mov_b32 s59, 0x20000
  s_add_u32 s60, s96, s38
  s_addc_u32 s61, s97, 0
  s_mov_b32 s63, 0x20000
  s_mov_b32 s54, 524288
  s_mov_b32 s58, s22
  s_mov_b32 s62, s26
  v_bfe_u32 v4, v1, 5, 1
  v_lshlrev_b32 v4, 1, v4
  v_xor_b32 v4, v4, v3
  v_lshlrev_b32 v4, 4, v4
  v_lshl_add_u32 v4, v2, 6, v4
  v_add_u32 v14, 131072, v4
  v_and_b32 v2, 15, v1
  v_lshrrev_b32 v3, 4, v1
  v_bfe_u32 v4, v1, 3, 1
  v_lshlrev_b32 v4, 1, v4
  v_xor_b32 v4, v4, v3
  v_lshlrev_b32 v4, 4, v4
  v_lshl_add_u32 v4, v2, 6, v4
  v_add_u32 v15, 131072, v4
  v_bfe_u32 v4, v1, 2, 2
  v_lshl_add_u32 v5, v3, 3, v4
  v_and_b32 v6, 3, v1
  v_lshlrev_b32 v6, 3, v6
  v_lshl_add_u32 v5, v5, 9, v6
  v_and_b32 v6, 1, v3
  v_lshl_add_u32 v6, v6, 2, v4
  s_lshl_b32 s36, s4, 2
  v_xor_b32 v6, s36, v6
  v_xor_b32 v8, 0, v6
  v_lshl_add_u32 v232, v8, 5, v5
  v_add_u32 v16, 65536, v232
  v_xor_b32 v8, 1, v6
  v_lshl_add_u32 v233, v8, 5, v5
  v_add_u32 v17, 65536, v233
  v_xor_b32 v8, 2, v6
  v_lshl_add_u32 v234, v8, 5, v5
  v_add_u32 v18, 65536, v234
  v_xor_b32 v8, 3, v6
  v_lshl_add_u32 v235, v8, 5, v5
  v_add_u32 v19, 65536, v235
  s_lshr_b32 s36, s4, 1
  s_and_b32 s37, s4, 1
  s_mov_b32 s40, 0x3e0293ee
  s_lshl_b32 s38, s36, 14
  s_add_u32 s38, s38, 131072
  v_bfe_u32 v6, v1, 4, 1
  v_lshrrev_b32 v7, 5, v1
  v_lshl_add_u32 v6, v6, 1, v7
  v_and_b32 v7, 15, v1
  v_xor_b32 v6, v6, v7
  v_lshlrev_b32 v6, 4, v6
  v_lshl_add_u32 v6, v7, 8, v6
  v_add_u32 v20, s38, v6
  s_lshl_b32 s38, s37, 7
  v_xor_b32 v20, s38, v20
  v_xor_b32 v6, v2, v3
  v_lshlrev_b32 v6, 4, v6
  v_lshl_add_u32 v6, v2, 8, v6
  s_lshl_b32 s38, s37, 13
  s_add_u32 s38, s38, 131072
  v_add_u32 v21, s38, v6
  s_lshl_b32 s38, s36, 11
  s_lshl_b32 s39, s37, 12
  s_add_u32 s38, s38, s39
  v_lshlrev_b32 v6, 4, v1
  v_add_u32 v24, s38, v6
  v_mov_b32 v10, v25
  v_mov_b32 v11, v26
  v_mov_b32 v12, v27
  v_mov_b32 v13, v28
  v_and_b32 v4, 15, v1
  v_lshrrev_b32 v5, 4, v1
  s_lshl_b32 s36, s4, 3
  v_add_u32 v6, s36, v5
  v_add_u32 v7, 0, v6
  v_and_b32 v7, 15, v7
  v_xor_b32 v7, v7, v4
  v_lshlrev_b32 v7, 4, v7
  v_lshl_add_u32 v29, v6, 8, v7
  v_add_u32 v7, 4, v6
  v_and_b32 v7, 15, v7
  v_xor_b32 v7, v7, v4
  v_lshlrev_b32 v7, 4, v7
  v_lshl_add_u32 v30, v6, 8, v7
  v_add_u32 v7, 0, v5
  v_lshlrev_b32 v7, 1, v7
  v_xor_b32 v7, v7, v4
  v_lshlrev_b32 v7, 4, v7
  v_lshl_add_u32 v31, v6, 8, v7
  v_add_u32 v7, 4, v5
  v_lshlrev_b32 v7, 1, v7
  v_xor_b32 v7, v7, v4
  v_lshlrev_b32 v7, 4, v7
  v_lshl_add_u32 v22, v6, 8, v7
  s_lshl_b32 s49, s4, 11
  s_lshl_b32 s68, 131072, s5
  s_mov_b32 s69, 0
  s_mov_b32 s47, 512
  s_waitcnt vmcnt(7)
  ds_write_b128 v14, v[32:35] offset:0
  s_waitcnt vmcnt(6)
  ds_write_b128 v14, v[36:39] offset:4096
  s_waitcnt vmcnt(5)
  ds_write_b128 v14, v[40:43] offset:8192
  s_waitcnt vmcnt(4)
  ds_write_b128 v14, v[44:47] offset:12288
  s_waitcnt lgkmcnt(3)
  s_barrier
  ds_read_b128 v[168:171], v15 offset:0
  ds_read_b64_tr_b16 v[184:185], v16 offset:0
  ds_read_b64_tr_b16 v[186:187], v16 offset:2048
  ds_read_b128 v[172:175], v15 offset:1024
  ds_read_b64_tr_b16 v[188:189], v17 offset:0
  ds_read_b64_tr_b16 v[190:191], v17 offset:2048
  ds_read_b128 v[176:179], v15 offset:2048
  ds_read_b64_tr_b16 v[192:193], v18 offset:0
  ds_read_b64_tr_b16 v[194:195], v18 offset:2048
  ds_read_b128 v[180:183], v15 offset:3072
  ds_read_b64_tr_b16 v[196:197], v19 offset:0
  ds_read_b64_tr_b16 v[198:199], v19 offset:2048
  s_waitcnt vmcnt(3)
  ds_write_b128 v14, v[48:51] offset:16384
  s_waitcnt vmcnt(2)
  ds_write_b128 v14, v[52:55] offset:20480
  s_waitcnt vmcnt(1)
  ds_write_b128 v14, v[56:59] offset:24576
  s_waitcnt vmcnt(0)
  ds_write_b128 v14, v[60:63] offset:28672
  s_waitcnt lgkmcnt(4)
  s_barrier
  v_mfma_f32_16x16x32_bf16 v[104:107], v[184:187], v[168:171], 0
  ds_read_b128 v[200:203], v15 offset:4096
  v_mfma_f32_16x16x32_bf16 v[108:111], v[188:191], v[168:171], 0
  ds_read_b64_tr_b16 v[216:217], v16 offset:16384
  v_mfma_f32_16x16x32_bf16 v[112:115], v[184:187], v[172:175], 0
  ds_read_b64_tr_b16 v[218:219], v16 offset:18432
  v_mfma_f32_16x16x32_bf16 v[116:119], v[188:191], v[172:175], 0
  ds_read_b128 v[204:207], v15 offset:5120
  v_mfma_f32_16x16x32_bf16 v[120:123], v[184:187], v[176:179], 0
  ds_read_b64_tr_b16 v[220:221], v17 offset:16384
  v_mfma_f32_16x16x32_bf16 v[124:127], v[188:191], v[176:179], 0
  ds_read_b64_tr_b16 v[222:223], v17 offset:18432
  v_mfma_f32_16x16x32_bf16 v[128:131], v[184:187], v[180:183], 0
  ds_read_b128 v[208:211], v15 offset:6144
  v_mfma_f32_16x16x32_bf16 v[132:135], v[188:191], v[180:183], 0
  ds_read_b64_tr_b16 v[224:225], v18 offset:16384
  v_mfma_f32_16x16x32_bf16 v[136:139], v[192:195], v[168:171], 0
  ds_read_b64_tr_b16 v[226:227], v18 offset:18432
  v_mfma_f32_16x16x32_bf16 v[140:143], v[196:199], v[168:171], 0
  ds_read_b128 v[212:215], v15 offset:7168
  v_mfma_f32_16x16x32_bf16 v[144:147], v[192:195], v[172:175], 0
  ds_read_b64_tr_b16 v[228:229], v19 offset:16384
  v_mfma_f32_16x16x32_bf16 v[148:151], v[196:199], v[172:175], 0
  ds_read_b64_tr_b16 v[230:231], v19 offset:18432
  v_mfma_f32_16x16x32_bf16 v[152:155], v[192:195], v[176:179], 0
  v_mfma_f32_16x16x32_bf16 v[156:159], v[196:199], v[176:179], 0
  v_mfma_f32_16x16x32_bf16 v[160:163], v[192:195], v[180:183], 0
  v_mfma_f32_16x16x32_bf16 v[164:167], v[196:199], v[180:183], 0
  s_waitcnt lgkmcnt(0)
  s_barrier
  v_mfma_f32_16x16x32_bf16 v[104:107], v[216:219], v[200:203], v[104:107]
  ds_read_b128 v[168:171], v15 offset:8192
  v_mfma_f32_16x16x32_bf16 v[108:111], v[220:223], v[200:203], v[108:111]
  ds_read_b64_tr_b16 v[184:185], v16 offset:32768
  v_mfma_f32_16x16x32_bf16 v[112:115], v[216:219], v[204:207], v[112:115]
  ds_read_b64_tr_b16 v[186:187], v16 offset:34816
  v_mfma_f32_16x16x32_bf16 v[116:119], v[220:223], v[204:207], v[116:119]
  ds_read_b128 v[172:175], v15 offset:9216
  v_mfma_f32_16x16x32_bf16 v[120:123], v[216:219], v[208:211], v[120:123]
  ds_read_b64_tr_b16 v[188:189], v17 offset:32768
  v_mfma_f32_16x16x32_bf16 v[124:127], v[220:223], v[208:211], v[124:127]
  ds_read_b64_tr_b16 v[190:191], v17 offset:34816
  v_mfma_f32_16x16x32_bf16 v[128:131], v[216:219], v[212:215], v[128:131]
  ds_read_b128 v[176:179], v15 offset:10240
  v_mfma_f32_16x16x32_bf16 v[132:135], v[220:223], v[212:215], v[132:135]
  ds_read_b64_tr_b16 v[192:193], v18 offset:32768
  v_mfma_f32_16x16x32_bf16 v[136:139], v[224:227], v[200:203], v[136:139]
  ds_read_b64_tr_b16 v[194:195], v18 offset:34816
  v_mfma_f32_16x16x32_bf16 v[140:143], v[228:231], v[200:203], v[140:143]
  ds_read_b128 v[180:183], v15 offset:11264
  v_mfma_f32_16x16x32_bf16 v[144:147], v[224:227], v[204:207], v[144:147]
  ds_read_b64_tr_b16 v[196:197], v19 offset:32768
  v_mfma_f32_16x16x32_bf16 v[148:151], v[228:231], v[204:207], v[148:151]
  ds_read_b64_tr_b16 v[198:199], v19 offset:34816
  v_mfma_f32_16x16x32_bf16 v[152:155], v[224:227], v[208:211], v[152:155]
  v_mfma_f32_16x16x32_bf16 v[156:159], v[228:231], v[208:211], v[156:159]
  v_mfma_f32_16x16x32_bf16 v[160:163], v[224:227], v[212:215], v[160:163]
  v_mfma_f32_16x16x32_bf16 v[164:167], v[228:231], v[212:215], v[164:167]
  s_waitcnt lgkmcnt(0)
  s_barrier
  v_mfma_f32_16x16x32_bf16 v[104:107], v[184:187], v[168:171], v[104:107]
  ds_read_b128 v[200:203], v15 offset:12288
  v_mfma_f32_16x16x32_bf16 v[108:111], v[188:191], v[168:171], v[108:111]
  ds_read_b64_tr_b16 v[216:217], v16 offset:49152
  v_mfma_f32_16x16x32_bf16 v[112:115], v[184:187], v[172:175], v[112:115]
  ds_read_b64_tr_b16 v[218:219], v16 offset:51200
  v_mfma_f32_16x16x32_bf16 v[116:119], v[188:191], v[172:175], v[116:119]
  ds_read_b128 v[204:207], v15 offset:13312
  buffer_load_dwordx4 v[64:67], v23, s[28:31], s48 offen
  v_mfma_f32_16x16x32_bf16 v[120:123], v[184:187], v[176:179], v[120:123]
  ds_read_b64_tr_b16 v[220:221], v17 offset:49152
  v_mfma_f32_16x16x32_bf16 v[124:127], v[188:191], v[176:179], v[124:127]
  ds_read_b64_tr_b16 v[222:223], v17 offset:51200
  v_mfma_f32_16x16x32_bf16 v[128:131], v[184:187], v[180:183], v[128:131]
  ds_read_b128 v[208:211], v15 offset:14336
  v_mfma_f32_16x16x32_bf16 v[132:135], v[188:191], v[180:183], v[132:135]
  ds_read_b64_tr_b16 v[224:225], v18 offset:49152
  s_add_u32 s48, s48, 64
  buffer_load_dwordx4 v[68:71], v23, s[28:31], s48 offen
  v_mfma_f32_16x16x32_bf16 v[136:139], v[192:195], v[168:171], v[136:139]
  ds_read_b64_tr_b16 v[226:227], v18 offset:51200
  v_mfma_f32_16x16x32_bf16 v[140:143], v[196:199], v[168:171], v[140:143]
  ds_read_b128 v[212:215], v15 offset:15360
  v_mfma_f32_16x16x32_bf16 v[144:147], v[192:195], v[172:175], v[144:147]
  ds_read_b64_tr_b16 v[228:229], v19 offset:49152
  v_mfma_f32_16x16x32_bf16 v[148:151], v[196:199], v[172:175], v[148:151]
  ds_read_b64_tr_b16 v[230:231], v19 offset:51200
  s_add_u32 s48, s48, 64
  s_cmp_eq_u32 s48, 1152
  s_cselect_b32 s48, 0, s48
  buffer_load_dwordx4 v[72:75], v23, s[28:31], s48 offen
  v_mfma_f32_16x16x32_bf16 v[152:155], v[192:195], v[176:179], v[152:155]
  v_mfma_f32_16x16x32_bf16 v[156:159], v[196:199], v[176:179], v[156:159]
  v_mfma_f32_16x16x32_bf16 v[160:163], v[192:195], v[180:183], v[160:163]
  v_mfma_f32_16x16x32_bf16 v[164:167], v[196:199], v[180:183], v[164:167]
  s_add_u32 s48, s48, 64
  buffer_load_dwordx4 v[76:79], v23, s[28:31], s48 offen
  s_add_u32 s48, s48, 64
  s_cmp_eq_u32 s48, 1152
  s_cselect_b32 s48, 0, s48
  s_waitcnt lgkmcnt(0)
  s_barrier
  v_mfma_f32_16x16x32_bf16 v[104:107], v[216:219], v[200:203], v[104:107]
  ds_read_b128 v[168:171], v15 offset:16384
  v_mfma_f32_16x16x32_bf16 v[108:111], v[220:223], v[200:203], v[108:111]
  ds_read_b64_tr_b16 v[184:185], v232 offset:0
  v_mfma_f32_16x16x32_bf16 v[112:115], v[216:219], v[204:207], v[112:115]
  ds_read_b64_tr_b16 v[186:187], v232 offset:2048
  v_mfma_f32_16x16x32_bf16 v[116:119], v[220:223], v[204:207], v[116:119]
  ds_read_b128 v[172:175], v15 offset:17408
  buffer_load_dwordx4 v[80:83], v23, s[28:31], s48 offen
  v_mfma_f32_16x16x32_bf16 v[120:123], v[216:219], v[208:211], v[120:123]
  ds_read_b64_tr_b16 v[188:189], v233 offset:0
  v_mfma_f32_16x16x32_bf16 v[124:127], v[220:223], v[208:211], v[124:127]
  ds_read_b64_tr_b16 v[190:191], v233 offset:2048
  v_mfma_f32_16x16x32_bf16 v[128:131], v[216:219], v[212:215], v[128:131]
  ds_read_b128 v[176:179], v15 offset:18432
  v_mfma_f32_16x16x32_bf16 v[132:135], v[220:223], v[212:215], v[132:135]
  ds_read_b64_tr_b16 v[192:193], v234 offset:0
  s_add_u32 s48, s48, 64
  buffer_load_dwordx4 v[84:87], v23, s[28:31], s48 offen
  v_mfma_f32_16x16x32_bf16 v[136:139], v[224:227], v[200:203], v[136:139]
  ds_read_b64_tr_b16 v[194:195], v234 offset:2048
  v_mfma_f32_16x16x32_bf16 v[140:143], v[228:231], v[200:203], v[140:143]
  ds_read_b128 v[180:183], v15 offset:19456
  v_mfma_f32_16x16x32_bf16 v[144:147], v[224:227], v[204:207], v[144:147]
  ds_read_b64_tr_b16 v[196:197], v235 offset:0
  v_mfma_f32_16x16x32_bf16 v[148:151], v[228:231], v[204:207], v[148:151]
  ds_read_b64_tr_b16 v[198:199], v235 offset:2048
  s_add_u32 s48, s48, 64
  s_cmp_eq_u32 s48, 1152
  s_cselect_b32 s48, 0, s48
  buffer_load_dwordx4 v[88:91], v23, s[28:31], s48 offen
  v_mfma_f32_16x16x32_bf16 v[152:155], v[224:227], v[208:211], v[152:155]
  v_mfma_f32_16x16x32_bf16 v[156:159], v[228:231], v[208:211], v[156:159]
  v_mfma_f32_16x16x32_bf16 v[160:163], v[224:227], v[212:215], v[160:163]
  v_mfma_f32_16x16x32_bf16 v[164:167], v[228:231], v[212:215], v[164:167]
  s_add_u32 s48, s48, 64
  buffer_load_dwordx4 v[92:95], v23, s[28:31], s48 offen
  s_add_u32 s48, s48, 64
  s_cmp_eq_u32 s48, 1152
  s_cselect_b32 s48, 0, s48
  s_waitcnt lgkmcnt(0)
  s_barrier
  v_mfma_f32_16x16x32_bf16 v[104:107], v[184:187], v[168:171], v[104:107]
  ds_read_b128 v[200:203], v15 offset:20480
  v_mfma_f32_16x16x32_bf16 v[108:111], v[188:191], v[168:171], v[108:111]
  ds_read_b64_tr_b16 v[216:217], v232 offset:16384
  v_mfma_f32_16x16x32_bf16 v[112:115], v[184:187], v[172:175], v[112:115]
  ds_read_b64_tr_b16 v[218:219], v232 offset:18432
  v_mfma_f32_16x16x32_bf16 v[116:119], v[188:191], v[172:175], v[116:119]
  ds_read_b128 v[204:207], v15 offset:21504
  buffer_load_dwordx4 v[96:99], v23, s[28:31], s48 offen
  v_mfma_f32_16x16x32_bf16 v[120:123], v[184:187], v[176:179], v[120:123]
  ds_read_b64_tr_b16 v[220:221], v233 offset:16384
  v_mfma_f32_16x16x32_bf16 v[124:127], v[188:191], v[176:179], v[124:127]
  ds_read_b64_tr_b16 v[222:223], v233 offset:18432
  v_mfma_f32_16x16x32_bf16 v[128:131], v[184:187], v[180:183], v[128:131]
  ds_read_b128 v[208:211], v15 offset:22528
  v_mfma_f32_16x16x32_bf16 v[132:135], v[188:191], v[180:183], v[132:135]
  ds_read_b64_tr_b16 v[224:225], v234 offset:16384
  s_add_u32 s48, s48, 64
  buffer_load_dwordx4 v[100:103], v23, s[28:31], s48 offen
  s_add_u32 s48, s48, 64
  s_cmp_eq_u32 s48, 1152
  s_cselect_b32 s48, 0, s48
  v_mfma_f32_16x16x32_bf16 v[136:139], v[192:195], v[168:171], v[136:139]
  ds_read_b64_tr_b16 v[226:227], v234 offset:18432
  v_mfma_f32_16x16x32_bf16 v[140:143], v[196:199], v[168:171], v[140:143]
  ds_read_b128 v[212:215], v15 offset:23552
  v_mfma_f32_16x16x32_bf16 v[144:147], v[192:195], v[172:175], v[144:147]
  ds_read_b64_tr_b16 v[228:229], v235 offset:16384
  v_mfma_f32_16x16x32_bf16 v[148:151], v[196:199], v[172:175], v[148:151]
  ds_read_b64_tr_b16 v[230:231], v235 offset:18432
  v_mfma_f32_16x16x32_bf16 v[152:155], v[192:195], v[176:179], v[152:155]
  v_mfma_f32_16x16x32_bf16 v[156:159], v[196:199], v[176:179], v[156:159]
  v_mfma_f32_16x16x32_bf16 v[160:163], v[192:195], v[180:183], v[160:163]
  v_mfma_f32_16x16x32_bf16 v[164:167], v[196:199], v[180:183], v[164:167]
  s_waitcnt lgkmcnt(0)
  s_barrier
  v_mfma_f32_16x16x32_bf16 v[104:107], v[216:219], v[200:203], v[104:107]
  ds_read_b128 v[168:171], v15 offset:24576
  v_mfma_f32_16x16x32_bf16 v[108:111], v[220:223], v[200:203], v[108:111]
  ds_read_b64_tr_b16 v[184:185], v232 offset:32768
  v_mfma_f32_16x16x32_bf16 v[112:115], v[216:219], v[204:207], v[112:115]
  ds_read_b64_tr_b16 v[186:187], v232 offset:34816
  v_mfma_f32_16x16x32_bf16 v[116:119], v[220:223], v[204:207], v[116:119]
  ds_read_b128 v[172:175], v15 offset:25600
  v_mfma_f32_16x16x32_bf16 v[120:123], v[216:219], v[208:211], v[120:123]
  ds_read_b64_tr_b16 v[188:189], v233 offset:32768
  v_mfma_f32_16x16x32_bf16 v[124:127], v[220:223], v[208:211], v[124:127]
  ds_read_b64_tr_b16 v[190:191], v233 offset:34816
  v_mfma_f32_16x16x32_bf16 v[128:131], v[216:219], v[212:215], v[128:131]
  ds_read_b128 v[176:179], v15 offset:26624
  v_mfma_f32_16x16x32_bf16 v[132:135], v[220:223], v[212:215], v[132:135]
  ds_read_b64_tr_b16 v[192:193], v234 offset:32768
  v_mfma_f32_16x16x32_bf16 v[136:139], v[224:227], v[200:203], v[136:139]
  ds_read_b64_tr_b16 v[194:195], v234 offset:34816
  v_mfma_f32_16x16x32_bf16 v[140:143], v[228:231], v[200:203], v[140:143]
  ds_read_b128 v[180:183], v15 offset:27648
  v_mfma_f32_16x16x32_bf16 v[144:147], v[224:227], v[204:207], v[144:147]
  ds_read_b64_tr_b16 v[196:197], v235 offset:32768
  v_mfma_f32_16x16x32_bf16 v[148:151], v[228:231], v[204:207], v[148:151]
  ds_read_b64_tr_b16 v[198:199], v235 offset:34816
  v_mfma_f32_16x16x32_bf16 v[152:155], v[224:227], v[208:211], v[152:155]
  v_mfma_f32_16x16x32_bf16 v[156:159], v[228:231], v[208:211], v[156:159]
  v_mfma_f32_16x16x32_bf16 v[160:163], v[224:227], v[212:215], v[160:163]
  v_mfma_f32_16x16x32_bf16 v[164:167], v[228:231], v[212:215], v[164:167]
  s_cmp_eq_u32 s5, 0
  s_cbranch_scc0 L_pf249
  s_lshl_b32 s36, s6, 2
  s_add_u32 s36, s36, s4
  s_mul_i32 s36, s36, 73728
  s_add_u32 s36, s36, 512
  v_lshrrev_b32 v2, 2, v1
  v_and_b32 v3, 3, v1
  v_lshlrev_b32 v3, 7, v3
  v_lshl_add_u32 v2, v2, 13, v3
  s_mov_b32 exec_hi, 15
  buffer_load_dword v0, v2, s[56:59], s36 offen
  buffer_load_dword v0, v2, s[20:23], s36 offen
  s_mov_b32 exec_hi, -1
L_pf249:
  s_waitcnt lgkmcnt(0)
  s_barrier
  v_mfma_f32_16x16x32_bf16 v[104:107], v[184:187], v[168:171], v[104:107]
  ds_read_b128 v[200:203], v15 offset:28672
  v_mfma_f32_16x16x32_bf16 v[108:111], v[188:191], v[168:171], v[108:111]
  ds_read_b64_tr_b16 v[216:217], v232 offset:49152
  v_mfma_f32_16x16x32_bf16 v[112:115], v[184:187], v[172:175], v[112:115]
  ds_read_b64_tr_b16 v[218:219], v232 offset:51200
  v_mfma_f32_16x16x32_bf16 v[116:119], v[188:191], v[172:175], v[116:119]
  ds_read_b128 v[204:207], v15 offset:29696
  v_mfma_f32_16x16x32_bf16 v[120:123], v[184:187], v[176:179], v[120:123]
  ds_read_b64_tr_b16 v[220:221], v233 offset:49152
  v_mfma_f32_16x16x32_bf16 v[124:127], v[188:191], v[176:179], v[124:127]
  ds_read_b64_tr_b16 v[222:223], v233 offset:51200
  v_mfma_f32_16x16x32_bf16 v[128:131], v[184:187], v[180:183], v[128:131]
  ds_read_b128 v[208:211], v15 offset:30720
  v_mfma_f32_16x16x32_bf16 v[132:135], v[188:191], v[180:183], v[132:135]
  ds_read_b64_tr_b16 v[224:225], v234 offset:49152
  v_mfma_f32_16x16x32_bf16 v[136:139], v[192:195], v[168:171], v[136:139]
  ds_read_b64_tr_b16 v[226:227], v234 offset:51200
  v_mfma_f32_16x16x32_bf16 v[140:143], v[196:199], v[168:171], v[140:143]
  ds_read_b128 v[212:215], v15 offset:31744
  v_mfma_f32_16x16x32_bf16 v[144:147], v[192:195], v[172:175], v[144:147]
  ds_read_b64_tr_b16 v[228:229], v235 offset:49152
  v_mfma_f32_16x16x32_bf16 v[148:151], v[196:199], v[172:175], v[148:151]
  ds_read_b64_tr_b16 v[230:231], v235 offset:51200
  v_mfma_f32_16x16x32_bf16 v[152:155], v[192:195], v[176:179], v[152:155]
  s_waitcnt vmcnt(9)
  ds_write_b128 v14, v[64:67] offset:0
  s_waitcnt vmcnt(8)
  ds_write_b128 v14, v[68:71] offset:4096
  s_waitcnt vmcnt(7)
  ds_write_b128 v14, v[72:75] offset:8192
  s_waitcnt vmcnt(6)
  ds_write_b128 v14, v[76:79] offset:12288
  s_waitcnt vmcnt(5)
  ds_write_b128 v14, v[80:83] offset:16384
  s_waitcnt vmcnt(4)
  ds_write_b128 v14, v[84:87] offset:20480
  s_waitcnt vmcnt(3)
  ds_write_b128 v14, v[88:91] offset:24576
  v_mfma_f32_16x16x32_bf16 v[156:159], v[196:199], v[176:179], v[156:159]
  v_mfma_f32_16x16x32_bf16 v[160:163], v[192:195], v[180:183], v[160:163]
  v_mfma_f32_16x16x32_bf16 v[164:167], v[196:199], v[180:183], v[164:167]
  s_waitcnt lgkmcnt(6)
  s_barrier
  v_mfma_f32_16x16x32_bf16 v[104:107], v[216:219], v[200:203], v[104:107]
  ds_read_b128 v[168:171], v15 offset:0
  v_mfma_f32_16x16x32_bf16 v[108:111], v[220:223], v[200:203], v[108:111]
  ds_read_b64_tr_b16 v[184:185], v16 offset:0
  v_mfma_f32_16x16x32_bf16 v[112:115], v[216:219], v[204:207], v[112:115]
  ds_read_b64_tr_b16 v[186:187], v16 offset:2048
  v_mfma_f32_16x16x32_bf16 v[116:119], v[220:223], v[204:207], v[116:119]
  ds_read_b128 v[172:175], v15 offset:1024
  v_mfma_f32_16x16x32_bf16 v[120:123], v[216:219], v[208:211], v[120:123]
  ds_read_b64_tr_b16 v[188:189], v17 offset:0
  v_mfma_f32_16x16x32_bf16 v[124:127], v[220:223], v[208:211], v[124:127]
  ds_read_b64_tr_b16 v[190:191], v17 offset:2048
  v_mfma_f32_16x16x32_bf16 v[128:131], v[216:219], v[212:215], v[128:131]
  ds_read_b128 v[176:179], v15 offset:2048
  v_mfma_f32_16x16x32_bf16 v[132:135], v[220:223], v[212:215], v[132:135]
  ds_read_b64_tr_b16 v[192:193], v18 offset:0
  v_mfma_f32_16x16x32_bf16 v[136:139], v[224:227], v[200:203], v[136:139]
  ds_read_b64_tr_b16 v[194:195], v18 offset:2048
  v_mfma_f32_16x16x32_bf16 v[140:143], v[228:231], v[200:203], v[140:143]
  ds_read_b128 v[180:183], v15 offset:3072
  v_mfma_f32_16x16x32_bf16 v[144:147], v[224:227], v[204:207], v[144:147]
  ds_read_b64_tr_b16 v[196:197], v19 offset:0
  v_mfma_f32_16x16x32_bf16 v[148:151], v[228:231], v[204:207], v[148:151]
  ds_read_b64_tr_b16 v[198:199], v19 offset:2048
  v_mfma_f32_16x16x32_bf16 v[152:155], v[224:227], v[208:211], v[152:155]
  v_mfma_f32_16x16x32_bf16 v[156:159], v[228:231], v[208:211], v[156:159]
  v_mfma_f32_16x16x32_bf16 v[160:163], v[224:227], v[212:215], v[160:163]
  v_mfma_f32_16x16x32_bf16 v[164:167], v[228:231], v[212:215], v[164:167]
  s_waitcnt lgkmcnt(0)
  s_barrier
  v_mfma_f32_16x16x32_bf16 v[104:107], v[184:187], v[168:171], v[104:107]
  ds_read_b128 v[200:203], v15 offset:4096
  v_mfma_f32_16x16x32_bf16 v[108:111], v[188:191], v[168:171], v[108:111]
  ds_read_b64_tr_b16 v[216:217], v16 offset:16384
  v_mfma_f32_16x16x32_bf16 v[112:115], v[184:187], v[172:175], v[112:115]
  ds_read_b64_tr_b16 v[218:219], v16 offset:18432
  v_mfma_f32_16x16x32_bf16 v[116:119], v[188:191], v[172:175], v[116:119]
  ds_read_b128 v[204:207], v15 offset:5120
  v_mfma_f32_16x16x32_bf16 v[120:123], v[184:187], v[176:179], v[120:123]
  ds_read_b64_tr_b16 v[220:221], v17 offset:16384
  v_mfma_f32_16x16x32_bf16 v[124:127], v[188:191], v[176:179], v[124:127]
  ds_read_b64_tr_b16 v[222:223], v17 offset:18432
  v_mfma_f32_16x16x32_bf16 v[128:131], v[184:187], v[180:183], v[128:131]
  ds_read_b128 v[208:211], v15 offset:6144
  v_mfma_f32_16x16x32_bf16 v[132:135], v[188:191], v[180:183], v[132:135]
  ds_read_b64_tr_b16 v[224:225], v18 offset:16384
  v_mfma_f32_16x16x32_bf16 v[136:139], v[192:195], v[168:171], v[136:139]
  ds_read_b64_tr_b16 v[226:227], v18 offset:18432
  v_mfma_f32_16x16x32_bf16 v[140:143], v[196:199], v[168:171], v[140:143]
  ds_read_b128 v[212:215], v15 offset:7168
  v_mfma_f32_16x16x32_bf16 v[144:147], v[192:195], v[172:175], v[144:147]
  ds_read_b64_tr_b16 v[228:229], v19 offset:16384
  v_mfma_f32_16x16x32_bf16 v[148:151], v[196:199], v[172:175], v[148:151]
  ds_read_b64_tr_b16 v[230:231], v19 offset:18432
  v_mfma_f32_16x16x32_bf16 v[152:155], v[192:195], v[176:179], v[152:155]
  v_mfma_f32_16x16x32_bf16 v[156:159], v[196:199], v[176:179], v[156:159]
  v_mfma_f32_16x16x32_bf16 v[160:163], v[192:195], v[180:183], v[160:163]
  v_mfma_f32_16x16x32_bf16 v[164:167], v[196:199], v[180:183], v[164:167]
  s_waitcnt lgkmcnt(0)
  s_barrier
  v_mfma_f32_16x16x32_bf16 v[104:107], v[216:219], v[200:203], v[104:107]
  ds_read_b128 v[168:171], v15 offset:8192
  v_mfma_f32_16x16x32_bf16 v[108:111], v[220:223], v[200:203], v[108:111]
  ds_read_b64_tr_b16 v[184:185], v16 offset:32768
  v_mfma_f32_16x16x32_bf16 v[112:115], v[216:219], v[204:207], v[112:115]
  ds_read_b64_tr_b16 v[186:187], v16 offset:34816
  v_mfma_f32_16x16x32_bf16 v[116:119], v[220:223], v[204:207], v[116:119]
  ds_read_b128 v[172:175], v15 offset:9216
  v_mfma_f32_16x16x32_bf16 v[120:123], v[216:219], v[208:211], v[120:123]
  ds_read_b64_tr_b16 v[188:189], v17 offset:32768
  v_mfma_f32_16x16x32_bf16 v[124:127], v[220:223], v[208:211], v[124:127]
  ds_read_b64_tr_b16 v[190:191], v17 offset:34816
  v_mfma_f32_16x16x32_bf16 v[128:131], v[216:219], v[212:215], v[128:131]
  ds_read_b128 v[176:179], v15 offset:10240
  v_mfma_f32_16x16x32_bf16 v[132:135], v[220:223], v[212:215], v[132:135]
  ds_read_b64_tr_b16 v[192:193], v18 offset:32768
  v_mfma_f32_16x16x32_bf16 v[136:139], v[224:227], v[200:203], v[136:139]
  ds_read_b64_tr_b16 v[194:195], v18 offset:34816
  v_mfma_f32_16x16x32_bf16 v[140:143], v[228:231], v[200:203], v[140:143]
  ds_read_b128 v[180:183], v15 offset:11264
  v_mfma_f32_16x16x32_bf16 v[144:147], v[224:227], v[204:207], v[144:147]
  ds_read_b64_tr_b16 v[196:197], v19 offset:32768
  v_mfma_f32_16x16x32_bf16 v[148:151], v[228:231], v[204:207], v[148:151]
  ds_read_b64_tr_b16 v[198:199], v19 offset:34816
  v_mfma_f32_16x16x32_bf16 v[152:155], v[224:227], v[208:211], v[152:155]
  s_waitcnt vmcnt(2)
  ds_write_b128 v14, v[92:95] offset:28672
  s_waitcnt vmcnt(1)
  ds_write_b128 v14, v[96:99] offset:0
  s_waitcnt vmcnt(0)
  ds_write_b128 v14, v[100:103] offset:4096
  v_mfma_f32_16x16x32_bf16 v[156:159], v[228:231], v[208:211], v[156:159]
  v_mfma_f32_16x16x32_bf16 v[160:163], v[224:227], v[212:215], v[160:163]
  v_mfma_f32_16x16x32_bf16 v[164:167], v[228:231], v[212:215], v[164:167]
  s_waitcnt lgkmcnt(3)
  s_barrier
  v_mfma_f32_16x16x32_bf16 v[104:107], v[184:187], v[168:171], v[104:107]
  ds_read_b128 v[200:203], v15 offset:12288
  v_mfma_f32_16x16x32_bf16 v[108:111], v[188:191], v[168:171], v[108:111]
  ds_read_b64_tr_b16 v[216:217], v16 offset:49152
  v_mfma_f32_16x16x32_bf16 v[112:115], v[184:187], v[172:175], v[112:115]
  ds_read_b64_tr_b16 v[218:219], v16 offset:51200
  v_mfma_f32_16x16x32_bf16 v[116:119], v[188:191], v[172:175], v[116:119]
  ds_read_b128 v[204:207], v15 offset:13312
  v_mfma_f32_16x16x32_bf16 v[120:123], v[184:187], v[176:179], v[120:123]
  ds_read_b64_tr_b16 v[220:221], v17 offset:49152
  v_mfma_f32_16x16x32_bf16 v[124:127], v[188:191], v[176:179], v[124:127]
  ds_read_b64_tr_b16 v[222:223], v17 offset:51200
  v_mfma_f32_16x16x32_bf16 v[128:131], v[184:187], v[180:183], v[128:131]
  ds_read_b128 v[208:211], v15 offset:14336
  v_mfma_f32_16x16x32_bf16 v[132:135], v[188:191], v[180:183], v[132:135]
  ds_read_b64_tr_b16 v[224:225], v18 offset:49152
  v_mfma_f32_16x16x32_bf16 v[136:139], v[192:195], v[168:171], v[136:139]
  ds_read_b64_tr_b16 v[226:227], v18 offset:51200
  v_mfma_f32_16x16x32_bf16 v[140:143], v[196:199], v[168:171], v[140:143]
  ds_read_b128 v[212:215], v15 offset:15360
  v_mfma_f32_16x16x32_bf16 v[144:147], v[192:195], v[172:175], v[144:147]
  ds_read_b64_tr_b16 v[228:229], v19 offset:49152
  v_mfma_f32_16x16x32_bf16 v[148:151], v[196:199], v[172:175], v[148:151]
  ds_read_b64_tr_b16 v[230:231], v19 offset:51200
  v_mfma_f32_16x16x32_bf16 v[152:155], v[192:195], v[176:179], v[152:155]
  v_mfma_f32_16x16x32_bf16 v[156:159], v[196:199], v[176:179], v[156:159]
  v_mfma_f32_16x16x32_bf16 v[160:163], v[192:195], v[180:183], v[160:163]
  v_mfma_f32_16x16x32_bf16 v[164:167], v[196:199], v[180:183], v[164:167]
  s_waitcnt lgkmcnt(0)
  s_barrier
  v_mfma_f32_16x16x32_bf16 v[104:107], v[216:219], v[200:203], v[104:107]
  ds_read_b128 v[168:171], v15 offset:16384
  v_mfma_f32_16x16x32_bf16 v[108:111], v[220:223], v[200:203], v[108:111]
  ds_read_b64_tr_b16 v[184:185], v232 offset:32768
  v_mfma_f32_16x16x32_bf16 v[112:115], v[216:219], v[204:207], v[112:115]
  ds_read_b64_tr_b16 v[186:187], v232 offset:34816
  v_mfma_f32_16x16x32_bf16 v[116:119], v[220:223], v[204:207], v[116:119]
  ds_read_b128 v[172:175], v15 offset:17408
  v_mfma_f32_16x16x32_bf16 v[120:123], v[216:219], v[208:211], v[120:123]
  ds_read_b64_tr_b16 v[188:189], v233 offset:32768
  v_mfma_f32_16x16x32_bf16 v[124:127], v[220:223], v[208:211], v[124:127]
  ds_read_b64_tr_b16 v[190:191], v233 offset:34816
  v_mfma_f32_16x16x32_bf16 v[128:131], v[216:219], v[212:215], v[128:131]
  ds_read_b128 v[176:179], v15 offset:18432
  v_mfma_f32_16x16x32_bf16 v[132:135], v[220:223], v[212:215], v[132:135]
  ds_read_b64_tr_b16 v[192:193], v234 offset:32768
  v_mfma_f32_16x16x32_bf16 v[136:139], v[224:227], v[200:203], v[136:139]
  ds_read_b64_tr_b16 v[194:195], v234 offset:34816
  v_mfma_f32_16x16x32_bf16 v[140:143], v[228:231], v[200:203], v[140:143]
  ds_read_b128 v[180:183], v15 offset:19456
  v_mfma_f32_16x16x32_bf16 v[144:147], v[224:227], v[204:207], v[144:147]
  ds_read_b64_tr_b16 v[196:197], v235 offset:32768
  v_mfma_f32_16x16x32_bf16 v[148:151], v[228:231], v[204:207], v[148:151]
  ds_read_b64_tr_b16 v[198:199], v235 offset:34816
  v_mfma_f32_16x16x32_bf16 v[152:155], v[224:227], v[208:211], v[152:155]
  v_mfma_f32_16x16x32_bf16 v[156:159], v[228:231], v[208:211], v[156:159]
  v_mfma_f32_16x16x32_bf16 v[160:163], v[224:227], v[212:215], v[160:163]
  v_mfma_f32_16x16x32_bf16 v[164:167], v[228:231], v[212:215], v[164:167]
  s_waitcnt lgkmcnt(0)
  s_barrier
  v_mfma_f32_16x16x32_bf16 v[104:107], v[184:187], v[168:171], v[104:107]
  ds_read_b128 v[200:203], v15 offset:20480
  v_mfma_f32_16x16x32_bf16 v[108:111], v[188:191], v[168:171], v[108:111]
  ds_read_b64_tr_b16 v[216:217], v232 offset:49152
  v_mfma_f32_16x16x32_bf16 v[112:115], v[184:187], v[172:175], v[112:115]
  ds_read_b64_tr_b16 v[218:219], v232 offset:51200
  v_mfma_f32_16x16x32_bf16 v[116:119], v[188:191], v[172:175], v[116:119]
  ds_read_b128 v[204:207], v15 offset:21504
  v_mfma_f32_16x16x32_bf16 v[120:123], v[184:187], v[176:179], v[120:123]
  ds_read_b64_tr_b16 v[220:221], v233 offset:49152
  v_mfma_f32_16x16x32_bf16 v[124:127], v[188:191], v[176:179], v[124:127]
  ds_read_b64_tr_b16 v[222:223], v233 offset:51200
  v_mfma_f32_16x16x32_bf16 v[128:131], v[184:187], v[180:183], v[128:131]
  ds_read_b128 v[208:211], v15 offset:22528
  v_mfma_f32_16x16x32_bf16 v[132:135], v[188:191], v[180:183], v[132:135]
  ds_read_b64_tr_b16 v[224:225], v234 offset:49152
  v_mfma_f32_16x16x32_bf16 v[136:139], v[192:195], v[168:171], v[136:139]
  ds_read_b64_tr_b16 v[226:227], v234 offset:51200
  v_mfma_f32_16x16x32_bf16 v[140:143], v[196:199], v[168:171], v[140:143]
  ds_read_b128 v[212:215], v15 offset:23552
  v_mfma_f32_16x16x32_bf16 v[144:147], v[192:195], v[172:175], v[144:147]
  ds_read_b64_tr_b16 v[228:229], v235 offset:49152
  v_mfma_f32_16x16x32_bf16 v[148:151], v[196:199], v[172:175], v[148:151]
  ds_read_b64_tr_b16 v[230:231], v235 offset:51200
  v_mfma_f32_16x16x32_bf16 v[152:155], v[192:195], v[176:179], v[152:155]
  v_mfma_f32_16x16x32_bf16 v[156:159], v[196:199], v[176:179], v[156:159]
  v_mfma_f32_16x16x32_bf16 v[160:163], v[192:195], v[180:183], v[160:163]
  v_mfma_f32_16x16x32_bf16 v[164:167], v[196:199], v[180:183], v[164:167]
  s_lshr_b32 s36, s4, 1
  s_mul_i32 s46, s36, 16384
  s_add_u32 s46, s46, s69
  s_lshl_b32 s36, s36, 17
  s_and_b32 s37, s4, 1
  s_lshl_b32 s37, s37, 12
  s_add_u32 s36, s36, s37
  v_lshl_add_u32 v23, v1, 7, s36
  s_cmp_eq_u32 s5, 0
  s_cbranch_scc0 L_x250
  s_add_u32 s36, s46, 32768
  s_and_b32 s36, s36, 0x1ffff
  s_mov_b32 exec_hi, 0
  buffer_load_dword v0, v23, s[52:55], s36 offen
  s_mov_b32 exec_hi, -1
L_x250:
  s_waitcnt lgkmcnt(0)
  s_barrier
  v_mfma_f32_16x16x32_bf16 v[104:107], v[216:219], v[200:203], v[104:107]
  ds_read_b128 v[168:171], v15 offset:24576
  v_mfma_f32_16x16x32_bf16 v[108:111], v[220:223], v[200:203], v[108:111]
  ds_read_b64_tr_b16 v[184:185], v16 offset:0
  v_mfma_f32_16x16x32_bf16 v[112:115], v[216:219], v[204:207], v[112:115]
  ds_read_b64_tr_b16 v[186:187], v16 offset:2048
  v_mfma_f32_16x16x32_bf16 v[116:119], v[220:223], v[204:207], v[116:119]
  ds_read_b128 v[172:175], v15 offset:25600
  v_mfma_f32_16x16x32_bf16 v[120:123], v[216:219], v[208:211], v[120:123]
  ds_read_b64_tr_b16 v[188:189], v17 offset:0
  v_mfma_f32_16x16x32_bf16 v[124:127], v[220:223], v[208:211], v[124:127]
  ds_read_b64_tr_b16 v[190:191], v17 offset:2048
  v_mfma_f32_16x16x32_bf16 v[128:131], v[216:219], v[212:215], v[128:131]
  ds_read_b128 v[176:179], v15 offset:26624
  v_mfma_f32_16x16x32_bf16 v[132:135], v[220:223], v[212:215], v[132:135]
  ds_read_b64_tr_b16 v[192:193], v18 offset:0
  v_mfma_f32_16x16x32_bf16 v[136:139], v[224:227], v[200:203], v[136:139]
  ds_read_b64_tr_b16 v[194:195], v18 offset:2048
  v_mfma_f32_16x16x32_bf16 v[140:143], v[228:231], v[200:203], v[140:143]
  ds_read_b128 v[180:183], v15 offset:27648
  v_mfma_f32_16x16x32_bf16 v[144:147], v[224:227], v[204:207], v[144:147]
  ds_read_b64_tr_b16 v[196:197], v19 offset:0
  v_mfma_f32_16x16x32_bf16 v[148:151], v[228:231], v[204:207], v[148:151]
  ds_read_b64_tr_b16 v[198:199], v19 offset:2048
  v_mfma_f32_16x16x32_bf16 v[152:155], v[224:227], v[208:211], v[152:155]
  v_mfma_f32_16x16x32_bf16 v[156:159], v[228:231], v[208:211], v[156:159]
  v_mfma_f32_16x16x32_bf16 v[160:163], v[224:227], v[212:215], v[160:163]
  v_mfma_f32_16x16x32_bf16 v[164:167], v[228:231], v[212:215], v[164:167]
  s_waitcnt lgkmcnt(0)
  s_barrier
  v_mfma_f32_16x16x32_bf16 v[104:107], v[184:187], v[168:171], v[104:107]
  ds_read_b128 v[200:203], v15 offset:28672
  v_mfma_f32_16x16x32_bf16 v[108:111], v[188:191], v[168:171], v[108:111]
  ds_read_b64_tr_b16 v[216:217], v16 offset:16384
  v_mfma_f32_16x16x32_bf16 v[112:115], v[184:187], v[172:175], v[112:115]
  ds_read_b64_tr_b16 v[218:219], v16 offset:18432
  v_mfma_f32_16x16x32_bf16 v[116:119], v[188:191], v[172:175], v[116:119]
  ds_read_b128 v[204:207], v15 offset:29696
  v_mfma_f32_16x16x32_bf16 v[120:123], v[184:187], v[176:179], v[120:123]
  ds_read_b64_tr_b16 v[220:221], v17 offset:16384
  v_mfma_f32_16x16x32_bf16 v[124:127], v[188:191], v[176:179], v[124:127]
  ds_read_b64_tr_b16 v[222:223], v17 offset:18432
  v_mfma_f32_16x16x32_bf16 v[128:131], v[184:187], v[180:183], v[128:131]
  ds_read_b128 v[208:211], v15 offset:30720
  v_mfma_f32_16x16x32_bf16 v[132:135], v[188:191], v[180:183], v[132:135]
  ds_read_b64_tr_b16 v[224:225], v18 offset:16384
  v_mfma_f32_16x16x32_bf16 v[136:139], v[192:195], v[168:171], v[136:139]
  ds_read_b64_tr_b16 v[226:227], v18 offset:18432
  v_mfma_f32_16x16x32_bf16 v[140:143], v[196:199], v[168:171], v[140:143]
  ds_read_b128 v[212:215], v15 offset:31744
  v_mfma_f32_16x16x32_bf16 v[144:147], v[192:195], v[172:175], v[144:147]
  ds_read_b64_tr_b16 v[228:229], v19 offset:16384
  v_mfma_f32_16x16x32_bf16 v[148:151], v[196:199], v[172:175], v[148:151]
  ds_read_b64_tr_b16 v[230:231], v19 offset:18432
  v_mfma_f32_16x16x32_bf16 v[152:155], v[192:195], v[176:179], v[152:155]
  v_mfma_f32_16x16x32_bf16 v[156:159], v[196:199], v[176:179], v[156:159]
  v_mfma_f32_16x16x32_bf16 v[160:163], v[192:195], v[180:183], v[160:163]
  v_mfma_f32_16x16x32_bf16 v[164:167], v[196:199], v[180:183], v[164:167]
  s_waitcnt lgkmcnt(0)
  s_barrier
  v_mfma_f32_16x16x32_bf16 v[104:107], v[216:219], v[200:203], v[104:107]
  ds_read_b128 v[168:171], v15 offset:0
  v_mfma_f32_16x16x32_bf16 v[108:111], v[220:223], v[200:203], v[108:111]
  ds_read_b64_tr_b16 v[184:185], v16 offset:32768
  v_mfma_f32_16x16x32_bf16 v[112:115], v[216:219], v[204:207], v[112:115]
  ds_read_b64_tr_b16 v[186:187], v16 offset:34816
  v_mfma_f32_16x16x32_bf16 v[116:119], v[220:223], v[204:207], v[116:119]
  ds_read_b128 v[172:175], v15 offset:1024
  v_mfma_f32_16x16x32_bf16 v[120:123], v[216:219], v[208:211], v[120:123]
  ds_read_b64_tr_b16 v[188:189], v17 offset:32768
  v_mfma_f32_16x16x32_bf16 v[124:127], v[220:223], v[208:211], v[124:127]
  ds_read_b64_tr_b16 v[190:191], v17 offset:34816
  v_mfma_f32_16x16x32_bf16 v[128:131], v[216:219], v[212:215], v[128:131]
  ds_read_b128 v[176:179], v15 offset:2048
  v_mfma_f32_16x16x32_bf16 v[132:135], v[220:223], v[212:215], v[132:135]
  ds_read_b64_tr_b16 v[192:193], v18 offset:32768
  v_mfma_f32_16x16x32_bf16 v[136:139], v[224:227], v[200:203], v[136:139]
  ds_read_b64_tr_b16 v[194:195], v18 offset:34816
  v_mfma_f32_16x16x32_bf16 v[140:143], v[228:231], v[200:203], v[140:143]
  ds_read_b128 v[180:183], v15 offset:3072
  v_mfma_f32_16x16x32_bf16 v[144:147], v[224:227], v[204:207], v[144:147]
  ds_read_b64_tr_b16 v[196:197], v19 offset:32768
  v_mfma_f32_16x16x32_bf16 v[148:151], v[228:231], v[204:207], v[148:151]
  ds_read_b64_tr_b16 v[198:199], v19 offset:34816
  v_mfma_f32_16x16x32_bf16 v[152:155], v[224:227], v[208:211], v[152:155]
  v_mfma_f32_16x16x32_bf16 v[156:159], v[228:231], v[208:211], v[156:159]
  v_mfma_f32_16x16x32_bf16 v[160:163], v[224:227], v[212:215], v[160:163]
  v_mfma_f32_16x16x32_bf16 v[164:167], v[228:231], v[212:215], v[164:167]
  s_waitcnt lgkmcnt(0)
  s_barrier
  v_mfma_f32_16x16x32_bf16 v[104:107], v[184:187], v[168:171], v[104:107]
  ds_read_b128 v[200:203], v15 offset:4096
  v_mfma_f32_16x16x32_bf16 v[108:111], v[188:191], v[168:171], v[108:111]
  ds_read_b64_tr_b16 v[216:217], v16 offset:49152
  v_mfma_f32_16x16x32_bf16 v[112:115], v[184:187], v[172:175], v[112:115]
  ds_read_b64_tr_b16 v[218:219], v16 offset:51200
  v_mfma_f32_16x16x32_bf16 v[116:119], v[188:191], v[172:175], v[116:119]
  ds_read_b128 v[204:207], v15 offset:5120
  v_mfma_f32_16x16x32_bf16 v[120:123], v[184:187], v[176:179], v[120:123]
  ds_read_b64_tr_b16 v[220:221], v17 offset:49152
  v_mfma_f32_16x16x32_bf16 v[124:127], v[188:191], v[176:179], v[124:127]
  ds_read_b64_tr_b16 v[222:223], v17 offset:51200
  v_mfma_f32_16x16x32_bf16 v[128:131], v[184:187], v[180:183], v[128:131]
  ds_read_b128 v[208:211], v15 offset:6144
  v_mfma_f32_16x16x32_bf16 v[132:135], v[188:191], v[180:183], v[132:135]
  ds_read_b64_tr_b16 v[224:225], v18 offset:49152
  v_mfma_f32_16x16x32_bf16 v[136:139], v[192:195], v[168:171], v[136:139]
  ds_read_b64_tr_b16 v[226:227], v18 offset:51200
  v_mfma_f32_16x16x32_bf16 v[140:143], v[196:199], v[168:171], v[140:143]
  ds_read_b128 v[212:215], v15 offset:7168
  v_mfma_f32_16x16x32_bf16 v[144:147], v[192:195], v[172:175], v[144:147]
  ds_read_b64_tr_b16 v[228:229], v19 offset:49152
  v_mfma_f32_16x16x32_bf16 v[148:151], v[196:199], v[172:175], v[148:151]
  ds_read_b64_tr_b16 v[230:231], v19 offset:51200
  v_mfma_f32_16x16x32_bf16 v[152:155], v[192:195], v[176:179], v[152:155]
  v_mfma_f32_16x16x32_bf16 v[156:159], v[196:199], v[176:179], v[156:159]
  v_mfma_f32_16x16x32_bf16 v[160:163], v[192:195], v[180:183], v[160:163]
  v_mfma_f32_16x16x32_bf16 v[164:167], v[196:199], v[180:183], v[164:167]
  s_waitcnt lgkmcnt(0)
  s_barrier
  v_mfma_f32_16x16x32_bf16 v[104:107], v[216:219], v[200:203], v[104:107]
  v_mfma_f32_16x16x32_bf16 v[108:111], v[220:223], v[200:203], v[108:111]
  v_mfma_f32_16x16x32_bf16 v[112:115], v[216:219], v[204:207], v[112:115]
  v_mfma_f32_16x16x32_bf16 v[116:119], v[220:223], v[204:207], v[116:119]
  v_mfma_f32_16x16x32_bf16 v[120:123], v[216:219], v[208:211], v[120:123]
  v_mfma_f32_16x16x32_bf16 v[124:127], v[220:223], v[208:211], v[124:127]
  v_mfma_f32_16x16x32_bf16 v[128:131], v[216:219], v[212:215], v[128:131]
  v_mfma_f32_16x16x32_bf16 v[132:135], v[220:223], v[212:215], v[132:135]
  v_mfma_f32_16x16x32_bf16 v[136:139], v[224:227], v[200:203], v[136:139]
  v_mfma_f32_16x16x32_bf16 v[140:143], v[228:231], v[200:203], v[140:143]
  v_mul_f32 v104, s40, v104
  v_mul_f32 v105, s40, v105
  v_mfma_f32_16x16x32_bf16 v[144:147], v[224:227], v[204:207], v[144:147]
  v_mul_f32 v106, s40, v106
  v_mul_f32 v107, s40, v107
  v_mfma_f32_16x16x32_bf16 v[148:151], v[228:231], v[204:207], v[148:151]
  v_mul_f32 v108, s40, v108
  v_mul_f32 v109, s40, v109
  v_mfma_f32_16x16x32_bf16 v[152:155], v[224:227], v[208:211], v[152:155]
  v_mul_f32 v110, s40, v110
  v_mul_f32 v111, s40, v111
  v_mfma_f32_16x16x32_bf16 v[156:159], v[228:231], v[208:211], v[156:159]
  v_cvt_pk_bf16_f32 v104, v104, v105
  v_cvt_pk_bf16_f32 v105, v106, v107
  v_mfma_f32_16x16x32_bf16 v[160:163], v[224:227], v[212:215], v[160:163]
  v_cvt_pk_bf16_f32 v106, v108, v109
  v_cvt_pk_bf16_f32 v107, v110, v111
  v_mfma_f32_16x16x32_bf16 v[164:167], v[228:231], v[212:215], v[164:167]
  v_xor_b32 v2, 0, v20
  s_nop 0
  v_permlane16_swap_b32 v104, v106
  v_permlane16_swap_b32 v105, v107
  v_mul_f32 v112, s40, v112
  v_mul_f32 v113, s40, v113
  v_mul_f32 v114, s40, v114
  v_mul_f32 v115, s40, v115
  v_mul_f32 v116, s40, v116
  v_mul_f32 v117, s40, v117
  v_mul_f32 v118, s40, v118
  v_mul_f32 v119, s40, v119
  v_cvt_pk_bf16_f32 v112, v112, v113
  v_cvt_pk_bf16_f32 v113, v114, v115
  v_cvt_pk_bf16_f32 v114, v116, v117
  v_cvt_pk_bf16_f32 v115, v118, v119
  v_xor_b32 v3, 0, v20
  ds_write_b128 v2, v[104:107] offset:0
  v_permlane16_swap_b32 v112, v114
  v_permlane16_swap_b32 v113, v115
  v_mul_f32 v120, s40, v120
  v_mul_f32 v121, s40, v121
  v_mul_f32 v122, s40, v122
  v_mul_f32 v123, s40, v123
  v_mul_f32 v124, s40, v124
  v_mul_f32 v125, s40, v125
  v_mul_f32 v126, s40, v126
  v_mul_f32 v127, s40, v127
  v_cvt_pk_bf16_f32 v120, v120, v121
  v_cvt_pk_bf16_f32 v121, v122, v123
  v_cvt_pk_bf16_f32 v122, v124, v125
  v_cvt_pk_bf16_f32 v123, v126, v127
  v_xor_b32 v2, 0, v20
  ds_write_b128 v3, v[112:115] offset:4096
  v_permlane16_swap_b32 v120, v122
  v_permlane16_swap_b32 v121, v123
  v_mul_f32 v128, s40, v128
  v_mul_f32 v129, s40, v129
  v_mul_f32 v130, s40, v130
  v_mul_f32 v131, s40, v131
  v_mul_f32 v132, s40, v132
  v_mul_f32 v133, s40, v133
  v_mul_f32 v134, s40, v134
  v_mul_f32 v135, s40, v135
  v_cvt_pk_bf16_f32 v128, v128, v129
  v_cvt_pk_bf16_f32 v129, v130, v131
  v_cvt_pk_bf16_f32 v130, v132, v133
  v_cvt_pk_bf16_f32 v131, v134, v135
  v_xor_b32 v3, 0, v20
  ds_write_b128 v2, v[120:123] offset:8192
  v_permlane16_swap_b32 v128, v130
  v_permlane16_swap_b32 v129, v131
  v_mul_f32 v136, s40, v136
  v_mul_f32 v137, s40, v137
  v_mul_f32 v138, s40, v138
  v_mul_f32 v139, s40, v139
  v_mul_f32 v140, s40, v140
  v_mul_f32 v141, s40, v141
  v_mul_f32 v142, s40, v142
  v_mul_f32 v143, s40, v143
  v_cvt_pk_bf16_f32 v136, v136, v137
  v_cvt_pk_bf16_f32 v137, v138, v139
  v_cvt_pk_bf16_f32 v138, v140, v141
  v_cvt_pk_bf16_f32 v139, v142, v143
  v_xor_b32 v2, 64, v20
  ds_write_b128 v3, v[128:131] offset:12288
  v_permlane16_swap_b32 v136, v138
  v_permlane16_swap_b32 v137, v139
  v_mul_f32 v144, s40, v144
  v_mul_f32 v145, s40, v145
  v_mul_f32 v146, s40, v146
  v_mul_f32 v147, s40, v147
  v_mul_f32 v148, s40, v148
  v_mul_f32 v149, s40, v149
  v_mul_f32 v150, s40, v150
  v_mul_f32 v151, s40, v151
  v_cvt_pk_bf16_f32 v144, v144, v145
  v_cvt_pk_bf16_f32 v145, v146, v147
  v_cvt_pk_bf16_f32 v146, v148, v149
  v_cvt_pk_bf16_f32 v147, v150, v151
  v_xor_b32 v3, 64, v20
  ds_write_b128 v2, v[136:139] offset:0
  v_permlane16_swap_b32 v144, v146
  v_permlane16_swap_b32 v145, v147
  v_mul_f32 v152, s40, v152
  v_mul_f32 v153, s40, v153
  v_mul_f32 v154, s40, v154
  v_mul_f32 v155, s40, v155
  v_mul_f32 v156, s40, v156
  v_mul_f32 v157, s40, v157
  v_mul_f32 v158, s40, v158
  v_mul_f32 v159, s40, v159
  v_cvt_pk_bf16_f32 v152, v152, v153
  v_cvt_pk_bf16_f32 v153, v154, v155
  v_cvt_pk_bf16_f32 v154, v156, v157
  v_cvt_pk_bf16_f32 v155, v158, v159
  v_xor_b32 v2, 64, v20
  ds_write_b128 v3, v[144:147] offset:4096
  v_permlane16_swap_b32 v152, v154
  v_permlane16_swap_b32 v153, v155
  v_mul_f32 v160, s40, v160
  v_mul_f32 v161, s40, v161
  v_mul_f32 v162, s40, v162
  v_mul_f32 v163, s40, v163
  v_mul_f32 v164, s40, v164
  v_mul_f32 v165, s40, v165
  v_mul_f32 v166, s40, v166
  v_mul_f32 v167, s40, v167
  v_cvt_pk_bf16_f32 v160, v160, v161
  v_cvt_pk_bf16_f32 v161, v162, v163
  v_cvt_pk_bf16_f32 v162, v164, v165
  v_cvt_pk_bf16_f32 v163, v166, v167
  v_xor_b32 v3, 64, v20
  ds_write_b128 v2, v[152:155] offset:8192
  v_permlane16_swap_b32 v160, v162
  v_permlane16_swap_b32 v161, v163
  ds_write_b128 v3, v[160:163] offset:12288
  s_waitcnt lgkmcnt(0)
  s_barrier
  s_add_u32 m0, s44, 65536
  s_add_u32 s36, s42, s47
  buffer_load_dwordx4 v10, s[20:23], s36 offen offset:0  lds
  buffer_load_dwordx4 v11, s[20:23], s36 offen offset:1024  lds
  buffer_load_dwordx4 v12, s[20:23], s36 offen offset:2048  lds
  buffer_load_dwordx4 v13, s[20:23], s36 offen offset:3072  lds
  s_add_u32 s42, s42, 262144
  s_cmp_eq_u32 s42, 4718592
  s_cselect_b32 s42, 0, s42
  s_add_u32 m0, s44, 81920
  s_add_u32 s36, s42, s47
  buffer_load_dwordx4 v10, s[20:23], s36 offen offset:0  lds
  buffer_load_dwordx4 v11, s[20:23], s36 offen offset:1024  lds
  buffer_load_dwordx4 v12, s[20:23], s36 offen offset:2048  lds
  buffer_load_dwordx4 v13, s[20:23], s36 offen offset:3072  lds
  s_add_u32 s42, s42, 262144
  s_cmp_eq_u32 s42, 4718592
  s_cselect_b32 s42, 0, s42
  s_add_u32 m0, s44, 98304
  s_add_u32 s36, s42, s47
  buffer_load_dwordx4 v10, s[20:23], s36 offen offset:0  lds
  buffer_load_dwordx4 v11, s[20:23], s36 offen offset:1024  lds
  buffer_load_dwordx4 v12, s[20:23], s36 offen offset:2048  lds
  buffer_load_dwordx4 v13, s[20:23], s36 offen offset:3072  lds
  s_add_u32 s42, s42, 262144
  s_cmp_eq_u32 s42, 4718592
  s_cselect_b32 s42, 0, s42
  s_add_u32 s36, s69, 8192
  s_and_b32 s36, s36, 0x1ffff
  s_add_u32 m0, s49, 0
  s_nop 0
  buffer_load_dwordx4 v31, s[16:19], s36 offen offset:0 nt lds
  buffer_load_dwordx4 v22, s[16:19], s36 offen offset:1024 nt lds
  s_add_u32 s36, s69, 24576
  s_and_b32 s36, s36, 0x1ffff
  s_add_u32 m0, s49, 8192
  s_add_u32 s36, s36, 131072
  s_cmp_eq_u32 s5, 0
  s_cbranch_scc1 L_t251
  buffer_load_dwordx4 v31, s[16:19], s36 offen offset:0 nt lds
L_t251:
  s_cmp_eq_u32 s5, 0
  s_cbranch_scc1 L_t252
  buffer_load_dwordx4 v22, s[16:19], s36 offen offset:1024 nt lds
L_t252:
  s_cmp_eq_u32 s5, 0
  s_cbranch_scc0 L_x253
  s_add_u32 s36, s46, 49152
  s_and_b32 s36, s36, 0x1ffff
  s_mov_b32 exec_hi, 0
  buffer_load_dword v0, v23, s[52:55], s36 offen
  s_mov_b32 exec_hi, -1
L_x253:
  s_barrier
  ds_write_b128 v14, v[32:35] offset:0
  s_add_u32 s36, s69, 24576
  s_and_b32 s36, s36, 0x1ffff
  s_add_u32 m0, s49, 16384
  s_nop 0
  buffer_load_dwordx4 v29, s[12:15], s36 offen offset:0 nt lds
  buffer_load_dwordx4 v30, s[12:15], s36 offen offset:1024 nt lds
  s_add_u32 s36, s69, 40960
  s_and_b32 s36, s36, 0x1ffff
  s_add_u32 m0, s49, 24576
  s_add_u32 s36, s36, 131072
  s_cmp_eq_u32 s5, 0
  s_cbranch_scc1 L_t254
  buffer_load_dwordx4 v29, s[12:15], s36 offen offset:0 nt lds
L_t254:
  s_cmp_eq_u32 s5, 0
  s_cbranch_scc1 L_t255
  buffer_load_dwordx4 v30, s[12:15], s36 offen offset:1024 nt lds
L_t255:
  s_waitcnt lgkmcnt(0)
  s_waitcnt vmcnt(8)
  s_cmp_eq_u32 s5, 0
  s_cbranch_scc0 L_w256
  s_waitcnt vmcnt(5)
L_w256:
  s_barrier
  ds_read_b128 v[168:171], v15 offset:0
  ds_read_b64_tr_b16 v[184:185], v16 offset:0
  ds_read_b64_tr_b16 v[186:187], v16 offset:2048
  ds_read_b128 v[172:175], v15 offset:1024
  ds_read_b64_tr_b16 v[188:189], v17 offset:0
  ds_read_b64_tr_b16 v[190:191], v17 offset:2048
  ds_read_b128 v[176:179], v15 offset:2048
  ds_read_b64_tr_b16 v[192:193], v18 offset:0
  ds_read_b64_tr_b16 v[194:195], v18 offset:2048
  ds_read_b128 v[180:183], v15 offset:3072
  ds_read_b64_tr_b16 v[196:197], v19 offset:0
  ds_read_b64_tr_b16 v[198:199], v19 offset:2048
  ds_write_b128 v14, v[36:39] offset:4096
  s_add_u32 s36, s69, 16384
  s_and_b32 s36, s36, 0x1ffff
  s_add_u32 m0, s49, 32768
  s_nop 0
  buffer_load_dwordx4 v31, s[16:19], s36 offen offset:0 nt lds
  buffer_load_dwordx4 v22, s[16:19], s36 offen offset:1024 nt lds
  s_waitcnt lgkmcnt(10)
  v_mfma_f32_16x16x32_bf16 v[104:107], v[184:187], v[168:171], 0
  s_add_u32 s36, s69, 32768
  s_and_b32 s36, s36, 0x1ffff
  s_add_u32 m0, s49, 40960
  s_add_u32 s36, s36, 131072
  s_cmp_eq_u32 s5, 0
  s_cbranch_scc1 L_t257
  buffer_load_dwordx4 v31, s[16:19], s36 offen offset:0 nt lds
L_t257:
  s_waitcnt lgkmcnt(7)
  v_mfma_f32_16x16x32_bf16 v[112:115], v[184:187], v[172:175], 0
  v_mfma_f32_16x16x32_bf16 v[108:111], v[188:191], v[168:171], 0
  v_mfma_f32_16x16x32_bf16 v[116:119], v[188:191], v[172:175], 0
  s_waitcnt lgkmcnt(4)
  v_mfma_f32_16x16x32_bf16 v[120:123], v[184:187], v[176:179], 0
  s_cmp_eq_u32 s5, 0
  s_cbranch_scc1 L_t258
  buffer_load_dwordx4 v22, s[16:19], s36 offen offset:1024 nt lds
L_t258:
  v_mfma_f32_16x16x32_bf16 v[124:127], v[188:191], v[176:179], 0
  v_mfma_f32_16x16x32_bf16 v[136:139], v[192:195], v[168:171], 0
  v_mfma_f32_16x16x32_bf16 v[144:147], v[192:195], v[172:175], 0
  v_mfma_f32_16x16x32_bf16 v[152:155], v[192:195], v[176:179], 0
  s_waitcnt lgkmcnt(1)
  v_mfma_f32_16x16x32_bf16 v[128:131], v[184:187], v[180:183], 0
  v_mfma_f32_16x16x32_bf16 v[132:135], v[188:191], v[180:183], 0
  v_mfma_f32_16x16x32_bf16 v[160:163], v[192:195], v[180:183], 0
  v_mfma_f32_16x16x32_bf16 v[140:143], v[196:199], v[168:171], 0
  v_mfma_f32_16x16x32_bf16 v[148:151], v[196:199], v[172:175], 0
  v_mfma_f32_16x16x32_bf16 v[156:159], v[196:199], v[176:179], 0
  v_mfma_f32_16x16x32_bf16 v[164:167], v[196:199], v[180:183], 0
  s_waitcnt lgkmcnt(0)
  s_waitcnt vmcnt(8)
  s_cmp_eq_u32 s5, 0
  s_cbranch_scc0 L_w259
  s_waitcnt vmcnt(5)
L_w259:
  s_barrier
  ds_read_b128 v[168:171], v15 offset:4096
  ds_read_b64_tr_b16 v[184:185], v16 offset:16384
  ds_read_b64_tr_b16 v[186:187], v16 offset:18432
  ds_read_b128 v[172:175], v15 offset:5120
  ds_read_b64_tr_b16 v[188:189], v17 offset:16384
  ds_read_b64_tr_b16 v[190:191], v17 offset:18432
  ds_read_b128 v[176:179], v15 offset:6144
  ds_read_b64_tr_b16 v[192:193], v18 offset:16384
  ds_read_b64_tr_b16 v[194:195], v18 offset:18432
  ds_read_b128 v[180:183], v15 offset:7168
  ds_read_b64_tr_b16 v[196:197], v19 offset:16384
  ds_read_b64_tr_b16 v[198:199], v19 offset:18432
  s_add_u32 s36, s69, 32768
  s_and_b32 s36, s36, 0x1ffff
  s_add_u32 m0, s49, 49152
  s_nop 0
  buffer_load_dwordx4 v29, s[12:15], s36 offen offset:0 nt lds
  buffer_load_dwordx4 v30, s[12:15], s36 offen offset:1024 nt lds
  s_waitcnt lgkmcnt(9)
  v_mfma_f32_16x16x32_bf16 v[104:107], v[184:187], v[168:171], v[104:107]
  s_add_u32 s36, s69, 49152
  s_and_b32 s36, s36, 0x1ffff
  s_add_u32 m0, s49, 57344
  s_add_u32 s36, s36, 131072
  s_cmp_eq_u32 s5, 0
  s_cbranch_scc1 L_t260
  buffer_load_dwordx4 v29, s[12:15], s36 offen offset:0 nt lds
L_t260:
  s_waitcnt lgkmcnt(6)
  v_mfma_f32_16x16x32_bf16 v[112:115], v[184:187], v[172:175], v[112:115]
  v_mfma_f32_16x16x32_bf16 v[108:111], v[188:191], v[168:171], v[108:111]
  v_mfma_f32_16x16x32_bf16 v[116:119], v[188:191], v[172:175], v[116:119]
  s_waitcnt lgkmcnt(3)
  v_mfma_f32_16x16x32_bf16 v[120:123], v[184:187], v[176:179], v[120:123]
  s_cmp_eq_u32 s5, 0
  s_cbranch_scc1 L_t261
  buffer_load_dwordx4 v30, s[12:15], s36 offen offset:1024 nt lds
L_t261:
  v_mfma_f32_16x16x32_bf16 v[124:127], v[188:191], v[176:179], v[124:127]
  v_mfma_f32_16x16x32_bf16 v[136:139], v[192:195], v[168:171], v[136:139]
  v_mfma_f32_16x16x32_bf16 v[144:147], v[192:195], v[172:175], v[144:147]
  v_mfma_f32_16x16x32_bf16 v[152:155], v[192:195], v[176:179], v[152:155]
  s_waitcnt lgkmcnt(0)
  v_mfma_f32_16x16x32_bf16 v[128:131], v[184:187], v[180:183], v[128:131]
  v_mfma_f32_16x16x32_bf16 v[132:135], v[188:191], v[180:183], v[132:135]
  v_mfma_f32_16x16x32_bf16 v[160:163], v[192:195], v[180:183], v[160:163]
  v_mfma_f32_16x16x32_bf16 v[140:143], v[196:199], v[168:171], v[140:143]
  v_mfma_f32_16x16x32_bf16 v[148:151], v[196:199], v[172:175], v[148:151]
  v_mfma_f32_16x16x32_bf16 v[156:159], v[196:199], v[176:179], v[156:159]
  v_mfma_f32_16x16x32_bf16 v[164:167], v[196:199], v[180:183], v[164:167]
  s_waitcnt vmcnt(8)
  s_cmp_eq_u32 s5, 0
  s_cbranch_scc0 L_w262
  s_waitcnt vmcnt(4)
L_w262:
  s_barrier
  ds_write_b128 v14, v[40:43] offset:0
  s_add_u32 m0, s44, 114688
  s_add_u32 s36, s42, s47
  buffer_load_dwordx4 v10, s[20:23], s36 offen offset:0  lds
  buffer_load_dwordx4 v11, s[20:23], s36 offen offset:1024  lds
  buffer_load_dwordx4 v12, s[20:23], s36 offen offset:2048  lds
  buffer_load_dwordx4 v13, s[20:23], s36 offen offset:3072  lds
  s_add_u32 s42, s42, 262144
  s_cmp_eq_u32 s42, 4718592
  s_cselect_b32 s42, 0, s42
  s_add_u32 m0, s44, 65536
  s_add_u32 s36, s42, s47
  buffer_load_dwordx4 v10, s[20:23], s36 offen offset:0  lds
  buffer_load_dwordx4 v11, s[20:23], s36 offen offset:1024  lds
  buffer_load_dwordx4 v12, s[20:23], s36 offen offset:2048  lds
  buffer_load_dwordx4 v13, s[20:23], s36 offen offset:3072  lds
  s_add_u32 s42, s42, 262144
  s_cmp_eq_u32 s42, 4718592
  s_cselect_b32 s42, 0, s42
  s_add_u32 m0, s44, 81920
  s_add_u32 s36, s42, s47
  buffer_load_dwordx4 v10, s[20:23], s36 offen offset:0  lds
  buffer_load_dwordx4 v11, s[20:23], s36 offen offset:1024  lds
  buffer_load_dwordx4 v12, s[20:23], s36 offen offset:2048  lds
  buffer_load_dwordx4 v13, s[20:23], s36 offen offset:3072  lds
  s_add_u32 s42, s42, 262144
  s_cmp_eq_u32 s42, 4718592
  s_cselect_b32 s42, 0, s42
  s_add_u32 s36, s69, 24576
  s_and_b32 s36, s36, 0x1ffff
  s_add_u32 m0, s49, 0
  s_nop 0
  buffer_load_dwordx4 v31, s[16:19], s36 offen offset:0 nt lds
  buffer_load_dwordx4 v22, s[16:19], s36 offen offset:1024 nt lds
  s_add_u32 s36, s69, 40960
  s_and_b32 s36, s36, 0x1ffff
  s_add_u32 m0, s49, 8192
  s_add_u32 s36, s36, 131072
  s_cmp_eq_u32 s5, 0
  s_cbranch_scc1 L_t263
  buffer_load_dwordx4 v31, s[16:19], s36 offen offset:0 nt lds
L_t263:
  s_cmp_eq_u32 s5, 0
  s_cbranch_scc1 L_t264
  buffer_load_dwordx4 v22, s[16:19], s36 offen offset:1024 nt lds
L_t264:
  s_cmp_eq_u32 s5, 0
  s_cbranch_scc0 L_x265
  s_add_u32 s36, s46, 65536
  s_and_b32 s36, s36, 0x1ffff
  s_mov_b32 exec_hi, 0
  buffer_load_dword v0, v23, s[52:55], s36 offen
  s_mov_b32 exec_hi, -1
L_x265:
  s_waitcnt lgkmcnt(0)
  s_waitcnt vmcnt(20)
  s_cmp_eq_u32 s5, 0
  s_cbranch_scc0 L_w266
  s_waitcnt vmcnt(17)
L_w266:
  s_barrier
  ds_read_b128 v[168:171], v15 offset:0
  ds_read_b64_tr_b16 v[184:185], v16 offset:32768
  ds_read_b64_tr_b16 v[186:187], v16 offset:34816
  ds_read_b128 v[172:175], v15 offset:1024
  ds_read_b64_tr_b16 v[188:189], v17 offset:32768
  ds_read_b64_tr_b16 v[190:191], v17 offset:34816
  ds_read_b128 v[176:179], v15 offset:2048
  ds_read_b64_tr_b16 v[192:193], v18 offset:32768
  ds_read_b64_tr_b16 v[194:195], v18 offset:34816
  ds_read_b128 v[180:183], v15 offset:3072
  ds_read_b64_tr_b16 v[196:197], v19 offset:32768
  ds_read_b64_tr_b16 v[198:199], v19 offset:34816
  ds_write_b128 v14, v[44:47] offset:4096
  s_add_u32 s36, s69, 40960
  s_and_b32 s36, s36, 0x1ffff
  s_add_u32 m0, s49, 16384
  s_nop 0
  buffer_load_dwordx4 v29, s[12:15], s36 offen offset:0 nt lds
  buffer_load_dwordx4 v30, s[12:15], s36 offen offset:1024 nt lds
  s_waitcnt lgkmcnt(10)
  v_mfma_f32_16x16x32_bf16 v[104:107], v[184:187], v[168:171], v[104:107]
  s_add_u32 s36, s69, 57344
  s_and_b32 s36, s36, 0x1ffff
  s_add_u32 m0, s49, 24576
  s_add_u32 s36, s36, 131072
  s_cmp_eq_u32 s5, 0
  s_cbranch_scc1 L_t267
  buffer_load_dwordx4 v29, s[12:15], s36 offen offset:0 nt lds
L_t267:
  s_waitcnt lgkmcnt(7)
  v_mfma_f32_16x16x32_bf16 v[112:115], v[184:187], v[172:175], v[112:115]
  v_mfma_f32_16x16x32_bf16 v[108:111], v[188:191], v[168:171], v[108:111]
  v_mfma_f32_16x16x32_bf16 v[116:119], v[188:191], v[172:175], v[116:119]
  s_waitcnt lgkmcnt(4)
  v_mfma_f32_16x16x32_bf16 v[120:123], v[184:187], v[176:179], v[120:123]
  s_cmp_eq_u32 s5, 0
  s_cbranch_scc1 L_t268
  buffer_load_dwordx4 v30, s[12:15], s36 offen offset:1024 nt lds
L_t268:
  v_mfma_f32_16x16x32_bf16 v[124:127], v[188:191], v[176:179], v[124:127]
  v_mfma_f32_16x16x32_bf16 v[136:139], v[192:195], v[168:171], v[136:139]
  v_mfma_f32_16x16x32_bf16 v[144:147], v[192:195], v[172:175], v[144:147]
  v_mfma_f32_16x16x32_bf16 v[152:155], v[192:195], v[176:179], v[152:155]
  s_waitcnt lgkmcnt(1)
  v_mfma_f32_16x16x32_bf16 v[128:131], v[184:187], v[180:183], v[128:131]
  v_mfma_f32_16x16x32_bf16 v[132:135], v[188:191], v[180:183], v[132:135]
  v_mfma_f32_16x16x32_bf16 v[160:163], v[192:195], v[180:183], v[160:163]
  v_mfma_f32_16x16x32_bf16 v[140:143], v[196:199], v[168:171], v[140:143]
  v_mfma_f32_16x16x32_bf16 v[148:151], v[196:199], v[172:175], v[148:151]
  v_mfma_f32_16x16x32_bf16 v[156:159], v[196:199], v[176:179], v[156:159]
  v_mfma_f32_16x16x32_bf16 v[164:167], v[196:199], v[180:183], v[164:167]
  s_waitcnt lgkmcnt(0)
  s_waitcnt vmcnt(8)
  s_cmp_eq_u32 s5, 0
  s_cbranch_scc0 L_w269
  s_waitcnt vmcnt(5)
L_w269:
  s_barrier
  ds_read_b128 v[168:171], v15 offset:4096
  ds_read_b64_tr_b16 v[184:185], v16 offset:49152
  ds_read_b64_tr_b16 v[186:187], v16 offset:51200
  ds_read_b128 v[172:175], v15 offset:5120
  ds_read_b64_tr_b16 v[188:189], v17 offset:49152
  ds_read_b64_tr_b16 v[190:191], v17 offset:51200
  ds_read_b128 v[176:179], v15 offset:6144
  ds_read_b64_tr_b16 v[192:193], v18 offset:49152
  ds_read_b64_tr_b16 v[194:195], v18 offset:51200
  ds_read_b128 v[180:183], v15 offset:7168
  ds_read_b64_tr_b16 v[196:197], v19 offset:49152
  ds_read_b64_tr_b16 v[198:199], v19 offset:51200
  s_add_u32 s36, s69, 32768
  s_and_b32 s36, s36, 0x1ffff
  s_add_u32 m0, s49, 32768
  s_nop 0
  buffer_load_dwordx4 v31, s[16:19], s36 offen offset:0 nt lds
  buffer_load_dwordx4 v22, s[16:19], s36 offen offset:1024 nt lds
  s_waitcnt lgkmcnt(9)
  v_mfma_f32_16x16x32_bf16 v[104:107], v[184:187], v[168:171], v[104:107]
  s_add_u32 s36, s69, 49152
  s_and_b32 s36, s36, 0x1ffff
  s_add_u32 m0, s49, 40960
  s_add_u32 s36, s36, 131072
  s_cmp_eq_u32 s5, 0
  s_cbranch_scc1 L_t270
  buffer_load_dwordx4 v31, s[16:19], s36 offen offset:0 nt lds
L_t270:
  s_waitcnt lgkmcnt(6)
  v_mfma_f32_16x16x32_bf16 v[112:115], v[184:187], v[172:175], v[112:115]
  v_mfma_f32_16x16x32_bf16 v[108:111], v[188:191], v[168:171], v[108:111]
  v_mfma_f32_16x16x32_bf16 v[116:119], v[188:191], v[172:175], v[116:119]
  s_waitcnt lgkmcnt(3)
  v_mfma_f32_16x16x32_bf16 v[120:123], v[184:187], v[176:179], v[120:123]
  s_cmp_eq_u32 s5, 0
  s_cbranch_scc1 L_t271
  buffer_load_dwordx4 v22, s[16:19], s36 offen offset:1024 nt lds
L_t271:
  v_mfma_f32_16x16x32_bf16 v[124:127], v[188:191], v[176:179], v[124:127]
  v_mfma_f32_16x16x32_bf16 v[136:139], v[192:195], v[168:171], v[136:139]
  v_mfma_f32_16x16x32_bf16 v[144:147], v[192:195], v[172:175], v[144:147]
  v_mfma_f32_16x16x32_bf16 v[152:155], v[192:195], v[176:179], v[152:155]
  s_waitcnt lgkmcnt(0)
  v_mfma_f32_16x16x32_bf16 v[128:131], v[184:187], v[180:183], v[128:131]
  v_mfma_f32_16x16x32_bf16 v[132:135], v[188:191], v[180:183], v[132:135]
  v_mfma_f32_16x16x32_bf16 v[160:163], v[192:195], v[180:183], v[160:163]
  v_mfma_f32_16x16x32_bf16 v[140:143], v[196:199], v[168:171], v[140:143]
  v_mfma_f32_16x16x32_bf16 v[148:151], v[196:199], v[172:175], v[148:151]
  v_mfma_f32_16x16x32_bf16 v[156:159], v[196:199], v[176:179], v[156:159]
  v_mfma_f32_16x16x32_bf16 v[164:167], v[196:199], v[180:183], v[164:167]
  s_waitcnt vmcnt(8)
  s_cmp_eq_u32 s5, 0
  s_cbranch_scc0 L_w272
  s_waitcnt vmcnt(5)
L_w272:
  s_barrier
  s_add_u32 s36, s69, 49152
  s_and_b32 s36, s36, 0x1ffff
  s_add_u32 m0, s49, 49152
  s_nop 0
  buffer_load_dwordx4 v29, s[12:15], s36 offen offset:0 nt lds
  buffer_load_dwordx4 v30, s[12:15], s36 offen offset:1024 nt lds
  s_add_u32 s36, s69, 65536
  s_and_b32 s36, s36, 0x1ffff
  s_add_u32 m0, s49, 57344
  s_add_u32 s36, s36, 131072
  s_cmp_eq_u32 s5, 0
  s_cbranch_scc1 L_t273
  buffer_load_dwordx4 v29, s[12:15], s36 offen offset:0 nt lds
L_t273:
  s_cmp_eq_u32 s5, 0
  s_cbranch_scc1 L_t274
  buffer_load_dwordx4 v30, s[12:15], s36 offen offset:1024 nt lds
L_t274:
  s_waitcnt vmcnt(8)
  s_cmp_eq_u32 s5, 0
  s_cbranch_scc0 L_w275
  s_waitcnt vmcnt(4)
L_w275:
  s_barrier
  ds_write_b128 v14, v[48:51] offset:0
  s_add_u32 m0, s44, 98304
  s_add_u32 s36, s42, s47
  buffer_load_dwordx4 v10, s[20:23], s36 offen offset:0  lds
  buffer_load_dwordx4 v11, s[20:23], s36 offen offset:1024  lds
  buffer_load_dwordx4 v12, s[20:23], s36 offen offset:2048  lds
  buffer_load_dwordx4 v13, s[20:23], s36 offen offset:3072  lds
  s_add_u32 s42, s42, 262144
  s_cmp_eq_u32 s42, 4718592
  s_cselect_b32 s42, 0, s42
  s_add_u32 m0, s44, 114688
  s_add_u32 s36, s42, s47
  buffer_load_dwordx4 v10, s[20:23], s36 offen offset:0  lds
  buffer_load_dwordx4 v11, s[20:23], s36 offen offset:1024  lds
  buffer_load_dwordx4 v12, s[20:23], s36 offen offset:2048  lds
  buffer_load_dwordx4 v13, s[20:23], s36 offen offset:3072  lds
  s_add_u32 s42, s42, 262144
  s_cmp_eq_u32 s42, 4718592
  s_cselect_b32 s42, 0, s42
  s_add_u32 s36, s69, 40960
  s_and_b32 s36, s36, 0x1ffff
  s_add_u32 m0, s49, 0
  s_nop 0
  buffer_load_dwordx4 v31, s[16:19], s36 offen offset:0 nt lds
  buffer_load_dwordx4 v22, s[16:19], s36 offen offset:1024 nt lds
  s_add_u32 s36, s69, 57344
  s_and_b32 s36, s36, 0x1ffff
  s_add_u32 m0, s49, 8192
  s_add_u32 s36, s36, 131072
  s_cmp_eq_u32 s5, 0
  s_cbranch_scc1 L_t276
  buffer_load_dwordx4 v31, s[16:19], s36 offen offset:0 nt lds
L_t276:
  s_cmp_eq_u32 s5, 0
  s_cbranch_scc1 L_t277
  buffer_load_dwordx4 v22, s[16:19], s36 offen offset:1024 nt lds
L_t277:
  s_cmp_eq_u32 s5, 0
  s_cbranch_scc0 L_x278
  s_add_u32 s36, s46, 81920
  s_and_b32 s36, s36, 0x1ffff
  s_mov_b32 exec_hi, 0
  buffer_load_dword v0, v23, s[52:55], s36 offen
  s_mov_b32 exec_hi, -1
L_x278:
  s_waitcnt lgkmcnt(0)
  s_waitcnt vmcnt(16)
  s_cmp_eq_u32 s5, 0
  s_cbranch_scc0 L_w279
  s_waitcnt vmcnt(13)
L_w279:
  s_barrier
  ds_read_b128 v[168:171], v15 offset:0
  ds_read_b64_tr_b16 v[184:185], v16 offset:0
  ds_read_b64_tr_b16 v[186:187], v16 offset:2048
  ds_read_b128 v[172:175], v15 offset:1024
  ds_read_b64_tr_b16 v[188:189], v17 offset:0
  ds_read_b64_tr_b16 v[190:191], v17 offset:2048
  ds_read_b128 v[176:179], v15 offset:2048
  ds_read_b64_tr_b16 v[192:193], v18 offset:0
  ds_read_b64_tr_b16 v[194:195], v18 offset:2048
  ds_read_b128 v[180:183], v15 offset:3072
  ds_read_b64_tr_b16 v[196:197], v19 offset:0
  ds_read_b64_tr_b16 v[198:199], v19 offset:2048
  ds_write_b128 v14, v[52:55] offset:4096
  s_add_u32 s36, s69, 57344
  s_and_b32 s36, s36, 0x1ffff
  s_add_u32 m0, s49, 16384
  s_nop 0
  buffer_load_dwordx4 v29, s[12:15], s36 offen offset:0 nt lds
  buffer_load_dwordx4 v30, s[12:15], s36 offen offset:1024 nt lds
  s_waitcnt lgkmcnt(10)
  v_mfma_f32_16x16x32_bf16 v[104:107], v[184:187], v[168:171], v[104:107]
  s_add_u32 s36, s69, 73728
  s_and_b32 s36, s36, 0x1ffff
  s_add_u32 m0, s49, 24576
  s_add_u32 s36, s36, 131072
  s_cmp_eq_u32 s5, 0
  s_cbranch_scc1 L_t280
  buffer_load_dwordx4 v29, s[12:15], s36 offen offset:0 nt lds
L_t280:
  s_waitcnt lgkmcnt(7)
  v_mfma_f32_16x16x32_bf16 v[112:115], v[184:187], v[172:175], v[112:115]
  v_mfma_f32_16x16x32_bf16 v[108:111], v[188:191], v[168:171], v[108:111]
  v_mfma_f32_16x16x32_bf16 v[116:119], v[188:191], v[172:175], v[116:119]
  s_waitcnt lgkmcnt(4)
  v_mfma_f32_16x16x32_bf16 v[120:123], v[184:187], v[176:179], v[120:123]
  s_cmp_eq_u32 s5, 0
  s_cbranch_scc1 L_t281
  buffer_load_dwordx4 v30, s[12:15], s36 offen offset:1024 nt lds
L_t281:
  v_mfma_f32_16x16x32_bf16 v[124:127], v[188:191], v[176:179], v[124:127]
  v_mfma_f32_16x16x32_bf16 v[136:139], v[192:195], v[168:171], v[136:139]
  v_mfma_f32_16x16x32_bf16 v[144:147], v[192:195], v[172:175], v[144:147]
  v_mfma_f32_16x16x32_bf16 v[152:155], v[192:195], v[176:179], v[152:155]
  s_waitcnt lgkmcnt(1)
  v_mfma_f32_16x16x32_bf16 v[128:131], v[184:187], v[180:183], v[128:131]
  v_mfma_f32_16x16x32_bf16 v[132:135], v[188:191], v[180:183], v[132:135]
  v_mfma_f32_16x16x32_bf16 v[160:163], v[192:195], v[180:183], v[160:163]
  v_mfma_f32_16x16x32_bf16 v[140:143], v[196:199], v[168:171], v[140:143]
  v_mfma_f32_16x16x32_bf16 v[148:151], v[196:199], v[172:175], v[148:151]
  v_mfma_f32_16x16x32_bf16 v[156:159], v[196:199], v[176:179], v[156:159]
  v_mfma_f32_16x16x32_bf16 v[164:167], v[196:199], v[180:183], v[164:167]
  s_waitcnt lgkmcnt(0)
  s_waitcnt vmcnt(8)
  s_cmp_eq_u32 s5, 0
  s_cbranch_scc0 L_w282
  s_waitcnt vmcnt(5)
L_w282:
  s_barrier
  ds_read_b128 v[168:171], v15 offset:4096
  ds_read_b64_tr_b16 v[184:185], v16 offset:16384
  ds_read_b64_tr_b16 v[186:187], v16 offset:18432
  ds_read_b128 v[172:175], v15 offset:5120
  ds_read_b64_tr_b16 v[188:189], v17 offset:16384
  ds_read_b64_tr_b16 v[190:191], v17 offset:18432
  ds_read_b128 v[176:179], v15 offset:6144
  ds_read_b64_tr_b16 v[192:193], v18 offset:16384
  ds_read_b64_tr_b16 v[194:195], v18 offset:18432
  ds_read_b128 v[180:183], v15 offset:7168
  ds_read_b64_tr_b16 v[196:197], v19 offset:16384
  ds_read_b64_tr_b16 v[198:199], v19 offset:18432
  ds_write_b128 v14, v[56:59] offset:0
  s_add_u32 s36, s69, 49152
  s_and_b32 s36, s36, 0x1ffff
  s_add_u32 m0, s49, 32768
  s_nop 0
  buffer_load_dwordx4 v31, s[16:19], s36 offen offset:0 nt lds
  buffer_load_dwordx4 v22, s[16:19], s36 offen offset:1024 nt lds
  s_waitcnt lgkmcnt(10)
  v_mfma_f32_16x16x32_bf16 v[104:107], v[184:187], v[168:171], v[104:107]
  s_add_u32 s36, s69, 65536
  s_and_b32 s36, s36, 0x1ffff
  s_add_u32 m0, s49, 40960
  s_add_u32 s36, s36, 131072
  s_cmp_eq_u32 s5, 0
  s_cbranch_scc1 L_t283
  buffer_load_dwordx4 v31, s[16:19], s36 offen offset:0 nt lds
L_t283:
  s_waitcnt lgkmcnt(7)
  v_mfma_f32_16x16x32_bf16 v[112:115], v[184:187], v[172:175], v[112:115]
  v_mfma_f32_16x16x32_bf16 v[108:111], v[188:191], v[168:171], v[108:111]
  v_mfma_f32_16x16x32_bf16 v[116:119], v[188:191], v[172:175], v[116:119]
  s_waitcnt lgkmcnt(4)
  v_mfma_f32_16x16x32_bf16 v[120:123], v[184:187], v[176:179], v[120:123]
  s_cmp_eq_u32 s5, 0
  s_cbranch_scc1 L_t284
  buffer_load_dwordx4 v22, s[16:19], s36 offen offset:1024 nt lds
L_t284:
  v_mfma_f32_16x16x32_bf16 v[124:127], v[188:191], v[176:179], v[124:127]
  v_mfma_f32_16x16x32_bf16 v[136:139], v[192:195], v[168:171], v[136:139]
  v_mfma_f32_16x16x32_bf16 v[144:147], v[192:195], v[172:175], v[144:147]
  v_mfma_f32_16x16x32_bf16 v[152:155], v[192:195], v[176:179], v[152:155]
  s_waitcnt lgkmcnt(1)
  v_mfma_f32_16x16x32_bf16 v[128:131], v[184:187], v[180:183], v[128:131]
  v_mfma_f32_16x16x32_bf16 v[132:135], v[188:191], v[180:183], v[132:135]
  v_mfma_f32_16x16x32_bf16 v[160:163], v[192:195], v[180:183], v[160:163]
  v_mfma_f32_16x16x32_bf16 v[140:143], v[196:199], v[168:171], v[140:143]
  v_mfma_f32_16x16x32_bf16 v[148:151], v[196:199], v[172:175], v[148:151]
  v_mfma_f32_16x16x32_bf16 v[156:159], v[196:199], v[176:179], v[156:159]
  v_mfma_f32_16x16x32_bf16 v[164:167], v[196:199], v[180:183], v[164:167]
  s_waitcnt lgkmcnt(0)
  s_waitcnt vmcnt(8)
  s_cmp_eq_u32 s5, 0
  s_cbranch_scc0 L_w285
  s_waitcnt vmcnt(5)
L_w285:
  s_barrier
  ds_read_b128 v[168:171], v15 offset:0
  ds_read_b64_tr_b16 v[184:185], v16 offset:32768
  ds_read_b64_tr_b16 v[186:187], v16 offset:34816
  ds_read_b128 v[172:175], v15 offset:1024
  ds_read_b64_tr_b16 v[188:189], v17 offset:32768
  ds_read_b64_tr_b16 v[190:191], v17 offset:34816
  ds_read_b128 v[176:179], v15 offset:2048
  ds_read_b64_tr_b16 v[192:193], v18 offset:32768
  ds_read_b64_tr_b16 v[194:195], v18 offset:34816
  ds_read_b128 v[180:183], v15 offset:3072
  ds_read_b64_tr_b16 v[196:197], v19 offset:32768
  ds_read_b64_tr_b16 v[198:199], v19 offset:34816
  s_add_u32 s36, s69, 65536
  s_and_b32 s36, s36, 0x1ffff
  s_add_u32 m0, s49, 49152
  s_nop 0
  buffer_load_dwordx4 v29, s[12:15], s36 offen offset:0 nt lds
  buffer_load_dwordx4 v30, s[12:15], s36 offen offset:1024 nt lds
  s_waitcnt lgkmcnt(9)
  v_mfma_f32_16x16x32_bf16 v[104:107], v[184:187], v[168:171], v[104:107]
  s_add_u32 s36, s69, 81920
  s_and_b32 s36, s36, 0x1ffff
  s_add_u32 m0, s49, 57344
  s_add_u32 s36, s36, 131072
  s_cmp_eq_u32 s5, 0
  s_cbranch_scc1 L_t286
  buffer_load_dwordx4 v29, s[12:15], s36 offen offset:0 nt lds
L_t286:
  s_waitcnt lgkmcnt(6)
  v_mfma_f32_16x16x32_bf16 v[112:115], v[184:187], v[172:175], v[112:115]
  v_mfma_f32_16x16x32_bf16 v[108:111], v[188:191], v[168:171], v[108:111]
  v_mfma_f32_16x16x32_bf16 v[116:119], v[188:191], v[172:175], v[116:119]
  s_waitcnt lgkmcnt(3)
  v_mfma_f32_16x16x32_bf16 v[120:123], v[184:187], v[176:179], v[120:123]
  s_cmp_eq_u32 s5, 0
  s_cbranch_scc1 L_t287
  buffer_load_dwordx4 v30, s[12:15], s36 offen offset:1024 nt lds
L_t287:
  v_mfma_f32_16x16x32_bf16 v[124:127], v[188:191], v[176:179], v[124:127]
  v_mfma_f32_16x16x32_bf16 v[136:139], v[192:195], v[168:171], v[136:139]
  v_mfma_f32_16x16x32_bf16 v[144:147], v[192:195], v[172:175], v[144:147]
  v_mfma_f32_16x16x32_bf16 v[152:155], v[192:195], v[176:179], v[152:155]
  s_waitcnt lgkmcnt(0)
  v_mfma_f32_16x16x32_bf16 v[128:131], v[184:187], v[180:183], v[128:131]
  v_mfma_f32_16x16x32_bf16 v[132:135], v[188:191], v[180:183], v[132:135]
  v_mfma_f32_16x16x32_bf16 v[160:163], v[192:195], v[180:183], v[160:163]
  v_mfma_f32_16x16x32_bf16 v[140:143], v[196:199], v[168:171], v[140:143]
  v_mfma_f32_16x16x32_bf16 v[148:151], v[196:199], v[172:175], v[148:151]
  v_mfma_f32_16x16x32_bf16 v[156:159], v[196:199], v[176:179], v[156:159]
  v_mfma_f32_16x16x32_bf16 v[164:167], v[196:199], v[180:183], v[164:167]
  s_waitcnt vmcnt(8)
  s_cmp_eq_u32 s5, 0
  s_cbranch_scc0 L_w288
  s_waitcnt vmcnt(4)
L_w288:
  s_barrier
  ds_write_b128 v14, v[60:63] offset:4096
  s_add_u32 m0, s44, 65536
  s_add_u32 s36, s42, s47
  buffer_load_dwordx4 v10, s[20:23], s36 offen offset:0  lds
  buffer_load_dwordx4 v11, s[20:23], s36 offen offset:1024  lds
  buffer_load_dwordx4 v12, s[20:23], s36 offen offset:2048  lds
  buffer_load_dwordx4 v13, s[20:23], s36 offen offset:3072  lds
  s_add_u32 s42, s42, 262144
  s_cmp_eq_u32 s42, 4718592
  s_cselect_b32 s42, 0, s42
  s_add_u32 m0, s44, 81920
  s_add_u32 s36, s42, s47
  buffer_load_dwordx4 v10, s[20:23], s36 offen offset:0  lds
  buffer_load_dwordx4 v11, s[20:23], s36 offen offset:1024  lds
  buffer_load_dwordx4 v12, s[20:23], s36 offen offset:2048  lds
  buffer_load_dwordx4 v13, s[20:23], s36 offen offset:3072  lds
  s_add_u32 s42, s42, 262144
  s_cmp_eq_u32 s42, 4718592
  s_cselect_b32 s42, 0, s42
  s_add_u32 m0, s44, 98304
  s_add_u32 s36, s42, s47
  buffer_load_dwordx4 v10, s[20:23], s36 offen offset:0  lds
  buffer_load_dwordx4 v11, s[20:23], s36 offen offset:1024  lds
  buffer_load_dwordx4 v12, s[20:23], s36 offen offset:2048  lds
  buffer_load_dwordx4 v13, s[20:23], s36 offen offset:3072  lds
  s_add_u32 s42, s42, 262144
  s_cmp_eq_u32 s42, 4718592
  s_cselect_b32 s42, 0, s42
  s_add_u32 s36, s69, 57344
  s_and_b32 s36, s36, 0x1ffff
  s_add_u32 m0, s49, 0
  s_nop 0
  buffer_load_dwordx4 v31, s[16:19], s36 offen offset:0 nt lds
  buffer_load_dwordx4 v22, s[16:19], s36 offen offset:1024 nt lds
  s_add_u32 s36, s69, 73728
  s_and_b32 s36, s36, 0x1ffff
  s_add_u32 m0, s49, 8192
  s_add_u32 s36, s36, 131072
  s_cmp_eq_u32 s5, 0
  s_cbranch_scc1 L_t289
  buffer_load_dwordx4 v31, s[16:19], s36 offen offset:0 nt lds
L_t289:
  s_cmp_eq_u32 s5, 0
  s_cbranch_scc1 L_t290
  buffer_load_dwordx4 v22, s[16:19], s36 offen offset:1024 nt lds
L_t290:
  s_cmp_eq_u32 s5, 0
  s_cbranch_scc0 L_x291
  s_add_u32 s36, s46, 98304
  s_and_b32 s36, s36, 0x1ffff
  s_mov_b32 exec_hi, 0
  buffer_load_dword v0, v23, s[52:55], s36 offen
  s_mov_b32 exec_hi, -1
L_x291:
  s_waitcnt lgkmcnt(0)
  s_waitcnt vmcnt(20)
  s_cmp_eq_u32 s5, 0
  s_cbranch_scc0 L_w292
  s_waitcnt vmcnt(17)
L_w292:
  s_barrier
  ds_read_b128 v[168:171], v15 offset:4096
  ds_read_b64_tr_b16 v[184:185], v16 offset:49152
  ds_read_b64_tr_b16 v[186:187], v16 offset:51200
  ds_read_b128 v[172:175], v15 offset:5120
  ds_read_b64_tr_b16 v[188:189], v17 offset:49152
  ds_read_b64_tr_b16 v[190:191], v17 offset:51200
  ds_read_b128 v[176:179], v15 offset:6144
  ds_read_b64_tr_b16 v[192:193], v18 offset:49152
  ds_read_b64_tr_b16 v[194:195], v18 offset:51200
  ds_read_b128 v[180:183], v15 offset:7168
  ds_read_b64_tr_b16 v[196:197], v19 offset:49152
  ds_read_b64_tr_b16 v[198:199], v19 offset:51200
  ds_write_b128 v14, v[64:67] offset:0
  s_add_u32 s36, s69, 73728
  s_and_b32 s36, s36, 0x1ffff
  s_add_u32 m0, s49, 16384
  s_nop 0
  buffer_load_dwordx4 v29, s[12:15], s36 offen offset:0 nt lds
  buffer_load_dwordx4 v30, s[12:15], s36 offen offset:1024 nt lds
  s_waitcnt lgkmcnt(10)
  v_mfma_f32_16x16x32_bf16 v[104:107], v[184:187], v[168:171], v[104:107]
  s_add_u32 s36, s69, 90112
  s_and_b32 s36, s36, 0x1ffff
  s_add_u32 m0, s49, 24576
  s_add_u32 s36, s36, 131072
  s_cmp_eq_u32 s5, 0
  s_cbranch_scc1 L_t293
  buffer_load_dwordx4 v29, s[12:15], s36 offen offset:0 nt lds
L_t293:
  s_waitcnt lgkmcnt(7)
  v_mfma_f32_16x16x32_bf16 v[112:115], v[184:187], v[172:175], v[112:115]
  v_mfma_f32_16x16x32_bf16 v[108:111], v[188:191], v[168:171], v[108:111]
  v_mfma_f32_16x16x32_bf16 v[116:119], v[188:191], v[172:175], v[116:119]
  s_waitcnt lgkmcnt(4)
  v_mfma_f32_16x16x32_bf16 v[120:123], v[184:187], v[176:179], v[120:123]
  s_cmp_eq_u32 s5, 0
  s_cbranch_scc1 L_t294
  buffer_load_dwordx4 v30, s[12:15], s36 offen offset:1024 nt lds
L_t294:
  v_mfma_f32_16x16x32_bf16 v[124:127], v[188:191], v[176:179], v[124:127]
  v_mfma_f32_16x16x32_bf16 v[136:139], v[192:195], v[168:171], v[136:139]
  v_mfma_f32_16x16x32_bf16 v[144:147], v[192:195], v[172:175], v[144:147]
  v_mfma_f32_16x16x32_bf16 v[152:155], v[192:195], v[176:179], v[152:155]
  s_waitcnt lgkmcnt(1)
  v_mfma_f32_16x16x32_bf16 v[128:131], v[184:187], v[180:183], v[128:131]
  v_mfma_f32_16x16x32_bf16 v[132:135], v[188:191], v[180:183], v[132:135]
  v_mfma_f32_16x16x32_bf16 v[160:163], v[192:195], v[180:183], v[160:163]
  v_mfma_f32_16x16x32_bf16 v[140:143], v[196:199], v[168:171], v[140:143]
  v_mfma_f32_16x16x32_bf16 v[148:151], v[196:199], v[172:175], v[148:151]
  v_mfma_f32_16x16x32_bf16 v[156:159], v[196:199], v[176:179], v[156:159]
  v_mfma_f32_16x16x32_bf16 v[164:167], v[196:199], v[180:183], v[164:167]
  s_waitcnt lgkmcnt(0)
  s_waitcnt vmcnt(8)
  s_cmp_eq_u32 s5, 0
  s_cbranch_scc0 L_w295
  s_waitcnt vmcnt(5)
L_w295:
  s_barrier
  ds_read_b128 v[168:171], v15 offset:0
  ds_read_b64_tr_b16 v[184:185], v16 offset:0
  ds_read_b64_tr_b16 v[186:187], v16 offset:2048
  ds_read_b128 v[172:175], v15 offset:1024
  ds_read_b64_tr_b16 v[188:189], v17 offset:0
  ds_read_b64_tr_b16 v[190:191], v17 offset:2048
  ds_read_b128 v[176:179], v15 offset:2048
  ds_read_b64_tr_b16 v[192:193], v18 offset:0
  ds_read_b64_tr_b16 v[194:195], v18 offset:2048
  ds_read_b128 v[180:183], v15 offset:3072
  ds_read_b64_tr_b16 v[196:197], v19 offset:0
  ds_read_b64_tr_b16 v[198:199], v19 offset:2048
  s_add_u32 s36, s69, 65536
  s_and_b32 s36, s36, 0x1ffff
  s_add_u32 m0, s49, 32768
  s_nop 0
  buffer_load_dwordx4 v31, s[16:19], s36 offen offset:0 nt lds
  buffer_load_dwordx4 v22, s[16:19], s36 offen offset:1024 nt lds
  s_waitcnt lgkmcnt(9)
  v_mfma_f32_16x16x32_bf16 v[104:107], v[184:187], v[168:171], v[104:107]
  s_add_u32 s36, s69, 81920
  s_and_b32 s36, s36, 0x1ffff
  s_add_u32 m0, s49, 40960
  s_add_u32 s36, s36, 131072
  s_cmp_eq_u32 s5, 0
  s_cbranch_scc1 L_t296
  buffer_load_dwordx4 v31, s[16:19], s36 offen offset:0 nt lds
L_t296:
  s_waitcnt lgkmcnt(6)
  v_mfma_f32_16x16x32_bf16 v[112:115], v[184:187], v[172:175], v[112:115]
  v_mfma_f32_16x16x32_bf16 v[108:111], v[188:191], v[168:171], v[108:111]
  v_mfma_f32_16x16x32_bf16 v[116:119], v[188:191], v[172:175], v[116:119]
  s_waitcnt lgkmcnt(3)
  v_mfma_f32_16x16x32_bf16 v[120:123], v[184:187], v[176:179], v[120:123]
  s_cmp_eq_u32 s5, 0
  s_cbranch_scc1 L_t297
  buffer_load_dwordx4 v22, s[16:19], s36 offen offset:1024 nt lds
L_t297:
  v_mfma_f32_16x16x32_bf16 v[124:127], v[188:191], v[176:179], v[124:127]
  v_mfma_f32_16x16x32_bf16 v[136:139], v[192:195], v[168:171], v[136:139]
  v_mfma_f32_16x16x32_bf16 v[144:147], v[192:195], v[172:175], v[144:147]
  v_mfma_f32_16x16x32_bf16 v[152:155], v[192:195], v[176:179], v[152:155]
  s_waitcnt lgkmcnt(0)
  v_mfma_f32_16x16x32_bf16 v[128:131], v[184:187], v[180:183], v[128:131]
  v_mfma_f32_16x16x32_bf16 v[132:135], v[188:191], v[180:183], v[132:135]
  v_mfma_f32_16x16x32_bf16 v[160:163], v[192:195], v[180:183], v[160:163]
  v_mfma_f32_16x16x32_bf16 v[140:143], v[196:199], v[168:171], v[140:143]
  v_mfma_f32_16x16x32_bf16 v[148:151], v[196:199], v[172:175], v[148:151]
  v_mfma_f32_16x16x32_bf16 v[156:159], v[196:199], v[176:179], v[156:159]
  v_mfma_f32_16x16x32_bf16 v[164:167], v[196:199], v[180:183], v[164:167]
  s_waitcnt vmcnt(8)
  s_cmp_eq_u32 s5, 0
  s_cbranch_scc0 L_w298
  s_waitcnt vmcnt(5)
L_w298:
  s_barrier
  s_add_u32 s36, s69, 81920
  s_and_b32 s36, s36, 0x1ffff
  s_add_u32 m0, s49, 49152
  s_nop 0
  buffer_load_dwordx4 v29, s[12:15], s36 offen offset:0 nt lds
  buffer_load_dwordx4 v30, s[12:15], s36 offen offset:1024 nt lds
  s_add_u32 s36, s69, 98304
  s_and_b32 s36, s36, 0x1ffff
  s_add_u32 m0, s49, 57344
  s_add_u32 s36, s36, 131072
  s_cmp_eq_u32 s5, 0
  s_cbranch_scc1 L_t299
  buffer_load_dwordx4 v29, s[12:15], s36 offen offset:0 nt lds
L_t299:
  s_cmp_eq_u32 s5, 0
  s_cbranch_scc1 L_t300
  buffer_load_dwordx4 v30, s[12:15], s36 offen offset:1024 nt lds
L_t300:
  s_cmp_eq_u32 s5, 0
  s_cbranch_scc0 L_pf301
  s_lshl_b32 s36, s6, 2
  s_add_u32 s36, s36, s4
  s_mul_i32 s36, s36, 4608
  v_lshlrev_b32 v2, 7, v1
  s_mov_b32 exec_hi, 15
  buffer_load_dword v0, v2, s[60:63], s36 offen
  buffer_load_dword v0, v2, s[24:27], s36 offen
  s_mov_b32 exec_hi, -1
L_pf301:
  s_waitcnt vmcnt(8)
  s_cmp_eq_u32 s5, 0
  s_cbranch_scc0 L_w302
  s_waitcnt vmcnt(6)
L_w302:
  s_barrier
  ds_write_b128 v14, v[68:71] offset:4096
  s_add_u32 m0, s44, 114688
  s_add_u32 s36, s42, s47
  buffer_load_dwordx4 v10, s[20:23], s36 offen offset:0  lds
  buffer_load_dwordx4 v11, s[20:23], s36 offen offset:1024  lds
  buffer_load_dwordx4 v12, s[20:23], s36 offen offset:2048  lds
  buffer_load_dwordx4 v13, s[20:23], s36 offen offset:3072  lds
  s_add_u32 s42, s42, 262144
  s_cmp_eq_u32 s42, 4718592
  s_cselect_b32 s42, 0, s42
  s_add_u32 m0, s44, 65536
  s_add_u32 s36, s42, s47
  buffer_load_dwordx4 v10, s[20:23], s36 offen offset:0  lds
  buffer_load_dwordx4 v11, s[20:23], s36 offen offset:1024  lds
  buffer_load_dwordx4 v12, s[20:23], s36 offen offset:2048  lds
  buffer_load_dwordx4 v13, s[20:23], s36 offen offset:3072  lds
  s_add_u32 s42, s42, 262144
  s_cmp_eq_u32 s42, 4718592
  s_cselect_b32 s42, 0, s42
  s_add_u32 s36, s69, 73728
  s_and_b32 s36, s36, 0x1ffff
  s_add_u32 m0, s49, 0
  s_nop 0
  buffer_load_dwordx4 v31, s[16:19], s36 offen offset:0 nt lds
  buffer_load_dwordx4 v22, s[16:19], s36 offen offset:1024 nt lds
  s_add_u32 s36, s69, 90112
  s_and_b32 s36, s36, 0x1ffff
  s_add_u32 m0, s49, 8192
  s_add_u32 s36, s36, 131072
  s_cmp_eq_u32 s5, 0
  s_cbranch_scc1 L_t303
  buffer_load_dwordx4 v31, s[16:19], s36 offen offset:0 nt lds
L_t303:
  s_cmp_eq_u32 s5, 0
  s_cbranch_scc1 L_t304
  buffer_load_dwordx4 v22, s[16:19], s36 offen offset:1024 nt lds
L_t304:
  s_cmp_eq_u32 s5, 0
  s_cbranch_scc0 L_x305
  s_add_u32 s36, s46, 114688
  s_and_b32 s36, s36, 0x1ffff
  s_mov_b32 exec_hi, 0
  buffer_load_dword v0, v23, s[52:55], s36 offen
  s_mov_b32 exec_hi, -1
L_x305:
  s_waitcnt lgkmcnt(0)
  s_waitcnt vmcnt(16)
  s_cmp_eq_u32 s5, 0
  s_cbranch_scc0 L_w306
  s_waitcnt vmcnt(15)
L_w306:
  s_barrier
  ds_read_b128 v[168:171], v15 offset:4096
  ds_read_b64_tr_b16 v[184:185], v16 offset:16384
  ds_read_b64_tr_b16 v[186:187], v16 offset:18432
  ds_read_b128 v[172:175], v15 offset:5120
  ds_read_b64_tr_b16 v[188:189], v17 offset:16384
  ds_read_b64_tr_b16 v[190:191], v17 offset:18432
  ds_read_b128 v[176:179], v15 offset:6144
  ds_read_b64_tr_b16 v[192:193], v18 offset:16384
  ds_read_b64_tr_b16 v[194:195], v18 offset:18432
  ds_read_b128 v[180:183], v15 offset:7168
  ds_read_b64_tr_b16 v[196:197], v19 offset:16384
  ds_read_b64_tr_b16 v[198:199], v19 offset:18432
  ds_write_b128 v14, v[72:75] offset:0
  s_add_u32 s36, s69, 90112
  s_and_b32 s36, s36, 0x1ffff
  s_add_u32 m0, s49, 16384
  s_nop 0
  buffer_load_dwordx4 v29, s[12:15], s36 offen offset:0 nt lds
  buffer_load_dwordx4 v30, s[12:15], s36 offen offset:1024 nt lds
  s_waitcnt lgkmcnt(10)
  v_mfma_f32_16x16x32_bf16 v[104:107], v[184:187], v[168:171], v[104:107]
  s_add_u32 s36, s69, 106496
  s_and_b32 s36, s36, 0x1ffff
  s_add_u32 m0, s49, 24576
  s_add_u32 s36, s36, 131072
  s_cmp_eq_u32 s5, 0
  s_cbranch_scc1 L_t307
  buffer_load_dwordx4 v29, s[12:15], s36 offen offset:0 nt lds
L_t307:
  s_waitcnt lgkmcnt(7)
  v_mfma_f32_16x16x32_bf16 v[112:115], v[184:187], v[172:175], v[112:115]
  v_mfma_f32_16x16x32_bf16 v[108:111], v[188:191], v[168:171], v[108:111]
  v_mfma_f32_16x16x32_bf16 v[116:119], v[188:191], v[172:175], v[116:119]
  s_waitcnt lgkmcnt(4)
  v_mfma_f32_16x16x32_bf16 v[120:123], v[184:187], v[176:179], v[120:123]
  s_cmp_eq_u32 s5, 0
  s_cbranch_scc1 L_t308
  buffer_load_dwordx4 v30, s[12:15], s36 offen offset:1024 nt lds
L_t308:
  v_mfma_f32_16x16x32_bf16 v[124:127], v[188:191], v[176:179], v[124:127]
  v_mfma_f32_16x16x32_bf16 v[136:139], v[192:195], v[168:171], v[136:139]
  v_mfma_f32_16x16x32_bf16 v[144:147], v[192:195], v[172:175], v[144:147]
  v_mfma_f32_16x16x32_bf16 v[152:155], v[192:195], v[176:179], v[152:155]
  s_waitcnt lgkmcnt(1)
  v_mfma_f32_16x16x32_bf16 v[128:131], v[184:187], v[180:183], v[128:131]
  v_mfma_f32_16x16x32_bf16 v[132:135], v[188:191], v[180:183], v[132:135]
  v_mfma_f32_16x16x32_bf16 v[160:163], v[192:195], v[180:183], v[160:163]
  v_mfma_f32_16x16x32_bf16 v[140:143], v[196:199], v[168:171], v[140:143]
  v_mfma_f32_16x16x32_bf16 v[148:151], v[196:199], v[172:175], v[148:151]
  v_mfma_f32_16x16x32_bf16 v[156:159], v[196:199], v[176:179], v[156:159]
  v_mfma_f32_16x16x32_bf16 v[164:167], v[196:199], v[180:183], v[164:167]
  s_waitcnt lgkmcnt(0)
  s_waitcnt vmcnt(8)
  s_cmp_eq_u32 s5, 0
  s_cbranch_scc0 L_w309
  s_waitcnt vmcnt(5)
L_w309:
  s_barrier
  ds_read_b128 v[168:171], v15 offset:0
  ds_read_b64_tr_b16 v[184:185], v16 offset:32768
  ds_read_b64_tr_b16 v[186:187], v16 offset:34816
  ds_read_b128 v[172:175], v15 offset:1024
  ds_read_b64_tr_b16 v[188:189], v17 offset:32768
  ds_read_b64_tr_b16 v[190:191], v17 offset:34816
  ds_read_b128 v[176:179], v15 offset:2048
  ds_read_b64_tr_b16 v[192:193], v18 offset:32768
  ds_read_b64_tr_b16 v[194:195], v18 offset:34816
  ds_read_b128 v[180:183], v15 offset:3072
  ds_read_b64_tr_b16 v[196:197], v19 offset:32768
  ds_read_b64_tr_b16 v[198:199], v19 offset:34816
  ds_write_b128 v14, v[76:79] offset:4096
  s_add_u32 s36, s69, 81920
  s_and_b32 s36, s36, 0x1ffff
  s_add_u32 m0, s49, 32768
  s_nop 0
  buffer_load_dwordx4 v31, s[16:19], s36 offen offset:0 nt lds
  buffer_load_dwordx4 v22, s[16:19], s36 offen offset:1024 nt lds
  s_waitcnt lgkmcnt(10)
  v_mfma_f32_16x16x32_bf16 v[104:107], v[184:187], v[168:171], v[104:107]
  s_add_u32 s36, s69, 98304
  s_and_b32 s36, s36, 0x1ffff
  s_add_u32 m0, s49, 40960
  s_add_u32 s36, s36, 131072
  s_cmp_eq_u32 s5, 0
  s_cbranch_scc1 L_t310
  buffer_load_dwordx4 v31, s[16:19], s36 offen offset:0 nt lds
L_t310:
  s_waitcnt lgkmcnt(7)
  v_mfma_f32_16x16x32_bf16 v[112:115], v[184:187], v[172:175], v[112:115]
  v_mfma_f32_16x16x32_bf16 v[108:111], v[188:191], v[168:171], v[108:111]
  v_mfma_f32_16x16x32_bf16 v[116:119], v[188:191], v[172:175], v[116:119]
  s_waitcnt lgkmcnt(4)
  v_mfma_f32_16x16x32_bf16 v[120:123], v[184:187], v[176:179], v[120:123]
  s_cmp_eq_u32 s5, 0
  s_cbranch_scc1 L_t311
  buffer_load_dwordx4 v22, s[16:19], s36 offen offset:1024 nt lds
L_t311:
  v_mfma_f32_16x16x32_bf16 v[124:127], v[188:191], v[176:179], v[124:127]
  v_mfma_f32_16x16x32_bf16 v[136:139], v[192:195], v[168:171], v[136:139]
  v_mfma_f32_16x16x32_bf16 v[144:147], v[192:195], v[172:175], v[144:147]
  v_mfma_f32_16x16x32_bf16 v[152:155], v[192:195], v[176:179], v[152:155]
  s_waitcnt lgkmcnt(1)
  v_mfma_f32_16x16x32_bf16 v[128:131], v[184:187], v[180:183], v[128:131]
  v_mfma_f32_16x16x32_bf16 v[132:135], v[188:191], v[180:183], v[132:135]
  v_mfma_f32_16x16x32_bf16 v[160:163], v[192:195], v[180:183], v[160:163]
  v_mfma_f32_16x16x32_bf16 v[140:143], v[196:199], v[168:171], v[140:143]
  v_mfma_f32_16x16x32_bf16 v[148:151], v[196:199], v[172:175], v[148:151]
  v_mfma_f32_16x16x32_bf16 v[156:159], v[196:199], v[176:179], v[156:159]
  v_mfma_f32_16x16x32_bf16 v[164:167], v[196:199], v[180:183], v[164:167]
  s_waitcnt lgkmcnt(0)
  s_waitcnt vmcnt(8)
  s_cmp_eq_u32 s5, 0
  s_cbranch_scc0 L_w312
  s_waitcnt vmcnt(5)
L_w312:
  s_barrier
  ds_read_b128 v[168:171], v15 offset:4096
  ds_read_b64_tr_b16 v[184:185], v16 offset:49152
  ds_read_b64_tr_b16 v[186:187], v16 offset:51200
  ds_read_b128 v[172:175], v15 offset:5120
  ds_read_b64_tr_b16 v[188:189], v17 offset:49152
  ds_read_b64_tr_b16 v[190:191], v17 offset:51200
  ds_read_b128 v[176:179], v15 offset:6144
  ds_read_b64_tr_b16 v[192:193], v18 offset:49152
  ds_read_b64_tr_b16 v[194:195], v18 offset:51200
  ds_read_b128 v[180:183], v15 offset:7168
  ds_read_b64_tr_b16 v[196:197], v19 offset:49152
  ds_read_b64_tr_b16 v[198:199], v19 offset:51200
  s_add_u32 s36, s69, 98304
  s_and_b32 s36, s36, 0x1ffff
  s_add_u32 m0, s49, 49152
  s_nop 0
  buffer_load_dwordx4 v29, s[12:15], s36 offen offset:0 nt lds
  buffer_load_dwordx4 v30, s[12:15], s36 offen offset:1024 nt lds
  s_waitcnt lgkmcnt(9)
  v_mfma_f32_16x16x32_bf16 v[104:107], v[184:187], v[168:171], v[104:107]
  s_add_u32 s36, s69, 114688
  s_and_b32 s36, s36, 0x1ffff
  s_add_u32 m0, s49, 57344
  s_add_u32 s36, s36, 131072
  s_cmp_eq_u32 s5, 0
  s_cbranch_scc1 L_t313
  buffer_load_dwordx4 v29, s[12:15], s36 offen offset:0 nt lds
L_t313:
  s_waitcnt lgkmcnt(6)
  v_mfma_f32_16x16x32_bf16 v[112:115], v[184:187], v[172:175], v[112:115]
  v_mfma_f32_16x16x32_bf16 v[108:111], v[188:191], v[168:171], v[108:111]
  v_mfma_f32_16x16x32_bf16 v[116:119], v[188:191], v[172:175], v[116:119]
  s_waitcnt lgkmcnt(3)
  v_mfma_f32_16x16x32_bf16 v[120:123], v[184:187], v[176:179], v[120:123]
  s_cmp_eq_u32 s5, 0
  s_cbranch_scc1 L_t314
  buffer_load_dwordx4 v30, s[12:15], s36 offen offset:1024 nt lds
L_t314:
  v_mfma_f32_16x16x32_bf16 v[124:127], v[188:191], v[176:179], v[124:127]
  v_mfma_f32_16x16x32_bf16 v[136:139], v[192:195], v[168:171], v[136:139]
  v_mfma_f32_16x16x32_bf16 v[144:147], v[192:195], v[172:175], v[144:147]
  v_mfma_f32_16x16x32_bf16 v[152:155], v[192:195], v[176:179], v[152:155]
  s_waitcnt lgkmcnt(0)
  v_mfma_f32_16x16x32_bf16 v[128:131], v[184:187], v[180:183], v[128:131]
  v_mfma_f32_16x16x32_bf16 v[132:135], v[188:191], v[180:183], v[132:135]
  v_mfma_f32_16x16x32_bf16 v[160:163], v[192:195], v[180:183], v[160:163]
  v_mfma_f32_16x16x32_bf16 v[140:143], v[196:199], v[168:171], v[140:143]
  v_mfma_f32_16x16x32_bf16 v[148:151], v[196:199], v[172:175], v[148:151]
  v_mfma_f32_16x16x32_bf16 v[156:159], v[196:199], v[176:179], v[156:159]
  v_mfma_f32_16x16x32_bf16 v[164:167], v[196:199], v[180:183], v[164:167]
  s_waitcnt vmcnt(8)
  s_cmp_eq_u32 s5, 0
  s_cbranch_scc0 L_w315
  s_waitcnt vmcnt(4)
L_w315:
  s_barrier
  ds_write_b128 v14, v[80:83] offset:0
  s_add_u32 m0, s44, 81920
  s_add_u32 s36, s42, s47
  buffer_load_dwordx4 v10, s[20:23], s36 offen offset:0  lds
  buffer_load_dwordx4 v11, s[20:23], s36 offen offset:1024  lds
  buffer_load_dwordx4 v12, s[20:23], s36 offen offset:2048  lds
  buffer_load_dwordx4 v13, s[20:23], s36 offen offset:3072  lds
  s_add_u32 s42, s42, 262144
  s_cmp_eq_u32 s42, 4718592
  s_cselect_b32 s42, 0, s42
  s_add_u32 m0, s44, 98304
  s_add_u32 s36, s42, s47
  buffer_load_dwordx4 v10, s[20:23], s36 offen offset:0  lds
  buffer_load_dwordx4 v11, s[20:23], s36 offen offset:1024  lds
  buffer_load_dwordx4 v12, s[20:23], s36 offen offset:2048  lds
  buffer_load_dwordx4 v13, s[20:23], s36 offen offset:3072  lds
  s_add_u32 s42, s42, 262144
  s_cmp_eq_u32 s42, 4718592
  s_cselect_b32 s42, 0, s42
  s_add_u32 m0, s44, 114688
  s_add_u32 s36, s42, s47
  buffer_load_dwordx4 v10, s[20:23], s36 offen offset:0  lds
  buffer_load_dwordx4 v11, s[20:23], s36 offen offset:1024  lds
  buffer_load_dwordx4 v12, s[20:23], s36 offen offset:2048  lds
  buffer_load_dwordx4 v13, s[20:23], s36 offen offset:3072  lds
  s_add_u32 s42, s42, 262144
  s_cmp_eq_u32 s42, 4718592
  s_cselect_b32 s42, 0, s42
  s_add_u32 s36, s69, 90112
  s_and_b32 s36, s36, 0x1ffff
  s_add_u32 m0, s49, 0
  s_nop 0
  buffer_load_dwordx4 v31, s[16:19], s36 offen offset:0 nt lds
  buffer_load_dwordx4 v22, s[16:19], s36 offen offset:1024 nt lds
  s_add_u32 s36, s69, 106496
  s_and_b32 s36, s36, 0x1ffff
  s_add_u32 m0, s49, 8192
  s_add_u32 s36, s36, 131072
  s_cmp_eq_u32 s5, 0
  s_cbranch_scc1 L_t316
  buffer_load_dwordx4 v31, s[16:19], s36 offen offset:0 nt lds
L_t316:
  s_cmp_eq_u32 s5, 0
  s_cbranch_scc1 L_t317
  buffer_load_dwordx4 v22, s[16:19], s36 offen offset:1024 nt lds
L_t317:
  s_cmp_eq_u32 s5, 0
  s_cbranch_scc0 L_x318
  s_add_u32 s36, s46, 0
  s_and_b32 s36, s36, 0x1ffff
  s_add_u32 s36, s36, 262144
  s_mov_b32 exec_hi, 0
  buffer_load_dword v0, v23, s[52:55], s36 offen
  s_mov_b32 exec_hi, -1
L_x318:
  s_waitcnt lgkmcnt(0)
  s_waitcnt vmcnt(20)
  s_cmp_eq_u32 s5, 0
  s_cbranch_scc0 L_w319
  s_waitcnt vmcnt(17)
L_w319:
  s_barrier
  ds_read_b128 v[168:171], v15 offset:0
  ds_read_b64_tr_b16 v[184:185], v16 offset:0
  ds_read_b64_tr_b16 v[186:187], v16 offset:2048
  ds_read_b128 v[172:175], v15 offset:1024
  ds_read_b64_tr_b16 v[188:189], v17 offset:0
  ds_read_b64_tr_b16 v[190:191], v17 offset:2048
  ds_read_b128 v[176:179], v15 offset:2048
  ds_read_b64_tr_b16 v[192:193], v18 offset:0
  ds_read_b64_tr_b16 v[194:195], v18 offset:2048
  ds_read_b128 v[180:183], v15 offset:3072
  ds_read_b64_tr_b16 v[196:197], v19 offset:0
  ds_read_b64_tr_b16 v[198:199], v19 offset:2048
  ds_write_b128 v14, v[84:87] offset:4096
  s_add_u32 s36, s69, 106496
  s_and_b32 s36, s36, 0x1ffff
  s_add_u32 m0, s49, 16384
  s_nop 0
  buffer_load_dwordx4 v29, s[12:15], s36 offen offset:0 nt lds
  buffer_load_dwordx4 v30, s[12:15], s36 offen offset:1024 nt lds
  s_waitcnt lgkmcnt(10)
  v_mfma_f32_16x16x32_bf16 v[104:107], v[184:187], v[168:171], v[104:107]
  s_add_u32 s36, s69, 122880
  s_and_b32 s36, s36, 0x1ffff
  s_add_u32 m0, s49, 24576
  s_add_u32 s36, s36, 131072
  s_cmp_eq_u32 s5, 0
  s_cbranch_scc1 L_t320
  buffer_load_dwordx4 v29, s[12:15], s36 offen offset:0 nt lds
L_t320:
  s_waitcnt lgkmcnt(7)
  v_mfma_f32_16x16x32_bf16 v[112:115], v[184:187], v[172:175], v[112:115]
  v_mfma_f32_16x16x32_bf16 v[108:111], v[188:191], v[168:171], v[108:111]
  v_mfma_f32_16x16x32_bf16 v[116:119], v[188:191], v[172:175], v[116:119]
  s_waitcnt lgkmcnt(4)
  v_mfma_f32_16x16x32_bf16 v[120:123], v[184:187], v[176:179], v[120:123]
  s_cmp_eq_u32 s5, 0
  s_cbranch_scc1 L_t321
  buffer_load_dwordx4 v30, s[12:15], s36 offen offset:1024 nt lds
L_t321:
  v_mfma_f32_16x16x32_bf16 v[124:127], v[188:191], v[176:179], v[124:127]
  v_mfma_f32_16x16x32_bf16 v[136:139], v[192:195], v[168:171], v[136:139]
  v_mfma_f32_16x16x32_bf16 v[144:147], v[192:195], v[172:175], v[144:147]
  v_mfma_f32_16x16x32_bf16 v[152:155], v[192:195], v[176:179], v[152:155]
  s_waitcnt lgkmcnt(1)
  v_mfma_f32_16x16x32_bf16 v[128:131], v[184:187], v[180:183], v[128:131]
  v_mfma_f32_16x16x32_bf16 v[132:135], v[188:191], v[180:183], v[132:135]
  v_mfma_f32_16x16x32_bf16 v[160:163], v[192:195], v[180:183], v[160:163]
  v_mfma_f32_16x16x32_bf16 v[140:143], v[196:199], v[168:171], v[140:143]
  v_mfma_f32_16x16x32_bf16 v[148:151], v[196:199], v[172:175], v[148:151]
  v_mfma_f32_16x16x32_bf16 v[156:159], v[196:199], v[176:179], v[156:159]
  v_mfma_f32_16x16x32_bf16 v[164:167], v[196:199], v[180:183], v[164:167]
  s_waitcnt lgkmcnt(0)
  s_waitcnt vmcnt(8)
  s_cmp_eq_u32 s5, 0
  s_cbranch_scc0 L_w322
  s_waitcnt vmcnt(5)
L_w322:
  s_barrier
  ds_read_b128 v[168:171], v15 offset:4096
  ds_read_b64_tr_b16 v[184:185], v16 offset:16384
  ds_read_b64_tr_b16 v[186:187], v16 offset:18432
  ds_read_b128 v[172:175], v15 offset:5120
  ds_read_b64_tr_b16 v[188:189], v17 offset:16384
  ds_read_b64_tr_b16 v[190:191], v17 offset:18432
  ds_read_b128 v[176:179], v15 offset:6144
  ds_read_b64_tr_b16 v[192:193], v18 offset:16384
  ds_read_b64_tr_b16 v[194:195], v18 offset:18432
  ds_read_b128 v[180:183], v15 offset:7168
  ds_read_b64_tr_b16 v[196:197], v19 offset:16384
  ds_read_b64_tr_b16 v[198:199], v19 offset:18432
  s_add_u32 s36, s69, 98304
  s_and_b32 s36, s36, 0x1ffff
  s_add_u32 m0, s49, 32768
  s_nop 0
  buffer_load_dwordx4 v31, s[16:19], s36 offen offset:0 nt lds
  buffer_load_dwordx4 v22, s[16:19], s36 offen offset:1024 nt lds
  s_waitcnt lgkmcnt(9)
  v_mfma_f32_16x16x32_bf16 v[104:107], v[184:187], v[168:171], v[104:107]
  s_add_u32 s36, s69, 114688
  s_and_b32 s36, s36, 0x1ffff
  s_add_u32 m0, s49, 40960
  s_add_u32 s36, s36, 131072
  s_cmp_eq_u32 s5, 0
  s_cbranch_scc1 L_t323
  buffer_load_dwordx4 v31, s[16:19], s36 offen offset:0 nt lds
L_t323:
  s_waitcnt lgkmcnt(6)
  v_mfma_f32_16x16x32_bf16 v[112:115], v[184:187], v[172:175], v[112:115]
  v_mfma_f32_16x16x32_bf16 v[108:111], v[188:191], v[168:171], v[108:111]
  v_mfma_f32_16x16x32_bf16 v[116:119], v[188:191], v[172:175], v[116:119]
  s_waitcnt lgkmcnt(3)
  v_mfma_f32_16x16x32_bf16 v[120:123], v[184:187], v[176:179], v[120:123]
  s_cmp_eq_u32 s5, 0
  s_cbranch_scc1 L_t324
  buffer_load_dwordx4 v22, s[16:19], s36 offen offset:1024 nt lds
L_t324:
  v_mfma_f32_16x16x32_bf16 v[124:127], v[188:191], v[176:179], v[124:127]
  v_mfma_f32_16x16x32_bf16 v[136:139], v[192:195], v[168:171], v[136:139]
  v_mfma_f32_16x16x32_bf16 v[144:147], v[192:195], v[172:175], v[144:147]
  v_mfma_f32_16x16x32_bf16 v[152:155], v[192:195], v[176:179], v[152:155]
  s_waitcnt lgkmcnt(0)
  v_mfma_f32_16x16x32_bf16 v[128:131], v[184:187], v[180:183], v[128:131]
  v_mfma_f32_16x16x32_bf16 v[132:135], v[188:191], v[180:183], v[132:135]
  v_mfma_f32_16x16x32_bf16 v[160:163], v[192:195], v[180:183], v[160:163]
  v_mfma_f32_16x16x32_bf16 v[140:143], v[196:199], v[168:171], v[140:143]
  v_mfma_f32_16x16x32_bf16 v[148:151], v[196:199], v[172:175], v[148:151]
  v_mfma_f32_16x16x32_bf16 v[156:159], v[196:199], v[176:179], v[156:159]
  v_mfma_f32_16x16x32_bf16 v[164:167], v[196:199], v[180:183], v[164:167]
  s_waitcnt vmcnt(8)
  s_cmp_eq_u32 s5, 0
  s_cbranch_scc0 L_w325
  s_waitcnt vmcnt(5)
L_w325:
  s_barrier
  s_add_u32 s36, s69, 114688
  s_and_b32 s36, s36, 0x1ffff
  s_add_u32 m0, s49, 49152
  s_nop 0
  buffer_load_dwordx4 v29, s[12:15], s36 offen offset:0 nt lds
  buffer_load_dwordx4 v30, s[12:15], s36 offen offset:1024 nt lds
  s_add_u32 s36, s69, 131072
  s_and_b32 s36, s36, 0x1ffff
  s_add_u32 m0, s49, 57344
  s_add_u32 s36, s36, 131072
  s_cmp_eq_u32 s5, 0
  s_cbranch_scc1 L_t326
  buffer_load_dwordx4 v29, s[12:15], s36 offen offset:0 nt lds
L_t326:
  s_cmp_eq_u32 s5, 0
  s_cbranch_scc1 L_t327
  buffer_load_dwordx4 v30, s[12:15], s36 offen offset:1024 nt lds
L_t327:
  s_waitcnt vmcnt(8)
  s_cmp_eq_u32 s5, 0
  s_cbranch_scc0 L_w328
  s_waitcnt vmcnt(4)
L_w328:
  s_barrier
  ds_write_b128 v14, v[88:91] offset:0
  s_add_u32 m0, s44, 65536
  s_add_u32 s36, s42, s47
  buffer_load_dwordx4 v10, s[20:23], s36 offen offset:0  lds
  buffer_load_dwordx4 v11, s[20:23], s36 offen offset:1024  lds
  buffer_load_dwordx4 v12, s[20:23], s36 offen offset:2048  lds
  buffer_load_dwordx4 v13, s[20:23], s36 offen offset:3072  lds
  s_add_u32 s42, s42, 262144
  s_cmp_eq_u32 s42, 4718592
  s_cselect_b32 s42, 0, s42
  s_add_u32 m0, s44, 81920
  s_add_u32 s36, s42, s47
  buffer_load_dwordx4 v10, s[20:23], s36 offen offset:0  lds
  buffer_load_dwordx4 v11, s[20:23], s36 offen offset:1024  lds
  buffer_load_dwordx4 v12, s[20:23], s36 offen offset:2048  lds
  buffer_load_dwordx4 v13, s[20:23], s36 offen offset:3072  lds
  s_add_u32 s42, s42, 262144
  s_cmp_eq_u32 s42, 4718592
  s_cselect_b32 s42, 0, s42
  s_add_u32 s36, s69, 106496
  s_and_b32 s36, s36, 0x1ffff
  s_add_u32 m0, s49, 0
  s_nop 0
  buffer_load_dwordx4 v31, s[16:19], s36 offen offset:0 nt lds
  buffer_load_dwordx4 v22, s[16:19], s36 offen offset:1024 nt lds
  s_add_u32 s36, s69, 122880
  s_and_b32 s36, s36, 0x1ffff
  s_add_u32 m0, s49, 8192
  s_add_u32 s36, s36, 131072
  s_cmp_eq_u32 s5, 0
  s_cbranch_scc1 L_t329
  buffer_load_dwordx4 v31, s[16:19], s36 offen offset:0 nt lds
L_t329:
  s_cmp_eq_u32 s5, 0
  s_cbranch_scc1 L_t330
  buffer_load_dwordx4 v22, s[16:19], s36 offen offset:1024 nt lds
L_t330:
  s_cmp_eq_u32 s5, 0
  s_cbranch_scc0 L_x331
  s_add_u32 s36, s46, 16384
  s_and_b32 s36, s36, 0x1ffff
  s_add_u32 s36, s36, 262144
  s_mov_b32 exec_hi, 0
  buffer_load_dword v0, v23, s[52:55], s36 offen
  s_mov_b32 exec_hi, -1
L_x331:
  s_waitcnt lgkmcnt(0)
  s_waitcnt vmcnt(16)
  s_cmp_eq_u32 s5, 0
  s_cbranch_scc0 L_w332
  s_waitcnt vmcnt(13)
L_w332:
  s_barrier
  ds_read_b128 v[168:171], v15 offset:0
  ds_read_b64_tr_b16 v[184:185], v16 offset:32768
  ds_read_b64_tr_b16 v[186:187], v16 offset:34816
  ds_read_b128 v[172:175], v15 offset:1024
  ds_read_b64_tr_b16 v[188:189], v17 offset:32768
  ds_read_b64_tr_b16 v[190:191], v17 offset:34816
  ds_read_b128 v[176:179], v15 offset:2048
  ds_read_b64_tr_b16 v[192:193], v18 offset:32768
  ds_read_b64_tr_b16 v[194:195], v18 offset:34816
  ds_read_b128 v[180:183], v15 offset:3072
  ds_read_b64_tr_b16 v[196:197], v19 offset:32768
  ds_read_b64_tr_b16 v[198:199], v19 offset:34816
  ds_write_b128 v14, v[92:95] offset:4096
  s_add_u32 s36, s69, 122880
  s_and_b32 s36, s36, 0x1ffff
  s_add_u32 m0, s49, 16384
  s_nop 0
  buffer_load_dwordx4 v29, s[12:15], s36 offen offset:0 nt lds
  buffer_load_dwordx4 v30, s[12:15], s36 offen offset:1024 nt lds
  s_waitcnt lgkmcnt(10)
  v_mfma_f32_16x16x32_bf16 v[104:107], v[184:187], v[168:171], v[104:107]
  s_add_u32 s36, s69, 139264
  s_and_b32 s36, s36, 0x1ffff
  s_add_u32 m0, s49, 24576
  s_add_u32 s36, s36, 131072
  s_cmp_eq_u32 s5, 0
  s_cbranch_scc1 L_t333
  buffer_load_dwordx4 v29, s[12:15], s36 offen offset:0 nt lds
L_t333:
  s_waitcnt lgkmcnt(7)
  v_mfma_f32_16x16x32_bf16 v[112:115], v[184:187], v[172:175], v[112:115]
  v_mfma_f32_16x16x32_bf16 v[108:111], v[188:191], v[168:171], v[108:111]
  v_mfma_f32_16x16x32_bf16 v[116:119], v[188:191], v[172:175], v[116:119]
  s_waitcnt lgkmcnt(4)
  v_mfma_f32_16x16x32_bf16 v[120:123], v[184:187], v[176:179], v[120:123]
  s_cmp_eq_u32 s5, 0
  s_cbranch_scc1 L_t334
  buffer_load_dwordx4 v30, s[12:15], s36 offen offset:1024 nt lds
L_t334:
  v_mfma_f32_16x16x32_bf16 v[124:127], v[188:191], v[176:179], v[124:127]
  v_mfma_f32_16x16x32_bf16 v[136:139], v[192:195], v[168:171], v[136:139]
  v_mfma_f32_16x16x32_bf16 v[144:147], v[192:195], v[172:175], v[144:147]
  v_mfma_f32_16x16x32_bf16 v[152:155], v[192:195], v[176:179], v[152:155]
  s_waitcnt lgkmcnt(1)
  v_mfma_f32_16x16x32_bf16 v[128:131], v[184:187], v[180:183], v[128:131]
  v_mfma_f32_16x16x32_bf16 v[132:135], v[188:191], v[180:183], v[132:135]
  v_mfma_f32_16x16x32_bf16 v[160:163], v[192:195], v[180:183], v[160:163]
  v_mfma_f32_16x16x32_bf16 v[140:143], v[196:199], v[168:171], v[140:143]
  v_mfma_f32_16x16x32_bf16 v[148:151], v[196:199], v[172:175], v[148:151]
  v_mfma_f32_16x16x32_bf16 v[156:159], v[196:199], v[176:179], v[156:159]
  v_mfma_f32_16x16x32_bf16 v[164:167], v[196:199], v[180:183], v[164:167]
  s_waitcnt lgkmcnt(0)
  s_waitcnt vmcnt(8)
  s_cmp_eq_u32 s5, 0
  s_cbranch_scc0 L_w335
  s_waitcnt vmcnt(5)
L_w335:
  s_barrier
  ds_read_b128 v[168:171], v15 offset:4096
  ds_read_b64_tr_b16 v[184:185], v16 offset:49152
  ds_read_b64_tr_b16 v[186:187], v16 offset:51200
  ds_read_b128 v[172:175], v15 offset:5120
  ds_read_b64_tr_b16 v[188:189], v17 offset:49152
  ds_read_b64_tr_b16 v[190:191], v17 offset:51200
  ds_read_b128 v[176:179], v15 offset:6144
  ds_read_b64_tr_b16 v[192:193], v18 offset:49152
  ds_read_b64_tr_b16 v[194:195], v18 offset:51200
  ds_read_b128 v[180:183], v15 offset:7168
  ds_read_b64_tr_b16 v[196:197], v19 offset:49152
  ds_read_b64_tr_b16 v[198:199], v19 offset:51200
  ds_write_b128 v14, v[96:99] offset:0
  s_add_u32 s36, s69, 114688
  s_and_b32 s36, s36, 0x1ffff
  s_add_u32 m0, s49, 32768
  s_nop 0
  buffer_load_dwordx4 v31, s[16:19], s36 offen offset:0 nt lds
  buffer_load_dwordx4 v22, s[16:19], s36 offen offset:1024 nt lds
  s_waitcnt lgkmcnt(10)
  v_mfma_f32_16x16x32_bf16 v[104:107], v[184:187], v[168:171], v[104:107]
  s_add_u32 s36, s69, 131072
  s_and_b32 s36, s36, 0x1ffff
  s_add_u32 m0, s49, 40960
  s_add_u32 s36, s36, 131072
  s_cmp_eq_u32 s5, 0
  s_cbranch_scc1 L_t336
  buffer_load_dwordx4 v31, s[16:19], s36 offen offset:0 nt lds
L_t336:
  s_waitcnt lgkmcnt(7)
  v_mfma_f32_16x16x32_bf16 v[112:115], v[184:187], v[172:175], v[112:115]
  v_mfma_f32_16x16x32_bf16 v[108:111], v[188:191], v[168:171], v[108:111]
  v_mfma_f32_16x16x32_bf16 v[116:119], v[188:191], v[172:175], v[116:119]
  s_waitcnt lgkmcnt(4)
  v_mfma_f32_16x16x32_bf16 v[120:123], v[184:187], v[176:179], v[120:123]
  s_cmp_eq_u32 s5, 0
  s_cbranch_scc1 L_t337
  buffer_load_dwordx4 v22, s[16:19], s36 offen offset:1024 nt lds
L_t337:
  v_mfma_f32_16x16x32_bf16 v[124:127], v[188:191], v[176:179], v[124:127]
  v_mfma_f32_16x16x32_bf16 v[136:139], v[192:195], v[168:171], v[136:139]
  v_mfma_f32_16x16x32_bf16 v[144:147], v[192:195], v[172:175], v[144:147]
  v_mfma_f32_16x16x32_bf16 v[152:155], v[192:195], v[176:179], v[152:155]
  s_waitcnt lgkmcnt(1)
  v_mfma_f32_16x16x32_bf16 v[128:131], v[184:187], v[180:183], v[128:131]
  v_mfma_f32_16x16x32_bf16 v[132:135], v[188:191], v[180:183], v[132:135]
  v_mfma_f32_16x16x32_bf16 v[160:163], v[192:195], v[180:183], v[160:163]
  v_mfma_f32_16x16x32_bf16 v[140:143], v[196:199], v[168:171], v[140:143]
  v_mfma_f32_16x16x32_bf16 v[148:151], v[196:199], v[172:175], v[148:151]
  v_mfma_f32_16x16x32_bf16 v[156:159], v[196:199], v[176:179], v[156:159]
  v_mfma_f32_16x16x32_bf16 v[164:167], v[196:199], v[180:183], v[164:167]
  s_waitcnt lgkmcnt(0)
  s_waitcnt vmcnt(8)
  s_cmp_eq_u32 s5, 0
  s_cbranch_scc0 L_w338
  s_waitcnt vmcnt(5)
L_w338:
  s_barrier
  ds_read_b128 v[168:171], v15 offset:0
  ds_read_b64_tr_b16 v[184:185], v16 offset:0
  ds_read_b64_tr_b16 v[186:187], v16 offset:2048
  ds_read_b128 v[172:175], v15 offset:1024
  ds_read_b64_tr_b16 v[188:189], v17 offset:0
  ds_read_b64_tr_b16 v[190:191], v17 offset:2048
  ds_read_b128 v[176:179], v15 offset:2048
  ds_read_b64_tr_b16 v[192:193], v18 offset:0
  ds_read_b64_tr_b16 v[194:195], v18 offset:2048
  ds_read_b128 v[180:183], v15 offset:3072
  ds_read_b64_tr_b16 v[196:197], v19 offset:0
  ds_read_b64_tr_b16 v[198:199], v19 offset:2048
  ds_write_b128 v14, v[100:103] offset:4096
  s_add_u32 s36, s69, 0
  s_and_b32 s36, s36, 0x1ffff
  s_add_u32 s36, s36, s68
  s_add_u32 m0, s49, 49152
  s_nop 0
  buffer_load_dwordx4 v29, s[12:15], s36 offen offset:0 nt lds
  buffer_load_dwordx4 v30, s[12:15], s36 offen offset:1024 nt lds
  s_waitcnt lgkmcnt(10)
  v_mfma_f32_16x16x32_bf16 v[104:107], v[184:187], v[168:171], v[104:107]
  s_add_u32 s36, s69, 16384
  s_and_b32 s36, s36, 0x1ffff
  s_add_u32 s36, s36, s68
  s_add_u32 m0, s49, 57344
  s_add_u32 s36, s36, 131072
  s_cmp_eq_u32 s5, 0
  s_cbranch_scc1 L_t339
  buffer_load_dwordx4 v29, s[12:15], s36 offen offset:0 nt lds
L_t339:
  s_waitcnt lgkmcnt(7)
  v_mfma_f32_16x16x32_bf16 v[112:115], v[184:187], v[172:175], v[112:115]
  v_mfma_f32_16x16x32_bf16 v[108:111], v[188:191], v[168:171], v[108:111]
  v_mfma_f32_16x16x32_bf16 v[116:119], v[188:191], v[172:175], v[116:119]
  s_waitcnt lgkmcnt(4)
  v_mfma_f32_16x16x32_bf16 v[120:123], v[184:187], v[176:179], v[120:123]
  s_cmp_eq_u32 s5, 0
  s_cbranch_scc1 L_t340
  buffer_load_dwordx4 v30, s[12:15], s36 offen offset:1024 nt lds
L_t340:
  v_mfma_f32_16x16x32_bf16 v[124:127], v[188:191], v[176:179], v[124:127]
  v_mfma_f32_16x16x32_bf16 v[136:139], v[192:195], v[168:171], v[136:139]
  v_mfma_f32_16x16x32_bf16 v[144:147], v[192:195], v[172:175], v[144:147]
  v_mfma_f32_16x16x32_bf16 v[152:155], v[192:195], v[176:179], v[152:155]
  s_waitcnt lgkmcnt(1)
  v_mfma_f32_16x16x32_bf16 v[128:131], v[184:187], v[180:183], v[128:131]
  v_mfma_f32_16x16x32_bf16 v[132:135], v[188:191], v[180:183], v[132:135]
  v_mfma_f32_16x16x32_bf16 v[160:163], v[192:195], v[180:183], v[160:163]
  v_mfma_f32_16x16x32_bf16 v[140:143], v[196:199], v[168:171], v[140:143]
  v_mfma_f32_16x16x32_bf16 v[148:151], v[196:199], v[172:175], v[148:151]
  v_mfma_f32_16x16x32_bf16 v[156:159], v[196:199], v[176:179], v[156:159]
  v_mfma_f32_16x16x32_bf16 v[164:167], v[196:199], v[180:183], v[164:167]
  s_waitcnt lgkmcnt(0)
  s_waitcnt vmcnt(8)
  s_cmp_eq_u32 s5, 0
  s_cbranch_scc0 L_w341
  s_waitcnt vmcnt(4)
L_w341:
  s_barrier
  ds_read_b128 v[168:171], v15 offset:4096
  ds_read_b64_tr_b16 v[184:185], v16 offset:16384
  ds_read_b64_tr_b16 v[186:187], v16 offset:18432
  ds_read_b128 v[172:175], v15 offset:5120
  ds_read_b64_tr_b16 v[188:189], v17 offset:16384
  ds_read_b64_tr_b16 v[190:191], v17 offset:18432
  ds_read_b128 v[176:179], v15 offset:6144
  ds_read_b64_tr_b16 v[192:193], v18 offset:16384
  ds_read_b64_tr_b16 v[194:195], v18 offset:18432
  ds_read_b128 v[180:183], v15 offset:7168
  ds_read_b64_tr_b16 v[196:197], v19 offset:16384
  ds_read_b64_tr_b16 v[198:199], v19 offset:18432
  v_lshrrev_b32 v2, 3, v1
  v_mul_u32_u24 v2, 1152, v2
  v_bfe_u32 v3, v1, 4, 1
  v_lshlrev_b32 v3, 1, v3
  v_and_b32 v4, 7, v1
  v_xor_b32 v4, v4, v3
  s_mul_i32 s36, s4, 36864
  v_add_u32 v2, s36, v2
  v_xor_b32 v3, 0, v4
  v_lshl_add_u32 v3, v3, 4, v2
  v_add_u32 v10, 0, v3
  v_xor_b32 v3, 4, v4
  v_lshl_add_u32 v3, v3, 4, v2
  v_add_u32 v11, 8192, v3
  v_xor_b32 v3, 0, v4
  v_lshl_add_u32 v3, v3, 4, v2
  v_add_u32 v12, 16384, v3
  v_xor_b32 v3, 4, v4
  v_lshl_add_u32 v3, v3, 4, v2
  v_add_u32 v13, 24576, v3
  s_lshl_b32 s42, s8, 7
  s_mov_b32 s47, 0
  s_add_u32 m0, s44, 98304
  s_add_u32 s36, s42, s47
  buffer_load_dwordx4 v10, s[24:27], s36 offen offset:0  lds
  buffer_load_dwordx4 v11, s[24:27], s36 offen offset:1024  lds
  s_waitcnt lgkmcnt(9)
  v_mfma_f32_16x16x32_bf16 v[104:107], v[184:187], v[168:171], v[104:107]
  buffer_load_dwordx4 v12, s[24:27], s36 offen offset:2048  lds
  s_waitcnt lgkmcnt(6)
  v_mfma_f32_16x16x32_bf16 v[112:115], v[184:187], v[172:175], v[112:115]
  v_mfma_f32_16x16x32_bf16 v[108:111], v[188:191], v[168:171], v[108:111]
  v_mfma_f32_16x16x32_bf16 v[116:119], v[188:191], v[172:175], v[116:119]
  s_waitcnt lgkmcnt(3)
  v_mfma_f32_16x16x32_bf16 v[120:123], v[184:187], v[176:179], v[120:123]
  buffer_load_dwordx4 v13, s[24:27], s36 offen offset:3072  lds
  v_mfma_f32_16x16x32_bf16 v[124:127], v[188:191], v[176:179], v[124:127]
  v_mfma_f32_16x16x32_bf16 v[136:139], v[192:195], v[168:171], v[136:139]
  v_mfma_f32_16x16x32_bf16 v[144:147], v[192:195], v[172:175], v[144:147]
  v_mfma_f32_16x16x32_bf16 v[152:155], v[192:195], v[176:179], v[152:155]
  s_add_u32 m0, s44, 114688
  s_add_u32 s36, s42, s47
  s_add_u32 s36, s36, 147456
  buffer_load_dwordx4 v10, s[24:27], s36 offen offset:0  lds
  s_waitcnt lgkmcnt(0)
  v_mfma_f32_16x16x32_bf16 v[128:131], v[184:187], v[180:183], v[128:131]
  v_mfma_f32_16x16x32_bf16 v[132:135], v[188:191], v[180:183], v[132:135]
  v_mfma_f32_16x16x32_bf16 v[160:163], v[192:195], v[180:183], v[160:163]
  v_mfma_f32_16x16x32_bf16 v[140:143], v[196:199], v[168:171], v[140:143]
  buffer_load_dwordx4 v11, s[24:27], s36 offen offset:1024  lds
  v_mfma_f32_16x16x32_bf16 v[148:151], v[196:199], v[172:175], v[148:151]
  v_mfma_f32_16x16x32_bf16 v[156:159], v[196:199], v[176:179], v[156:159]
  v_mfma_f32_16x16x32_bf16 v[164:167], v[196:199], v[180:183], v[164:167]
  buffer_load_dwordx4 v12, s[24:27], s36 offen offset:2048  lds
  buffer_load_dwordx4 v13, s[24:27], s36 offen offset:3072  lds
  s_add_u32 s42, s42, 128
  s_cmp_eq_u32 s42, 1152
  s_cselect_b32 s42, 0, s42
  s_add_u32 m0, s44, 65536
  s_add_u32 s36, s42, s47
  buffer_load_dwordx4 v10, s[24:27], s36 offen offset:0  lds
  buffer_load_dwordx4 v11, s[24:27], s36 offen offset:1024  lds
  buffer_load_dwordx4 v12, s[24:27], s36 offen offset:2048  lds
  buffer_load_dwordx4 v13, s[24:27], s36 offen offset:3072  lds
  s_add_u32 s36, s69, 122880
  s_and_b32 s36, s36, 0x1ffff
  s_add_u32 m0, s49, 0
  s_nop 0
  buffer_load_dwordx4 v31, s[16:19], s36 offen offset:0 nt lds
  buffer_load_dwordx4 v22, s[16:19], s36 offen offset:1024 nt lds
  s_add_u32 s36, s69, 139264
  s_and_b32 s36, s36, 0x1ffff
  s_add_u32 m0, s49, 8192
  s_add_u32 s36, s36, 131072
  s_cmp_eq_u32 s5, 0
  s_cbranch_scc1 L_t342
  buffer_load_dwordx4 v31, s[16:19], s36 offen offset:0 nt lds
L_t342:
  s_cmp_eq_u32 s5, 0
  s_cbranch_scc1 L_t343
  buffer_load_dwordx4 v22, s[16:19], s36 offen offset:1024 nt lds
L_t343:
  s_waitcnt vmcnt(20)
  s_cmp_eq_u32 s5, 0
  s_cbranch_scc0 L_w344
  s_waitcnt vmcnt(16)
L_w344:
  s_barrier
  s_add_u32 s36, s69, 8192
  s_and_b32 s36, s36, 0x1ffff
  s_add_u32 s36, s36, s68
  s_add_u32 m0, s49, 16384
  s_nop 0
  buffer_load_dwordx4 v29, s[12:15], s36 offen offset:0 nt lds
  buffer_load_dwordx4 v30, s[12:15], s36 offen offset:1024 nt lds
  s_add_u32 s36, s69, 24576
  s_and_b32 s36, s36, 0x1ffff
  s_add_u32 s36, s36, s68
  s_add_u32 m0, s49, 24576
  s_add_u32 s36, s36, 131072
  s_cmp_eq_u32 s5, 0
  s_cbranch_scc1 L_t345
  buffer_load_dwordx4 v29, s[12:15], s36 offen offset:0 nt lds
L_t345:
  s_cmp_eq_u32 s5, 0
  s_cbranch_scc1 L_t346
  buffer_load_dwordx4 v30, s[12:15], s36 offen offset:1024 nt lds
L_t346:
  v_mul_f32 v104, s40, v104
  v_mul_f32 v105, s40, v105
  v_mul_f32 v106, s40, v106
  v_mul_f32 v107, s40, v107
  v_mul_f32 v108, s40, v108
  v_mul_f32 v109, s40, v109
  v_mul_f32 v110, s40, v110
  v_mul_f32 v111, s40, v111
  v_cvt_pk_bf16_f32 v104, v104, v105
  v_cvt_pk_bf16_f32 v105, v106, v107
  v_cvt_pk_bf16_f32 v106, v108, v109
  v_cvt_pk_bf16_f32 v107, v110, v111
  v_xor_b32 v2, 0, v20
  s_nop 0
  v_permlane16_swap_b32 v104, v106
  v_permlane16_swap_b32 v105, v107
  v_mul_f32 v112, s40, v112
  v_mul_f32 v113, s40, v113
  v_mul_f32 v114, s40, v114
  v_mul_f32 v115, s40, v115
  v_mul_f32 v116, s40, v116
  v_mul_f32 v117, s40, v117
  v_mul_f32 v118, s40, v118
  v_mul_f32 v119, s40, v119
  v_cvt_pk_bf16_f32 v112, v112, v113
  v_cvt_pk_bf16_f32 v113, v114, v115
  v_cvt_pk_bf16_f32 v114, v116, v117
  v_cvt_pk_bf16_f32 v115, v118, v119
  v_xor_b32 v3, 0, v20
  ds_write_b128 v2, v[104:107] offset:0
  v_permlane16_swap_b32 v112, v114
  v_permlane16_swap_b32 v113, v115
  v_mul_f32 v120, s40, v120
  v_mul_f32 v121, s40, v121
  v_mul_f32 v122, s40, v122
  v_mul_f32 v123, s40, v123
  v_mul_f32 v124, s40, v124
  v_mul_f32 v125, s40, v125
  v_mul_f32 v126, s40, v126
  v_mul_f32 v127, s40, v127
  v_cvt_pk_bf16_f32 v120, v120, v121
  v_cvt_pk_bf16_f32 v121, v122, v123
  v_cvt_pk_bf16_f32 v122, v124, v125
  v_cvt_pk_bf16_f32 v123, v126, v127
  v_xor_b32 v2, 0, v20
  ds_write_b128 v3, v[112:115] offset:4096
  v_permlane16_swap_b32 v120, v122
  v_permlane16_swap_b32 v121, v123
  v_mul_f32 v128, s40, v128
  v_mul_f32 v129, s40, v129
  v_mul_f32 v130, s40, v130
  v_mul_f32 v131, s40, v131
  v_mul_f32 v132, s40, v132
  v_mul_f32 v133, s40, v133
  v_mul_f32 v134, s40, v134
  v_mul_f32 v135, s40, v135
  v_cvt_pk_bf16_f32 v128, v128, v129
  v_cvt_pk_bf16_f32 v129, v130, v131
  v_cvt_pk_bf16_f32 v130, v132, v133
  v_cvt_pk_bf16_f32 v131, v134, v135
  v_xor_b32 v3, 0, v20
  ds_write_b128 v2, v[120:123] offset:8192
  v_permlane16_swap_b32 v128, v130
  v_permlane16_swap_b32 v129, v131
  v_mul_f32 v136, s40, v136
  v_mul_f32 v137, s40, v137
  v_mul_f32 v138, s40, v138
  v_mul_f32 v139, s40, v139
  v_mul_f32 v140, s40, v140
  v_mul_f32 v141, s40, v141
  v_mul_f32 v142, s40, v142
  v_mul_f32 v143, s40, v143
  v_cvt_pk_bf16_f32 v136, v136, v137
  v_cvt_pk_bf16_f32 v137, v138, v139
  v_cvt_pk_bf16_f32 v138, v140, v141
  v_cvt_pk_bf16_f32 v139, v142, v143
  v_xor_b32 v2, 64, v20
  ds_write_b128 v3, v[128:131] offset:12288
  v_permlane16_swap_b32 v136, v138
  v_permlane16_swap_b32 v137, v139
  v_mul_f32 v144, s40, v144
  v_mul_f32 v145, s40, v145
  v_mul_f32 v146, s40, v146
  v_mul_f32 v147, s40, v147
  v_mul_f32 v148, s40, v148
  v_mul_f32 v149, s40, v149
  v_mul_f32 v150, s40, v150
  v_mul_f32 v151, s40, v151
  v_cvt_pk_bf16_f32 v144, v144, v145
  v_cvt_pk_bf16_f32 v145, v146, v147
  v_cvt_pk_bf16_f32 v146, v148, v149
  v_cvt_pk_bf16_f32 v147, v150, v151
  v_xor_b32 v3, 64, v20
  ds_write_b128 v2, v[136:139] offset:0
  v_permlane16_swap_b32 v144, v146
  v_permlane16_swap_b32 v145, v147
  v_mul_f32 v152, s40, v152
  v_mul_f32 v153, s40, v153
  v_mul_f32 v154, s40, v154
  v_mul_f32 v155, s40, v155
  v_mul_f32 v156, s40, v156
  v_mul_f32 v157, s40, v157
  v_mul_f32 v158, s40, v158
  v_mul_f32 v159, s40, v159
  v_cvt_pk_bf16_f32 v152, v152, v153
  v_cvt_pk_bf16_f32 v153, v154, v155
  v_cvt_pk_bf16_f32 v154, v156, v157
  v_cvt_pk_bf16_f32 v155, v158, v159
  v_xor_b32 v2, 64, v20
  ds_write_b128 v3, v[144:147] offset:4096
  v_permlane16_swap_b32 v152, v154
  v_permlane16_swap_b32 v153, v155
  v_mul_f32 v160, s40, v160
  v_mul_f32 v161, s40, v161
  v_mul_f32 v162, s40, v162
  v_mul_f32 v163, s40, v163
  v_mul_f32 v164, s40, v164
  v_mul_f32 v165, s40, v165
  v_mul_f32 v166, s40, v166
  v_mul_f32 v167, s40, v167
  v_cvt_pk_bf16_f32 v160, v160, v161
  v_cvt_pk_bf16_f32 v161, v162, v163
  v_cvt_pk_bf16_f32 v162, v164, v165
  v_cvt_pk_bf16_f32 v163, v166, v167
  v_xor_b32 v3, 64, v20
  ds_write_b128 v2, v[152:155] offset:8192
  v_permlane16_swap_b32 v160, v162
  v_permlane16_swap_b32 v161, v163
  ds_write_b128 v3, v[160:163] offset:12288
  s_waitcnt lgkmcnt(0)
  s_waitcnt vmcnt(8)
  s_cmp_eq_u32 s5, 0
  s_cbranch_scc0 L_w347
  s_waitcnt vmcnt(4)
L_w347:
  s_barrier
  s_add_u32 s36, s69, 0
  s_and_b32 s36, s36, 0x1ffff
  s_add_u32 s36, s36, s68
  s_add_u32 m0, s49, 32768
  s_nop 0
  buffer_load_dwordx4 v31, s[16:19], s36 offen offset:0 nt lds
  buffer_load_dwordx4 v22, s[16:19], s36 offen offset:1024 nt lds
  s_add_u32 s36, s69, 16384
  s_and_b32 s36, s36, 0x1ffff
  s_add_u32 s36, s36, s68
  s_add_u32 m0, s49, 40960
  s_add_u32 s36, s36, 131072
  s_cmp_eq_u32 s5, 0
  s_cbranch_scc1 L_t348
  buffer_load_dwordx4 v31, s[16:19], s36 offen offset:0 nt lds
L_t348:
  s_cmp_eq_u32 s5, 0
  s_cbranch_scc1 L_t349
  buffer_load_dwordx4 v22, s[16:19], s36 offen offset:1024 nt lds
L_t349:
  s_waitcnt vmcnt(8)
  s_cmp_eq_u32 s5, 0
  s_cbranch_scc0 L_w350
  s_waitcnt vmcnt(4)
L_w350:
  s_barrier
  s_add_u32 s36, s69, 16384
  s_and_b32 s36, s36, 0x1ffff
  s_add_u32 s36, s36, s68
  s_add_u32 m0, s49, 49152
  s_nop 0
  buffer_load_dwordx4 v29, s[12:15], s36 offen offset:0 nt lds
  buffer_load_dwordx4 v30, s[12:15], s36 offen offset:1024 nt lds
  s_add_u32 s36, s69, 32768
  s_and_b32 s36, s36, 0x1ffff
  s_add_u32 s36, s36, s68
  s_add_u32 m0, s49, 57344
  s_add_u32 s36, s36, 131072
  s_cmp_eq_u32 s5, 0
  s_cbranch_scc1 L_t351
  buffer_load_dwordx4 v29, s[12:15], s36 offen offset:0 nt lds
L_t351:
  s_cmp_eq_u32 s5, 0
  s_cbranch_scc1 L_t352
  buffer_load_dwordx4 v30, s[12:15], s36 offen offset:1024 nt lds
L_t352:
  s_waitcnt vmcnt(8)
  s_cmp_eq_u32 s5, 0
  s_cbranch_scc0 L_w353
  s_waitcnt vmcnt(4)
L_w353:
  s_barrier
  v_lshrrev_b32 v2, 4, v1
  v_bfe_u32 v3, v1, 2, 2
  v_lshl_add_u32 v4, v2, 3, v3
  v_and_b32 v5, 3, v1
  v_lshlrev_b32 v5, 3, v5
  v_lshl_add_u32 v4, v4, 7, v5
  v_and_b32 v2, 1, v2
  v_lshrrev_b32 v3, 1, v3
  v_lshl_add_u32 v2, v2, 1, v3
  s_and_b32 s36, s4, 2
  v_xor_b32 v2, s36, v2
  v_lshl_add_u32 v14, v2, 5, v4
  v_xor_b32 v15, 32, v14
  v_add_u32 v16, 65536, v14
  v_add_u32 v17, 65536, v15
  v_add_u32 v18, 65536, v16
  v_add_u32 v19, 65536, v17
  s_add_u32 m0, s44, 81920
  s_add_u32 s36, s42, s47
  s_add_u32 s36, s36, 147456
  buffer_load_dwordx4 v10, s[24:27], s36 offen offset:0  lds
  buffer_load_dwordx4 v11, s[24:27], s36 offen offset:1024  lds
  buffer_load_dwordx4 v12, s[24:27], s36 offen offset:2048  lds
  buffer_load_dwordx4 v13, s[24:27], s36 offen offset:3072  lds
  s_add_u32 s42, s42, 128
  s_cmp_eq_u32 s42, 1152
  s_cselect_b32 s42, 0, s42
  s_add_u32 s36, s69, 8192
  s_and_b32 s36, s36, 0x1ffff
  s_add_u32 s36, s36, s68
  s_add_u32 m0, s49, 0
  s_nop 0
  buffer_load_dwordx4 v31, s[16:19], s36 offen offset:0 nt lds
  buffer_load_dwordx4 v22, s[16:19], s36 offen offset:1024 nt lds
  s_add_u32 s36, s69, 24576
  s_and_b32 s36, s36, 0x1ffff
  s_add_u32 s36, s36, s68
  s_add_u32 m0, s49, 8192
  s_add_u32 s36, s36, 131072
  s_cmp_eq_u32 s5, 0
  s_cbranch_scc1 L_t354
  buffer_load_dwordx4 v31, s[16:19], s36 offen offset:0 nt lds
L_t354:
  s_cmp_eq_u32 s5, 0
  s_cbranch_scc1 L_t355
  buffer_load_dwordx4 v22, s[16:19], s36 offen offset:1024 nt lds
L_t355:
  s_lshl_b32 s36, s6, 2
  s_add_u32 s36, s36, s4
  s_mul_i32 s36, s36, 4608
  s_add_u32 s36, s36, 294912
  v_lshlrev_b32 v2, 7, v1
  s_mov_b32 exec_hi, 15
  buffer_load_dword v0, v2, s[24:27], s36 offen
  s_mov_b32 exec_hi, -1
L_pf356:
  s_waitcnt vmcnt(13)
  s_cmp_eq_u32 s5, 0
  s_cbranch_scc0 L_w357
  s_waitcnt vmcnt(9)
L_w357:
  s_barrier
  v_xor_b32 v25, 0, v21
  v_xor_b32 v26, 64, v21
  v_xor_b32 v27, 128, v21
  v_xor_b32 v28, 192, v21
  ds_read_b128 v[176:179], v25 offset:0
  ds_read_b128 v[180:183], v25 offset:4096
  ds_read_b128 v[184:187], v26 offset:0
  ds_read_b128 v[188:191], v26 offset:4096
  ds_read_b128 v[192:195], v27 offset:0
  ds_read_b128 v[196:199], v27 offset:4096
  ds_read_b128 v[200:203], v28 offset:0
  ds_read_b128 v[204:207], v28 offset:4096
  ds_read_b128 v[208:211], v25 offset:16384
  ds_read_b128 v[212:215], v25 offset:20480
  ds_read_b128 v[216:219], v26 offset:16384
  ds_read_b128 v[220:223], v26 offset:20480
  ds_read_b128 v[224:227], v27 offset:16384
  ds_read_b128 v[228:231], v27 offset:20480
  ds_read_b128 v[232:235], v28 offset:16384
  s_waitcnt lgkmcnt(14)
  ds_read_b128 v[236:239], v28 offset:20480
  s_waitcnt lgkmcnt(0)
  ds_read_b64_tr_b16 v[240:241], v16 offset:32768
  ds_read_b64_tr_b16 v[242:243], v16 offset:33280
  ds_read_b64_tr_b16 v[244:245], v17 offset:32768
  ds_read_b64_tr_b16 v[246:247], v17 offset:33280
  ds_read_b64_tr_b16 v[248:249], v16 offset:36864
  ds_read_b64_tr_b16 v[250:251], v16 offset:37376
  ds_read_b64_tr_b16 v[252:253], v17 offset:36864
  ds_read_b64_tr_b16 v[254:255], v17 offset:37376
  s_add_u32 s36, s69, 24576
  s_and_b32 s36, s36, 0x1ffff
  s_add_u32 s36, s36, s68
  s_add_u32 m0, s49, 16384
  s_nop 0
  buffer_load_dwordx4 v29, s[12:15], s36 offen offset:0 nt lds
  buffer_load_dwordx4 v30, s[12:15], s36 offen offset:1024 nt lds
  s_waitcnt lgkmcnt(6)
  v_mfma_f32_16x16x32_bf16 v[32:35], v[240:243], v[176:179], 0
  s_add_u32 s36, s69, 40960
  s_and_b32 s36, s36, 0x1ffff
  s_add_u32 s36, s36, s68
  s_add_u32 m0, s49, 24576
  s_add_u32 s36, s36, 131072
  s_cmp_eq_u32 s5, 0
  s_cbranch_scc1 L_t358
  buffer_load_dwordx4 v29, s[12:15], s36 offen offset:0 nt lds
L_t358:
  ds_read_b64_tr_b16 v[6:7], v16 offset:40960
  v_mfma_f32_16x16x32_bf16 v[40:43], v[240:243], v[180:183], 0
  ds_read_b64_tr_b16 v[8:9], v16 offset:41472
  s_waitcnt lgkmcnt(6)
  v_mfma_f32_16x16x32_bf16 v[36:39], v[244:247], v[176:179], 0
  ds_read_b64_tr_b16 v[240:241], v17 offset:40960
  v_mfma_f32_16x16x32_bf16 v[44:47], v[244:247], v[180:183], 0
  ds_read_b64_tr_b16 v[242:243], v17 offset:41472
  s_waitcnt lgkmcnt(6)
  v_mfma_f32_16x16x32_bf16 v[32:35], v[248:251], v[184:187], v[32:35]
  s_cmp_eq_u32 s5, 0
  s_cbranch_scc1 L_t359
  buffer_load_dwordx4 v30, s[12:15], s36 offen offset:1024 nt lds
L_t359:
  ds_read_b64_tr_b16 v[244:245], v16 offset:45056
  v_mfma_f32_16x16x32_bf16 v[40:43], v[248:251], v[188:191], v[40:43]
  ds_read_b64_tr_b16 v[246:247], v16 offset:45568
  s_waitcnt lgkmcnt(6)
  v_mfma_f32_16x16x32_bf16 v[36:39], v[252:255], v[184:187], v[36:39]
  ds_read_b64_tr_b16 v[248:249], v17 offset:45056
  v_mfma_f32_16x16x32_bf16 v[44:47], v[252:255], v[188:191], v[44:47]
  ds_read_b64_tr_b16 v[250:251], v17 offset:45568
  s_waitcnt lgkmcnt(6)
  v_mfma_f32_16x16x32_bf16 v[32:35], v[6:9], v[192:195], v[32:35]
  v_mfma_f32_16x16x32_bf16 v[40:43], v[6:9], v[196:199], v[40:43]
  s_waitcnt lgkmcnt(4)
  v_mfma_f32_16x16x32_bf16 v[36:39], v[240:243], v[192:195], v[36:39]
  v_mfma_f32_16x16x32_bf16 v[44:47], v[240:243], v[196:199], v[44:47]
  s_waitcnt lgkmcnt(2)
  v_mfma_f32_16x16x32_bf16 v[32:35], v[244:247], v[200:203], v[32:35]
  v_mfma_f32_16x16x32_bf16 v[40:43], v[244:247], v[204:207], v[40:43]
  s_waitcnt lgkmcnt(0)
  v_mfma_f32_16x16x32_bf16 v[36:39], v[248:251], v[200:203], v[36:39]
  v_mfma_f32_16x16x32_bf16 v[44:47], v[248:251], v[204:207], v[44:47]
  s_waitcnt vmcnt(9)
  s_cmp_eq_u32 s5, 0
  s_cbranch_scc0 L_w360
  s_waitcnt vmcnt(5)
L_w360:
  s_barrier
  s_add_u32 s36, s69, 16384
  s_and_b32 s36, s36, 0x1ffff
  s_add_u32 s36, s36, s68
  s_add_u32 m0, s49, 32768
  s_nop 0
  buffer_load_dwordx4 v31, s[16:19], s36 offen offset:0 nt lds
  buffer_load_dwordx4 v22, s[16:19], s36 offen offset:1024 nt lds
  s_add_u32 s36, s69, 32768
  s_and_b32 s36, s36, 0x1ffff
  s_add_u32 s36, s36, s68
  s_add_u32 m0, s49, 40960
  s_add_u32 s36, s36, 131072
  s_cmp_eq_u32 s5, 0
  s_cbranch_scc1 L_t361
  buffer_load_dwordx4 v31, s[16:19], s36 offen offset:0 nt lds
L_t361:
  s_cmp_eq_u32 s5, 0
  s_cbranch_scc1 L_t362
  buffer_load_dwordx4 v22, s[16:19], s36 offen offset:1024 nt lds
L_t362:
  s_waitcnt vmcnt(9)
  s_cmp_eq_u32 s5, 0
  s_cbranch_scc0 L_w363
  s_waitcnt vmcnt(5)
L_w363:
  s_barrier
  ds_read_b64_tr_b16 v[252:253], v16 offset:49152
  ds_read_b64_tr_b16 v[254:255], v16 offset:49664
  ds_read_b64_tr_b16 v[6:7], v17 offset:49152
  ds_read_b64_tr_b16 v[8:9], v17 offset:49664
  ds_read_b64_tr_b16 v[240:241], v16 offset:53248
  ds_read_b64_tr_b16 v[242:243], v16 offset:53760
  ds_read_b64_tr_b16 v[244:245], v17 offset:53248
  ds_read_b64_tr_b16 v[246:247], v17 offset:53760
  s_add_u32 s36, s69, 32768
  s_and_b32 s36, s36, 0x1ffff
  s_add_u32 s36, s36, s68
  s_add_u32 m0, s49, 49152
  s_nop 0
  buffer_load_dwordx4 v29, s[12:15], s36 offen offset:0 nt lds
  buffer_load_dwordx4 v30, s[12:15], s36 offen offset:1024 nt lds
  s_waitcnt lgkmcnt(6)
  v_mfma_f32_16x16x32_bf16 v[32:35], v[252:255], v[208:211], v[32:35]
  s_add_u32 s36, s69, 49152
  s_and_b32 s36, s36, 0x1ffff
  s_add_u32 s36, s36, s68
  s_add_u32 m0, s49, 57344
  s_add_u32 s36, s36, 131072
  s_cmp_eq_u32 s5, 0
  s_cbranch_scc1 L_t364
  buffer_load_dwordx4 v29, s[12:15], s36 offen offset:0 nt lds
L_t364:
  ds_read_b64_tr_b16 v[248:249], v16 offset:57344
  v_mfma_f32_16x16x32_bf16 v[40:43], v[252:255], v[212:215], v[40:43]
  ds_read_b64_tr_b16 v[250:251], v16 offset:57856
  s_waitcnt lgkmcnt(6)
  v_mfma_f32_16x16x32_bf16 v[36:39], v[6:9], v[208:211], v[36:39]
  ds_read_b64_tr_b16 v[252:253], v17 offset:57344
  v_mfma_f32_16x16x32_bf16 v[44:47], v[6:9], v[212:215], v[44:47]
  ds_read_b64_tr_b16 v[254:255], v17 offset:57856
  s_waitcnt lgkmcnt(6)
  v_mfma_f32_16x16x32_bf16 v[32:35], v[240:243], v[216:219], v[32:35]
  s_cmp_eq_u32 s5, 0
  s_cbranch_scc1 L_t365
  buffer_load_dwordx4 v30, s[12:15], s36 offen offset:1024 nt lds
L_t365:
  ds_read_b64_tr_b16 v[6:7], v16 offset:61440
  v_mfma_f32_16x16x32_bf16 v[40:43], v[240:243], v[220:223], v[40:43]
  ds_read_b64_tr_b16 v[8:9], v16 offset:61952
  s_waitcnt lgkmcnt(6)
  v_mfma_f32_16x16x32_bf16 v[36:39], v[244:247], v[216:219], v[36:39]
  ds_read_b64_tr_b16 v[240:241], v17 offset:61440
  v_mfma_f32_16x16x32_bf16 v[44:47], v[244:247], v[220:223], v[44:47]
  ds_read_b64_tr_b16 v[242:243], v17 offset:61952
  s_waitcnt lgkmcnt(6)
  v_mfma_f32_16x16x32_bf16 v[32:35], v[248:251], v[224:227], v[32:35]
  v_mfma_f32_16x16x32_bf16 v[40:43], v[248:251], v[228:231], v[40:43]
  s_waitcnt lgkmcnt(4)
  v_mfma_f32_16x16x32_bf16 v[36:39], v[252:255], v[224:227], v[36:39]
  v_mfma_f32_16x16x32_bf16 v[44:47], v[252:255], v[228:231], v[44:47]
  s_waitcnt lgkmcnt(2)
  v_mfma_f32_16x16x32_bf16 v[32:35], v[6:9], v[232:235], v[32:35]
  v_mfma_f32_16x16x32_bf16 v[40:43], v[6:9], v[236:239], v[40:43]
  s_waitcnt lgkmcnt(0)
  v_mfma_f32_16x16x32_bf16 v[36:39], v[240:243], v[232:235], v[36:39]
  v_mfma_f32_16x16x32_bf16 v[44:47], v[240:243], v[236:239], v[44:47]
  s_waitcnt vmcnt(8)
  s_cmp_eq_u32 s5, 0
  s_cbranch_scc0 L_w366
  s_waitcnt vmcnt(4)
L_w366:
  s_barrier
  s_add_u32 m0, s44, 98304
  s_add_u32 s36, s42, s47
  buffer_load_dwordx4 v10, s[24:27], s36 offen offset:0  lds
  buffer_load_dwordx4 v11, s[24:27], s36 offen offset:1024  lds
  buffer_load_dwordx4 v12, s[24:27], s36 offen offset:2048  lds
  buffer_load_dwordx4 v13, s[24:27], s36 offen offset:3072  lds
  s_add_u32 m0, s44, 114688
  s_add_u32 s36, s42, s47
  s_add_u32 s36, s36, 147456
  buffer_load_dwordx4 v10, s[24:27], s36 offen offset:0  lds
  buffer_load_dwordx4 v11, s[24:27], s36 offen offset:1024  lds
  buffer_load_dwordx4 v12, s[24:27], s36 offen offset:2048  lds
  buffer_load_dwordx4 v13, s[24:27], s36 offen offset:3072  lds
  s_add_u32 s42, s42, 128
  s_cmp_eq_u32 s42, 1152
  s_cselect_b32 s42, 0, s42
  s_add_u32 s36, s69, 24576
  s_and_b32 s36, s36, 0x1ffff
  s_add_u32 s36, s36, s68
  s_add_u32 m0, s49, 0
  s_nop 0
  buffer_load_dwordx4 v31, s[16:19], s36 offen offset:0 nt lds
  buffer_load_dwordx4 v22, s[16:19], s36 offen offset:1024 nt lds
  s_add_u32 s36, s69, 40960
  s_and_b32 s36, s36, 0x1ffff
  s_add_u32 s36, s36, s68
  s_add_u32 m0, s49, 8192
  s_add_u32 s36, s36, 131072
  s_cmp_eq_u32 s5, 0
  s_cbranch_scc1 L_t367
  buffer_load_dwordx4 v31, s[16:19], s36 offen offset:0 nt lds
L_t367:
  s_cmp_eq_u32 s5, 0
  s_cbranch_scc1 L_t368
  buffer_load_dwordx4 v22, s[16:19], s36 offen offset:1024 nt lds
L_t368:
  s_waitcnt vmcnt(16)
  s_cmp_eq_u32 s5, 0
  s_cbranch_scc0 L_w369
  s_waitcnt vmcnt(12)
L_w369:
  s_barrier
  ds_read_b64_tr_b16 v[240:241], v16 offset:0
  ds_read_b64_tr_b16 v[242:243], v16 offset:512
  ds_read_b64_tr_b16 v[244:245], v17 offset:0
  ds_read_b64_tr_b16 v[246:247], v17 offset:512
  ds_read_b64_tr_b16 v[248:249], v16 offset:4096
  ds_read_b64_tr_b16 v[250:251], v16 offset:4608
  ds_read_b64_tr_b16 v[252:253], v17 offset:4096
  ds_read_b64_tr_b16 v[254:255], v17 offset:4608
  s_add_u32 s36, s69, 40960
  s_and_b32 s36, s36, 0x1ffff
  s_add_u32 s36, s36, s68
  s_add_u32 m0, s49, 16384
  s_nop 0
  buffer_load_dwordx4 v29, s[12:15], s36 offen offset:0 nt lds
  buffer_load_dwordx4 v30, s[12:15], s36 offen offset:1024 nt lds
  s_waitcnt lgkmcnt(6)
  v_mfma_f32_16x16x32_bf16 v[48:51], v[240:243], v[176:179], 0
  s_add_u32 s36, s69, 57344
  s_and_b32 s36, s36, 0x1ffff
  s_add_u32 s36, s36, s68
  s_add_u32 m0, s49, 24576
  s_add_u32 s36, s36, 131072
  s_cmp_eq_u32 s5, 0
  s_cbranch_scc1 L_t370
  buffer_load_dwordx4 v29, s[12:15], s36 offen offset:0 nt lds
L_t370:
  ds_read_b64_tr_b16 v[6:7], v16 offset:8192
  v_mfma_f32_16x16x32_bf16 v[56:59], v[240:243], v[180:183], 0
  ds_read_b64_tr_b16 v[8:9], v16 offset:8704
  s_waitcnt lgkmcnt(6)
  v_mfma_f32_16x16x32_bf16 v[52:55], v[244:247], v[176:179], 0
  ds_read_b64_tr_b16 v[240:241], v17 offset:8192
  v_mfma_f32_16x16x32_bf16 v[60:63], v[244:247], v[180:183], 0
  ds_read_b64_tr_b16 v[242:243], v17 offset:8704
  s_waitcnt lgkmcnt(6)
  v_mfma_f32_16x16x32_bf16 v[48:51], v[248:251], v[184:187], v[48:51]
  s_cmp_eq_u32 s5, 0
  s_cbranch_scc1 L_t371
  buffer_load_dwordx4 v30, s[12:15], s36 offen offset:1024 nt lds
L_t371:
  ds_read_b64_tr_b16 v[244:245], v16 offset:12288
  v_mfma_f32_16x16x32_bf16 v[56:59], v[248:251], v[188:191], v[56:59]
  ds_read_b64_tr_b16 v[246:247], v16 offset:12800
  s_waitcnt lgkmcnt(6)
  v_mfma_f32_16x16x32_bf16 v[52:55], v[252:255], v[184:187], v[52:55]
  ds_read_b64_tr_b16 v[248:249], v17 offset:12288
  v_mfma_f32_16x16x32_bf16 v[60:63], v[252:255], v[188:191], v[60:63]
  ds_read_b64_tr_b16 v[250:251], v17 offset:12800
  s_waitcnt lgkmcnt(6)
  v_mfma_f32_16x16x32_bf16 v[48:51], v[6:9], v[192:195], v[48:51]
  v_mfma_f32_16x16x32_bf16 v[56:59], v[6:9], v[196:199], v[56:59]
  s_waitcnt lgkmcnt(4)
  v_mfma_f32_16x16x32_bf16 v[52:55], v[240:243], v[192:195], v[52:55]
  v_mfma_f32_16x16x32_bf16 v[60:63], v[240:243], v[196:199], v[60:63]
  s_waitcnt lgkmcnt(2)
  v_mfma_f32_16x16x32_bf16 v[48:51], v[244:247], v[200:203], v[48:51]
  v_mfma_f32_16x16x32_bf16 v[56:59], v[244:247], v[204:207], v[56:59]
  s_waitcnt lgkmcnt(0)
  v_mfma_f32_16x16x32_bf16 v[52:55], v[248:251], v[200:203], v[52:55]
  v_mfma_f32_16x16x32_bf16 v[60:63], v[248:251], v[204:207], v[60:63]
  s_waitcnt vmcnt(8)
  s_cmp_eq_u32 s5, 0
  s_cbranch_scc0 L_w372
  s_waitcnt vmcnt(2)
L_w372:
  s_barrier
  ds_read_b64_tr_b16 v[252:253], v16 offset:16384
  ds_read_b64_tr_b16 v[254:255], v16 offset:16896
  ds_read_b64_tr_b16 v[6:7], v17 offset:16384
  ds_read_b64_tr_b16 v[8:9], v17 offset:16896
  ds_read_b64_tr_b16 v[240:241], v16 offset:20480
  ds_read_b64_tr_b16 v[242:243], v16 offset:20992
  ds_read_b64_tr_b16 v[244:245], v17 offset:20480
  ds_read_b64_tr_b16 v[246:247], v17 offset:20992
  s_add_u32 s36, s69, 32768
  s_and_b32 s36, s36, 0x1ffff
  s_add_u32 s36, s36, s68
  s_add_u32 m0, s49, 32768
  s_nop 0
  buffer_load_dwordx4 v31, s[16:19], s36 offen offset:0 nt lds
  buffer_load_dwordx4 v22, s[16:19], s36 offen offset:1024 nt lds
  s_waitcnt lgkmcnt(6)
  v_mfma_f32_16x16x32_bf16 v[48:51], v[252:255], v[208:211], v[48:51]
  s_add_u32 s36, s69, 49152
  s_and_b32 s36, s36, 0x1ffff
  s_add_u32 s36, s36, s68
  s_add_u32 m0, s49, 40960
  s_add_u32 s36, s36, 131072
  s_cmp_eq_u32 s5, 0
  s_cbranch_scc1 L_t373
  buffer_load_dwordx4 v31, s[16:19], s36 offen offset:0 nt lds
L_t373:
  ds_read_b64_tr_b16 v[248:249], v16 offset:24576
  v_mfma_f32_16x16x32_bf16 v[56:59], v[252:255], v[212:215], v[56:59]
  ds_read_b64_tr_b16 v[250:251], v16 offset:25088
  s_waitcnt lgkmcnt(6)
  v_mfma_f32_16x16x32_bf16 v[52:55], v[6:9], v[208:211], v[52:55]
  ds_read_b64_tr_b16 v[252:253], v17 offset:24576
  v_mfma_f32_16x16x32_bf16 v[60:63], v[6:9], v[212:215], v[60:63]
  ds_read_b64_tr_b16 v[254:255], v17 offset:25088
  s_waitcnt lgkmcnt(6)
  v_mfma_f32_16x16x32_bf16 v[48:51], v[240:243], v[216:219], v[48:51]
  s_cmp_eq_u32 s5, 0
  s_cbranch_scc1 L_t374
  buffer_load_dwordx4 v22, s[16:19], s36 offen offset:1024 nt lds
L_t374:
  ds_read_b64_tr_b16 v[6:7], v16 offset:28672
  v_mfma_f32_16x16x32_bf16 v[56:59], v[240:243], v[220:223], v[56:59]
  ds_read_b64_tr_b16 v[8:9], v16 offset:29184
  s_waitcnt lgkmcnt(6)
  v_mfma_f32_16x16x32_bf16 v[52:55], v[244:247], v[216:219], v[52:55]
  ds_read_b64_tr_b16 v[240:241], v17 offset:28672
  v_mfma_f32_16x16x32_bf16 v[60:63], v[244:247], v[220:223], v[60:63]
  ds_read_b64_tr_b16 v[242:243], v17 offset:29184
  s_waitcnt lgkmcnt(6)
  v_mfma_f32_16x16x32_bf16 v[48:51], v[248:251], v[224:227], v[48:51]
  v_mfma_f32_16x16x32_bf16 v[56:59], v[248:251], v[228:231], v[56:59]
  s_waitcnt lgkmcnt(4)
  v_mfma_f32_16x16x32_bf16 v[52:55], v[252:255], v[224:227], v[52:55]
  v_mfma_f32_16x16x32_bf16 v[60:63], v[252:255], v[228:231], v[60:63]
  s_waitcnt lgkmcnt(2)
  v_mfma_f32_16x16x32_bf16 v[48:51], v[6:9], v[232:235], v[48:51]
  v_mfma_f32_16x16x32_bf16 v[56:59], v[6:9], v[236:239], v[56:59]
  s_waitcnt lgkmcnt(0)
  v_mfma_f32_16x16x32_bf16 v[52:55], v[240:243], v[232:235], v[52:55]
  v_mfma_f32_16x16x32_bf16 v[60:63], v[240:243], v[236:239], v[60:63]
  s_cmp_eq_u32 s5, 1
  s_cbranch_scc0 L_w375
  s_waitcnt vmcnt(8)
L_w375:
  s_barrier
  ds_read_b64_tr_b16 v[240:241], v16 offset:32768
  ds_read_b64_tr_b16 v[242:243], v16 offset:33280
  ds_read_b64_tr_b16 v[244:245], v17 offset:32768
  ds_read_b64_tr_b16 v[246:247], v17 offset:33280
  ds_read_b64_tr_b16 v[248:249], v16 offset:36864
  ds_read_b64_tr_b16 v[250:251], v16 offset:37376
  ds_read_b64_tr_b16 v[252:253], v17 offset:36864
  ds_read_b64_tr_b16 v[254:255], v17 offset:37376
  s_add_u32 s36, s69, 49152
  s_and_b32 s36, s36, 0x1ffff
  s_add_u32 s36, s36, s68
  s_add_u32 m0, s49, 49152
  s_nop 0
  buffer_load_dwordx4 v29, s[12:15], s36 offen offset:0 nt lds
  buffer_load_dwordx4 v30, s[12:15], s36 offen offset:1024 nt lds
  s_waitcnt lgkmcnt(6)
  v_mfma_f32_16x16x32_bf16 v[64:67], v[240:243], v[176:179], 0
  s_add_u32 s36, s69, 65536
  s_and_b32 s36, s36, 0x1ffff
  s_add_u32 s36, s36, s68
  s_add_u32 m0, s49, 57344
  s_add_u32 s36, s36, 131072
  s_cmp_eq_u32 s5, 0
  s_cbranch_scc1 L_t376
  buffer_load_dwordx4 v29, s[12:15], s36 offen offset:0 nt lds
L_t376:
  ds_read_b64_tr_b16 v[6:7], v16 offset:40960
  v_mfma_f32_16x16x32_bf16 v[72:75], v[240:243], v[180:183], 0
  ds_read_b64_tr_b16 v[8:9], v16 offset:41472
  s_waitcnt lgkmcnt(6)
  v_mfma_f32_16x16x32_bf16 v[68:71], v[244:247], v[176:179], 0
  ds_read_b64_tr_b16 v[240:241], v17 offset:40960
  v_mfma_f32_16x16x32_bf16 v[76:79], v[244:247], v[180:183], 0
  ds_read_b64_tr_b16 v[242:243], v17 offset:41472
  s_waitcnt lgkmcnt(6)
  v_mfma_f32_16x16x32_bf16 v[64:67], v[248:251], v[184:187], v[64:67]
  s_cmp_eq_u32 s5, 0
  s_cbranch_scc1 L_t377
  buffer_load_dwordx4 v30, s[12:15], s36 offen offset:1024 nt lds
L_t377:
  ds_read_b64_tr_b16 v[244:245], v16 offset:45056
  v_mfma_f32_16x16x32_bf16 v[72:75], v[248:251], v[188:191], v[72:75]
  ds_read_b64_tr_b16 v[246:247], v16 offset:45568
  s_waitcnt lgkmcnt(6)
  v_mfma_f32_16x16x32_bf16 v[68:71], v[252:255], v[184:187], v[68:71]
  ds_read_b64_tr_b16 v[248:249], v17 offset:45056
  v_mfma_f32_16x16x32_bf16 v[76:79], v[252:255], v[188:191], v[76:79]
  ds_read_b64_tr_b16 v[250:251], v17 offset:45568
  s_waitcnt lgkmcnt(6)
  v_mfma_f32_16x16x32_bf16 v[64:67], v[6:9], v[192:195], v[64:67]
  v_mfma_f32_16x16x32_bf16 v[72:75], v[6:9], v[196:199], v[72:75]
  s_waitcnt lgkmcnt(4)
  v_mfma_f32_16x16x32_bf16 v[68:71], v[240:243], v[192:195], v[68:71]
  v_mfma_f32_16x16x32_bf16 v[76:79], v[240:243], v[196:199], v[76:79]
  s_waitcnt lgkmcnt(2)
  v_mfma_f32_16x16x32_bf16 v[64:67], v[244:247], v[200:203], v[64:67]
  v_mfma_f32_16x16x32_bf16 v[72:75], v[244:247], v[204:207], v[72:75]
  s_waitcnt lgkmcnt(0)
  v_mfma_f32_16x16x32_bf16 v[68:71], v[248:251], v[200:203], v[68:71]
  v_mfma_f32_16x16x32_bf16 v[76:79], v[248:251], v[204:207], v[76:79]
  s_waitcnt vmcnt(8)
  s_cmp_eq_u32 s5, 0
  s_cbranch_scc0 L_w378
  s_waitcnt vmcnt(4)
L_w378:
  s_barrier
  s_add_u32 m0, s44, 65536
  s_add_u32 s36, s42, s47
  buffer_load_dwordx4 v10, s[24:27], s36 offen offset:0  lds
  buffer_load_dwordx4 v11, s[24:27], s36 offen offset:1024  lds
  buffer_load_dwordx4 v12, s[24:27], s36 offen offset:2048  lds
  buffer_load_dwordx4 v13, s[24:27], s36 offen offset:3072  lds
  s_add_u32 m0, s44, 81920
  s_add_u32 s36, s42, s47
  s_add_u32 s36, s36, 147456
  buffer_load_dwordx4 v10, s[24:27], s36 offen offset:0  lds
  buffer_load_dwordx4 v11, s[24:27], s36 offen offset:1024  lds
  buffer_load_dwordx4 v12, s[24:27], s36 offen offset:2048  lds
  buffer_load_dwordx4 v13, s[24:27], s36 offen offset:3072  lds
  s_add_u32 s42, s42, 128
  s_cmp_eq_u32 s42, 1152
  s_cselect_b32 s42, 0, s42
  s_add_u32 m0, s44, 98304
  s_add_u32 s36, s42, s47
  buffer_load_dwordx4 v10, s[24:27], s36 offen offset:0  lds
  buffer_load_dwordx4 v11, s[24:27], s36 offen offset:1024  lds
  buffer_load_dwordx4 v12, s[24:27], s36 offen offset:2048  lds
  buffer_load_dwordx4 v13, s[24:27], s36 offen offset:3072  lds
  s_add_u32 s36, s69, 40960
  s_and_b32 s36, s36, 0x1ffff
  s_add_u32 s36, s36, s68
  s_add_u32 m0, s49, 0
  s_nop 0
  buffer_load_dwordx4 v31, s[16:19], s36 offen offset:0 nt lds
  buffer_load_dwordx4 v22, s[16:19], s36 offen offset:1024 nt lds
  s_add_u32 s36, s69, 57344
  s_and_b32 s36, s36, 0x1ffff
  s_add_u32 s36, s36, s68
  s_add_u32 m0, s49, 8192
  s_add_u32 s36, s36, 131072
  s_cmp_eq_u32 s5, 0
  s_cbranch_scc1 L_t379
  buffer_load_dwordx4 v31, s[16:19], s36 offen offset:0 nt lds
L_t379:
  s_cmp_eq_u32 s5, 0
  s_cbranch_scc1 L_t380
  buffer_load_dwordx4 v22, s[16:19], s36 offen offset:1024 nt lds
L_t380:
  s_waitcnt vmcnt(20)
  s_cmp_eq_u32 s5, 0
  s_cbranch_scc0 L_w381
  s_waitcnt vmcnt(16)
L_w381:
  s_barrier
  ds_read_b64_tr_b16 v[252:253], v16 offset:49152
  ds_read_b64_tr_b16 v[254:255], v16 offset:49664
  ds_read_b64_tr_b16 v[6:7], v17 offset:49152
  ds_read_b64_tr_b16 v[8:9], v17 offset:49664
  ds_read_b64_tr_b16 v[240:241], v16 offset:53248
  ds_read_b64_tr_b16 v[242:243], v16 offset:53760
  ds_read_b64_tr_b16 v[244:245], v17 offset:53248
  ds_read_b64_tr_b16 v[246:247], v17 offset:53760
  s_add_u32 s36, s69, 57344
  s_and_b32 s36, s36, 0x1ffff
  s_add_u32 s36, s36, s68
  s_add_u32 m0, s49, 16384
  s_nop 0
  buffer_load_dwordx4 v29, s[12:15], s36 offen offset:0 nt lds
  buffer_load_dwordx4 v30, s[12:15], s36 offen offset:1024 nt lds
  s_waitcnt lgkmcnt(6)
  v_mfma_f32_16x16x32_bf16 v[64:67], v[252:255], v[208:211], v[64:67]
  s_add_u32 s36, s69, 73728
  s_and_b32 s36, s36, 0x1ffff
  s_add_u32 s36, s36, s68
  s_add_u32 m0, s49, 24576
  s_add_u32 s36, s36, 131072
  s_cmp_eq_u32 s5, 0
  s_cbranch_scc1 L_t382
  buffer_load_dwordx4 v29, s[12:15], s36 offen offset:0 nt lds
L_t382:
  ds_read_b64_tr_b16 v[248:249], v16 offset:57344
  v_mfma_f32_16x16x32_bf16 v[72:75], v[252:255], v[212:215], v[72:75]
  ds_read_b64_tr_b16 v[250:251], v16 offset:57856
  s_waitcnt lgkmcnt(6)
  v_mfma_f32_16x16x32_bf16 v[68:71], v[6:9], v[208:211], v[68:71]
  ds_read_b64_tr_b16 v[252:253], v17 offset:57344
  v_mfma_f32_16x16x32_bf16 v[76:79], v[6:9], v[212:215], v[76:79]
  ds_read_b64_tr_b16 v[254:255], v17 offset:57856
  s_waitcnt lgkmcnt(6)
  v_mfma_f32_16x16x32_bf16 v[64:67], v[240:243], v[216:219], v[64:67]
  s_cmp_eq_u32 s5, 0
  s_cbranch_scc1 L_t383
  buffer_load_dwordx4 v30, s[12:15], s36 offen offset:1024 nt lds
L_t383:
  ds_read_b64_tr_b16 v[6:7], v16 offset:61440
  v_mfma_f32_16x16x32_bf16 v[72:75], v[240:243], v[220:223], v[72:75]
  ds_read_b64_tr_b16 v[8:9], v16 offset:61952
  s_waitcnt lgkmcnt(6)
  v_mfma_f32_16x16x32_bf16 v[68:71], v[244:247], v[216:219], v[68:71]
  ds_read_b64_tr_b16 v[240:241], v17 offset:61440
  v_mfma_f32_16x16x32_bf16 v[76:79], v[244:247], v[220:223], v[76:79]
  ds_read_b64_tr_b16 v[242:243], v17 offset:61952
  s_waitcnt lgkmcnt(6)
  v_mfma_f32_16x16x32_bf16 v[64:67], v[248:251], v[224:227], v[64:67]
  v_mfma_f32_16x16x32_bf16 v[72:75], v[248:251], v[228:231], v[72:75]
  s_waitcnt lgkmcnt(4)
  v_mfma_f32_16x16x32_bf16 v[68:71], v[252:255], v[224:227], v[68:71]
  v_mfma_f32_16x16x32_bf16 v[76:79], v[252:255], v[228:231], v[76:79]
  s_waitcnt lgkmcnt(2)
  v_mfma_f32_16x16x32_bf16 v[64:67], v[6:9], v[232:235], v[64:67]
  v_mfma_f32_16x16x32_bf16 v[72:75], v[6:9], v[236:239], v[72:75]
  s_waitcnt lgkmcnt(0)
  v_mfma_f32_16x16x32_bf16 v[68:71], v[240:243], v[232:235], v[68:71]
  v_mfma_f32_16x16x32_bf16 v[76:79], v[240:243], v[236:239], v[76:79]
  s_waitcnt vmcnt(8)
  s_cmp_eq_u32 s5, 0
  s_cbranch_scc0 L_w384
  s_waitcnt vmcnt(2)
L_w384:
  s_barrier
  ds_read_b64_tr_b16 v[240:241], v16 offset:0
  ds_read_b64_tr_b16 v[242:243], v16 offset:512
  ds_read_b64_tr_b16 v[244:245], v17 offset:0
  ds_read_b64_tr_b16 v[246:247], v17 offset:512
  ds_read_b64_tr_b16 v[248:249], v16 offset:4096
  ds_read_b64_tr_b16 v[250:251], v16 offset:4608
  ds_read_b64_tr_b16 v[252:253], v17 offset:4096
  ds_read_b64_tr_b16 v[254:255], v17 offset:4608
  s_add_u32 s36, s69, 49152
  s_and_b32 s36, s36, 0x1ffff
  s_add_u32 s36, s36, s68
  s_add_u32 m0, s49, 32768
  s_nop 0
  buffer_load_dwordx4 v31, s[16:19], s36 offen offset:0 nt lds
  buffer_load_dwordx4 v22, s[16:19], s36 offen offset:1024 nt lds
  s_waitcnt lgkmcnt(6)
  v_mfma_f32_16x16x32_bf16 v[80:83], v[240:243], v[176:179], 0
  s_add_u32 s36, s69, 65536
  s_and_b32 s36, s36, 0x1ffff
  s_add_u32 s36, s36, s68
  s_add_u32 m0, s49, 40960
  s_add_u32 s36, s36, 131072
  s_cmp_eq_u32 s5, 0
  s_cbranch_scc1 L_t385
  buffer_load_dwordx4 v31, s[16:19], s36 offen offset:0 nt lds
L_t385:
  ds_read_b64_tr_b16 v[6:7], v16 offset:8192
  v_mfma_f32_16x16x32_bf16 v[88:91], v[240:243], v[180:183], 0
  ds_read_b64_tr_b16 v[8:9], v16 offset:8704
  s_waitcnt lgkmcnt(6)
  v_mfma_f32_16x16x32_bf16 v[84:87], v[244:247], v[176:179], 0
  ds_read_b64_tr_b16 v[240:241], v17 offset:8192
  v_mfma_f32_16x16x32_bf16 v[92:95], v[244:247], v[180:183], 0
  ds_read_b64_tr_b16 v[242:243], v17 offset:8704
  s_waitcnt lgkmcnt(6)
  v_mfma_f32_16x16x32_bf16 v[80:83], v[248:251], v[184:187], v[80:83]
  s_cmp_eq_u32 s5, 0
  s_cbranch_scc1 L_t386
  buffer_load_dwordx4 v22, s[16:19], s36 offen offset:1024 nt lds
L_t386:
  ds_read_b64_tr_b16 v[244:245], v16 offset:12288
  v_mfma_f32_16x16x32_bf16 v[88:91], v[248:251], v[188:191], v[88:91]
  ds_read_b64_tr_b16 v[246:247], v16 offset:12800
  s_waitcnt lgkmcnt(6)
  v_mfma_f32_16x16x32_bf16 v[84:87], v[252:255], v[184:187], v[84:87]
  ds_read_b64_tr_b16 v[248:249], v17 offset:12288
  v_mfma_f32_16x16x32_bf16 v[92:95], v[252:255], v[188:191], v[92:95]
  ds_read_b64_tr_b16 v[250:251], v17 offset:12800
  s_waitcnt lgkmcnt(6)
  v_mfma_f32_16x16x32_bf16 v[80:83], v[6:9], v[192:195], v[80:83]
  v_mfma_f32_16x16x32_bf16 v[88:91], v[6:9], v[196:199], v[88:91]
  s_waitcnt lgkmcnt(4)
  v_mfma_f32_16x16x32_bf16 v[84:87], v[240:243], v[192:195], v[84:87]
  v_mfma_f32_16x16x32_bf16 v[92:95], v[240:243], v[196:199], v[92:95]
  s_waitcnt lgkmcnt(2)
  v_mfma_f32_16x16x32_bf16 v[80:83], v[244:247], v[200:203], v[80:83]
  v_mfma_f32_16x16x32_bf16 v[88:91], v[244:247], v[204:207], v[88:91]
  s_waitcnt lgkmcnt(0)
  v_mfma_f32_16x16x32_bf16 v[84:87], v[248:251], v[200:203], v[84:87]
  v_mfma_f32_16x16x32_bf16 v[92:95], v[248:251], v[204:207], v[92:95]
  s_cmp_eq_u32 s5, 1
  s_cbranch_scc0 L_w387
  s_waitcnt vmcnt(8)
L_w387:
  s_barrier
  ds_read_b64_tr_b16 v[252:253], v16 offset:16384
  ds_read_b64_tr_b16 v[254:255], v16 offset:16896
  ds_read_b64_tr_b16 v[6:7], v17 offset:16384
  ds_read_b64_tr_b16 v[8:9], v17 offset:16896
  ds_read_b64_tr_b16 v[240:241], v16 offset:20480
  ds_read_b64_tr_b16 v[242:243], v16 offset:20992
  ds_read_b64_tr_b16 v[244:245], v17 offset:20480
  ds_read_b64_tr_b16 v[246:247], v17 offset:20992
  s_add_u32 s36, s69, 65536
  s_and_b32 s36, s36, 0x1ffff
  s_add_u32 s36, s36, s68
  s_add_u32 m0, s49, 49152
  s_nop 0
  buffer_load_dwordx4 v29, s[12:15], s36 offen offset:0 nt lds
  buffer_load_dwordx4 v30, s[12:15], s36 offen offset:1024 nt lds
  s_waitcnt lgkmcnt(6)
  v_mfma_f32_16x16x32_bf16 v[80:83], v[252:255], v[208:211], v[80:83]
  s_add_u32 s36, s69, 81920
  s_and_b32 s36, s36, 0x1ffff
  s_add_u32 s36, s36, s68
  s_add_u32 m0, s49, 57344
  s_add_u32 s36, s36, 131072
  s_cmp_eq_u32 s5, 0
  s_cbranch_scc1 L_t388
  buffer_load_dwordx4 v29, s[12:15], s36 offen offset:0 nt lds
L_t388:
  ds_read_b64_tr_b16 v[248:249], v16 offset:24576
  v_mfma_f32_16x16x32_bf16 v[88:91], v[252:255], v[212:215], v[88:91]
  ds_read_b64_tr_b16 v[250:251], v16 offset:25088
  s_waitcnt lgkmcnt(6)
  v_mfma_f32_16x16x32_bf16 v[84:87], v[6:9], v[208:211], v[84:87]
  ds_read_b64_tr_b16 v[252:253], v17 offset:24576
  v_mfma_f32_16x16x32_bf16 v[92:95], v[6:9], v[212:215], v[92:95]
  ds_read_b64_tr_b16 v[254:255], v17 offset:25088
  s_waitcnt lgkmcnt(6)
  v_mfma_f32_16x16x32_bf16 v[80:83], v[240:243], v[216:219], v[80:83]
  s_cmp_eq_u32 s5, 0
  s_cbranch_scc1 L_t389
  buffer_load_dwordx4 v30, s[12:15], s36 offen offset:1024 nt lds
L_t389:
  ds_read_b64_tr_b16 v[6:7], v16 offset:28672
  v_mfma_f32_16x16x32_bf16 v[88:91], v[240:243], v[220:223], v[88:91]
  ds_read_b64_tr_b16 v[8:9], v16 offset:29184
  s_waitcnt lgkmcnt(6)
  v_mfma_f32_16x16x32_bf16 v[84:87], v[244:247], v[216:219], v[84:87]
  ds_read_b64_tr_b16 v[240:241], v17 offset:28672
  v_mfma_f32_16x16x32_bf16 v[92:95], v[244:247], v[220:223], v[92:95]
  ds_read_b64_tr_b16 v[242:243], v17 offset:29184
  s_waitcnt lgkmcnt(6)
  v_mfma_f32_16x16x32_bf16 v[80:83], v[248:251], v[224:227], v[80:83]
  v_mfma_f32_16x16x32_bf16 v[88:91], v[248:251], v[228:231], v[88:91]
  s_waitcnt lgkmcnt(4)
  v_mfma_f32_16x16x32_bf16 v[84:87], v[252:255], v[224:227], v[84:87]
  v_mfma_f32_16x16x32_bf16 v[92:95], v[252:255], v[228:231], v[92:95]
  s_waitcnt lgkmcnt(2)
  v_mfma_f32_16x16x32_bf16 v[80:83], v[6:9], v[232:235], v[80:83]
  v_mfma_f32_16x16x32_bf16 v[88:91], v[6:9], v[236:239], v[88:91]
  s_waitcnt lgkmcnt(0)
  v_mfma_f32_16x16x32_bf16 v[84:87], v[240:243], v[232:235], v[84:87]
  v_mfma_f32_16x16x32_bf16 v[92:95], v[240:243], v[236:239], v[92:95]
  s_waitcnt vmcnt(8)
  s_cmp_eq_u32 s5, 0
  s_cbranch_scc0 L_w390
  s_waitcnt vmcnt(4)
L_w390:
  s_barrier
  s_add_u32 m0, s44, 114688
  s_add_u32 s36, s42, s47
  s_add_u32 s36, s36, 147456
  buffer_load_dwordx4 v10, s[24:27], s36 offen offset:0  lds
  buffer_load_dwordx4 v11, s[24:27], s36 offen offset:1024  lds
  buffer_load_dwordx4 v12, s[24:27], s36 offen offset:2048  lds
  buffer_load_dwordx4 v13, s[24:27], s36 offen offset:3072  lds
  s_add_u32 s42, s42, 128
  s_cmp_eq_u32 s42, 1152
  s_cselect_b32 s42, 0, s42
  s_add_u32 m0, s44, 65536
  s_add_u32 s36, s42, s47
  buffer_load_dwordx4 v10, s[24:27], s36 offen offset:0  lds
  buffer_load_dwordx4 v11, s[24:27], s36 offen offset:1024  lds
  buffer_load_dwordx4 v12, s[24:27], s36 offen offset:2048  lds
  buffer_load_dwordx4 v13, s[24:27], s36 offen offset:3072  lds
  s_add_u32 m0, s44, 81920
  s_add_u32 s36, s42, s47
  s_add_u32 s36, s36, 147456
  buffer_load_dwordx4 v10, s[24:27], s36 offen offset:0  lds
  buffer_load_dwordx4 v11, s[24:27], s36 offen offset:1024  lds
  buffer_load_dwordx4 v12, s[24:27], s36 offen offset:2048  lds
  buffer_load_dwordx4 v13, s[24:27], s36 offen offset:3072  lds
  s_add_u32 s42, s42, 128
  s_cmp_eq_u32 s42, 1152
  s_cselect_b32 s42, 0, s42
  s_add_u32 s36, s69, 57344
  s_and_b32 s36, s36, 0x1ffff
  s_add_u32 s36, s36, s68
  s_add_u32 m0, s49, 0
  s_nop 0
  buffer_load_dwordx4 v31, s[16:19], s36 offen offset:0 nt lds
  buffer_load_dwordx4 v22, s[16:19], s36 offen offset:1024 nt lds
  s_add_u32 s36, s69, 73728
  s_and_b32 s36, s36, 0x1ffff
  s_add_u32 s36, s36, s68
  s_add_u32 m0, s49, 8192
  s_add_u32 s36, s36, 131072
  s_cmp_eq_u32 s5, 0
  s_cbranch_scc1 L_t391
  buffer_load_dwordx4 v31, s[16:19], s36 offen offset:0 nt lds
L_t391:
  s_cmp_eq_u32 s5, 0
  s_cbranch_scc1 L_t392
  buffer_load_dwordx4 v22, s[16:19], s36 offen offset:1024 nt lds
L_t392:
  s_waitcnt vmcnt(20)
  s_cmp_eq_u32 s5, 0
  s_cbranch_scc0 L_w393
  s_waitcnt vmcnt(16)
L_w393:
  s_barrier
  s_add_u32 s36, s69, 73728
  s_and_b32 s36, s36, 0x1ffff
  s_add_u32 s36, s36, s68
  s_add_u32 m0, s49, 16384
  s_nop 0
  buffer_load_dwordx4 v29, s[12:15], s36 offen offset:0 nt lds
  buffer_load_dwordx4 v30, s[12:15], s36 offen offset:1024 nt lds
  s_add_u32 s36, s69, 90112
  s_and_b32 s36, s36, 0x1ffff
  s_add_u32 s36, s36, s68
  s_add_u32 m0, s49, 24576
  s_add_u32 s36, s36, 131072
  s_cmp_eq_u32 s5, 0
  s_cbranch_scc1 L_t394
  buffer_load_dwordx4 v29, s[12:15], s36 offen offset:0 nt lds
L_t394:
  s_cmp_eq_u32 s5, 0
  s_cbranch_scc1 L_t395
  buffer_load_dwordx4 v30, s[12:15], s36 offen offset:1024 nt lds
L_t395:
  s_waitcnt vmcnt(8)
  s_cmp_eq_u32 s5, 0
  s_cbranch_scc0 L_w396
  s_waitcnt vmcnt(2)
L_w396:
  s_barrier
  ds_read_b64_tr_b16 v[240:241], v16 offset:32768
  ds_read_b64_tr_b16 v[242:243], v16 offset:33280
  ds_read_b64_tr_b16 v[244:245], v17 offset:32768
  ds_read_b64_tr_b16 v[246:247], v17 offset:33280
  ds_read_b64_tr_b16 v[248:249], v16 offset:36864
  ds_read_b64_tr_b16 v[250:251], v16 offset:37376
  ds_read_b64_tr_b16 v[252:253], v17 offset:36864
  ds_read_b64_tr_b16 v[254:255], v17 offset:37376
  s_add_u32 s36, s69, 65536
  s_and_b32 s36, s36, 0x1ffff
  s_add_u32 s36, s36, s68
  s_add_u32 m0, s49, 32768
  s_nop 0
  buffer_load_dwordx4 v31, s[16:19], s36 offen offset:0 nt lds
  buffer_load_dwordx4 v22, s[16:19], s36 offen offset:1024 nt lds
  s_waitcnt lgkmcnt(6)
  v_mfma_f32_16x16x32_bf16 v[96:99], v[240:243], v[176:179], 0
  s_add_u32 s36, s69, 81920
  s_and_b32 s36, s36, 0x1ffff
  s_add_u32 s36, s36, s68
  s_add_u32 m0, s49, 40960
  s_add_u32 s36, s36, 131072
  s_cmp_eq_u32 s5, 0
  s_cbranch_scc1 L_t397
  buffer_load_dwordx4 v31, s[16:19], s36 offen offset:0 nt lds
L_t397:
  ds_read_b64_tr_b16 v[6:7], v16 offset:40960
  v_mfma_f32_16x16x32_bf16 v[104:107], v[240:243], v[180:183], 0
  ds_read_b64_tr_b16 v[8:9], v16 offset:41472
  s_waitcnt lgkmcnt(6)
  v_mfma_f32_16x16x32_bf16 v[100:103], v[244:247], v[176:179], 0
  ds_read_b64_tr_b16 v[240:241], v17 offset:40960
  v_mfma_f32_16x16x32_bf16 v[108:111], v[244:247], v[180:183], 0
  ds_read_b64_tr_b16 v[242:243], v17 offset:41472
  s_waitcnt lgkmcnt(6)
  v_mfma_f32_16x16x32_bf16 v[96:99], v[248:251], v[184:187], v[96:99]
  s_cmp_eq_u32 s5, 0
  s_cbranch_scc1 L_t398
  buffer_load_dwordx4 v22, s[16:19], s36 offen offset:1024 nt lds
L_t398:
  ds_read_b64_tr_b16 v[244:245], v16 offset:45056
  v_mfma_f32_16x16x32_bf16 v[104:107], v[248:251], v[188:191], v[104:107]
  ds_read_b64_tr_b16 v[246:247], v16 offset:45568
  s_waitcnt lgkmcnt(6)
  v_mfma_f32_16x16x32_bf16 v[100:103], v[252:255], v[184:187], v[100:103]
  ds_read_b64_tr_b16 v[248:249], v17 offset:45056
  v_mfma_f32_16x16x32_bf16 v[108:111], v[252:255], v[188:191], v[108:111]
  ds_read_b64_tr_b16 v[250:251], v17 offset:45568
  s_waitcnt lgkmcnt(6)
  v_mfma_f32_16x16x32_bf16 v[96:99], v[6:9], v[192:195], v[96:99]
  v_mfma_f32_16x16x32_bf16 v[104:107], v[6:9], v[196:199], v[104:107]
  s_waitcnt lgkmcnt(4)
  v_mfma_f32_16x16x32_bf16 v[100:103], v[240:243], v[192:195], v[100:103]
  v_mfma_f32_16x16x32_bf16 v[108:111], v[240:243], v[196:199], v[108:111]
  s_waitcnt lgkmcnt(2)
  v_mfma_f32_16x16x32_bf16 v[96:99], v[244:247], v[200:203], v[96:99]
  v_mfma_f32_16x16x32_bf16 v[104:107], v[244:247], v[204:207], v[104:107]
  s_waitcnt lgkmcnt(0)
  v_mfma_f32_16x16x32_bf16 v[100:103], v[248:251], v[200:203], v[100:103]
  v_mfma_f32_16x16x32_bf16 v[108:111], v[248:251], v[204:207], v[108:111]
  s_cmp_eq_u32 s5, 1
  s_cbranch_scc0 L_w399
  s_waitcnt vmcnt(8)
L_w399:
  s_barrier
  ds_read_b64_tr_b16 v[252:253], v16 offset:49152
  ds_read_b64_tr_b16 v[254:255], v16 offset:49664
  ds_read_b64_tr_b16 v[6:7], v17 offset:49152
  ds_read_b64_tr_b16 v[8:9], v17 offset:49664
  ds_read_b64_tr_b16 v[240:241], v16 offset:53248
  ds_read_b64_tr_b16 v[242:243], v16 offset:53760
  ds_read_b64_tr_b16 v[244:245], v17 offset:53248
  ds_read_b64_tr_b16 v[246:247], v17 offset:53760
  s_add_u32 s36, s69, 81920
  s_and_b32 s36, s36, 0x1ffff
  s_add_u32 s36, s36, s68
  s_add_u32 m0, s49, 49152
  s_nop 0
  buffer_load_dwordx4 v29, s[12:15], s36 offen offset:0 nt lds
  buffer_load_dwordx4 v30, s[12:15], s36 offen offset:1024 nt lds
  s_waitcnt lgkmcnt(6)
  v_mfma_f32_16x16x32_bf16 v[96:99], v[252:255], v[208:211], v[96:99]
  s_add_u32 s36, s69, 98304
  s_and_b32 s36, s36, 0x1ffff
  s_add_u32 s36, s36, s68
  s_add_u32 m0, s49, 57344
  s_add_u32 s36, s36, 131072
  s_cmp_eq_u32 s5, 0
  s_cbranch_scc1 L_t400
  buffer_load_dwordx4 v29, s[12:15], s36 offen offset:0 nt lds
L_t400:
  ds_read_b64_tr_b16 v[248:249], v16 offset:57344
  v_mfma_f32_16x16x32_bf16 v[104:107], v[252:255], v[212:215], v[104:107]
  ds_read_b64_tr_b16 v[250:251], v16 offset:57856
  s_waitcnt lgkmcnt(6)
  v_mfma_f32_16x16x32_bf16 v[100:103], v[6:9], v[208:211], v[100:103]
  ds_read_b64_tr_b16 v[252:253], v17 offset:57344
  v_mfma_f32_16x16x32_bf16 v[108:111], v[6:9], v[212:215], v[108:111]
  ds_read_b64_tr_b16 v[254:255], v17 offset:57856
  s_waitcnt lgkmcnt(6)
  v_mfma_f32_16x16x32_bf16 v[96:99], v[240:243], v[216:219], v[96:99]
  s_cmp_eq_u32 s5, 0
  s_cbranch_scc1 L_t401
  buffer_load_dwordx4 v30, s[12:15], s36 offen offset:1024 nt lds
L_t401:
  ds_read_b64_tr_b16 v[6:7], v16 offset:61440
  v_mfma_f32_16x16x32_bf16 v[104:107], v[240:243], v[220:223], v[104:107]
  ds_read_b64_tr_b16 v[8:9], v16 offset:61952
  s_waitcnt lgkmcnt(6)
  v_mfma_f32_16x16x32_bf16 v[100:103], v[244:247], v[216:219], v[100:103]
  ds_read_b64_tr_b16 v[240:241], v17 offset:61440
  v_mfma_f32_16x16x32_bf16 v[108:111], v[244:247], v[220:223], v[108:111]
  ds_read_b64_tr_b16 v[242:243], v17 offset:61952
  s_waitcnt lgkmcnt(6)
  v_mfma_f32_16x16x32_bf16 v[96:99], v[248:251], v[224:227], v[96:99]
  v_mfma_f32_16x16x32_bf16 v[104:107], v[248:251], v[228:231], v[104:107]
  s_waitcnt lgkmcnt(4)
  v_mfma_f32_16x16x32_bf16 v[100:103], v[252:255], v[224:227], v[100:103]
  v_mfma_f32_16x16x32_bf16 v[108:111], v[252:255], v[228:231], v[108:111]
  s_waitcnt lgkmcnt(2)
  v_mfma_f32_16x16x32_bf16 v[96:99], v[6:9], v[232:235], v[96:99]
  v_mfma_f32_16x16x32_bf16 v[104:107], v[6:9], v[236:239], v[104:107]
  s_waitcnt lgkmcnt(0)
  v_mfma_f32_16x16x32_bf16 v[100:103], v[240:243], v[232:235], v[100:103]
  v_mfma_f32_16x16x32_bf16 v[108:111], v[240:243], v[236:239], v[108:111]
  s_waitcnt vmcnt(8)
  s_cmp_eq_u32 s5, 0
  s_cbranch_scc0 L_w402
  s_waitcnt vmcnt(4)
L_w402:
  s_barrier
  s_add_u32 m0, s44, 98304
  s_add_u32 s36, s42, s47
  buffer_load_dwordx4 v10, s[24:27], s36 offen offset:0  lds
  buffer_load_dwordx4 v11, s[24:27], s36 offen offset:1024  lds
  buffer_load_dwordx4 v12, s[24:27], s36 offen offset:2048  lds
  buffer_load_dwordx4 v13, s[24:27], s36 offen offset:3072  lds
  s_add_u32 m0, s44, 114688
  s_add_u32 s36, s42, s47
  s_add_u32 s36, s36, 147456
  buffer_load_dwordx4 v10, s[24:27], s36 offen offset:0  lds
  buffer_load_dwordx4 v11, s[24:27], s36 offen offset:1024  lds
  buffer_load_dwordx4 v12, s[24:27], s36 offen offset:2048  lds
  buffer_load_dwordx4 v13, s[24:27], s36 offen offset:3072  lds
  s_add_u32 s42, s42, 128
  s_cmp_eq_u32 s42, 1152
  s_cselect_b32 s42, 0, s42
  s_add_u32 s36, s69, 73728
  s_and_b32 s36, s36, 0x1ffff
  s_add_u32 s36, s36, s68
  s_add_u32 m0, s49, 0
  s_nop 0
  buffer_load_dwordx4 v31, s[16:19], s36 offen offset:0 nt lds
  buffer_load_dwordx4 v22, s[16:19], s36 offen offset:1024 nt lds
  s_add_u32 s36, s69, 90112
  s_and_b32 s36, s36, 0x1ffff
  s_add_u32 s36, s36, s68
  s_add_u32 m0, s49, 8192
  s_add_u32 s36, s36, 131072
  s_cmp_eq_u32 s5, 0
  s_cbranch_scc1 L_t403
  buffer_load_dwordx4 v31, s[16:19], s36 offen offset:0 nt lds
L_t403:
  s_cmp_eq_u32 s5, 0
  s_cbranch_scc1 L_t404
  buffer_load_dwordx4 v22, s[16:19], s36 offen offset:1024 nt lds
L_t404:
  s_waitcnt vmcnt(16)
  s_cmp_eq_u32 s5, 0
  s_cbranch_scc0 L_w405
  s_waitcnt vmcnt(12)
L_w405:
  s_barrier
  ds_read_b64_tr_b16 v[240:241], v16 offset:0
  ds_read_b64_tr_b16 v[242:243], v16 offset:512
  ds_read_b64_tr_b16 v[244:245], v17 offset:0
  ds_read_b64_tr_b16 v[246:247], v17 offset:512
  ds_read_b64_tr_b16 v[248:249], v16 offset:4096
  ds_read_b64_tr_b16 v[250:251], v16 offset:4608
  ds_read_b64_tr_b16 v[252:253], v17 offset:4096
  ds_read_b64_tr_b16 v[254:255], v17 offset:4608
  s_add_u32 s36, s69, 90112
  s_and_b32 s36, s36, 0x1ffff
  s_add_u32 s36, s36, s68
  s_add_u32 m0, s49, 16384
  s_nop 0
  buffer_load_dwordx4 v29, s[12:15], s36 offen offset:0 nt lds
  buffer_load_dwordx4 v30, s[12:15], s36 offen offset:1024 nt lds
  s_waitcnt lgkmcnt(6)
  v_mfma_f32_16x16x32_bf16 v[112:115], v[240:243], v[176:179], 0
  s_add_u32 s36, s69, 106496
  s_and_b32 s36, s36, 0x1ffff
  s_add_u32 s36, s36, s68
  s_add_u32 m0, s49, 24576
  s_add_u32 s36, s36, 131072
  s_cmp_eq_u32 s5, 0
  s_cbranch_scc1 L_t406
  buffer_load_dwordx4 v29, s[12:15], s36 offen offset:0 nt lds
L_t406:
  ds_read_b64_tr_b16 v[6:7], v16 offset:8192
  v_mfma_f32_16x16x32_bf16 v[120:123], v[240:243], v[180:183], 0
  ds_read_b64_tr_b16 v[8:9], v16 offset:8704
  s_waitcnt lgkmcnt(6)
  v_mfma_f32_16x16x32_bf16 v[116:119], v[244:247], v[176:179], 0
  ds_read_b64_tr_b16 v[240:241], v17 offset:8192
  v_mfma_f32_16x16x32_bf16 v[124:127], v[244:247], v[180:183], 0
  ds_read_b64_tr_b16 v[242:243], v17 offset:8704
  s_waitcnt lgkmcnt(6)
  v_mfma_f32_16x16x32_bf16 v[112:115], v[248:251], v[184:187], v[112:115]
  s_cmp_eq_u32 s5, 0
  s_cbranch_scc1 L_t407
  buffer_load_dwordx4 v30, s[12:15], s36 offen offset:1024 nt lds
L_t407:
  ds_read_b64_tr_b16 v[244:245], v16 offset:12288
  v_mfma_f32_16x16x32_bf16 v[120:123], v[248:251], v[188:191], v[120:123]
  ds_read_b64_tr_b16 v[246:247], v16 offset:12800
  s_waitcnt lgkmcnt(6)
  v_mfma_f32_16x16x32_bf16 v[116:119], v[252:255], v[184:187], v[116:119]
  ds_read_b64_tr_b16 v[248:249], v17 offset:12288
  v_mfma_f32_16x16x32_bf16 v[124:127], v[252:255], v[188:191], v[124:127]
  ds_read_b64_tr_b16 v[250:251], v17 offset:12800
  s_waitcnt lgkmcnt(6)
  v_mfma_f32_16x16x32_bf16 v[112:115], v[6:9], v[192:195], v[112:115]
  v_mfma_f32_16x16x32_bf16 v[120:123], v[6:9], v[196:199], v[120:123]
  s_waitcnt lgkmcnt(4)
  v_mfma_f32_16x16x32_bf16 v[116:119], v[240:243], v[192:195], v[116:119]
  v_mfma_f32_16x16x32_bf16 v[124:127], v[240:243], v[196:199], v[124:127]
  s_waitcnt lgkmcnt(2)
  v_mfma_f32_16x16x32_bf16 v[112:115], v[244:247], v[200:203], v[112:115]
  v_mfma_f32_16x16x32_bf16 v[120:123], v[244:247], v[204:207], v[120:123]
  s_waitcnt lgkmcnt(0)
  v_mfma_f32_16x16x32_bf16 v[116:119], v[248:251], v[200:203], v[116:119]
  v_mfma_f32_16x16x32_bf16 v[124:127], v[248:251], v[204:207], v[124:127]
  s_waitcnt vmcnt(8)
  s_cmp_eq_u32 s5, 0
  s_cbranch_scc0 L_w408
  s_waitcnt vmcnt(4)
L_w408:
  s_barrier
  ds_read_b64_tr_b16 v[252:253], v16 offset:16384
  ds_read_b64_tr_b16 v[254:255], v16 offset:16896
  ds_read_b64_tr_b16 v[6:7], v17 offset:16384
  ds_read_b64_tr_b16 v[8:9], v17 offset:16896
  ds_read_b64_tr_b16 v[240:241], v16 offset:20480
  ds_read_b64_tr_b16 v[242:243], v16 offset:20992
  ds_read_b64_tr_b16 v[244:245], v17 offset:20480
  ds_read_b64_tr_b16 v[246:247], v17 offset:20992
  s_add_u32 s36, s69, 81920
  s_and_b32 s36, s36, 0x1ffff
  s_add_u32 s36, s36, s68
  s_add_u32 m0, s49, 32768
  s_nop 0
  buffer_load_dwordx4 v31, s[16:19], s36 offen offset:0 nt lds
  buffer_load_dwordx4 v22, s[16:19], s36 offen offset:1024 nt lds
  s_waitcnt lgkmcnt(6)
  v_mfma_f32_16x16x32_bf16 v[112:115], v[252:255], v[208:211], v[112:115]
  s_add_u32 s36, s69, 98304
  s_and_b32 s36, s36, 0x1ffff
  s_add_u32 s36, s36, s68
  s_add_u32 m0, s49, 40960
  s_add_u32 s36, s36, 131072
  s_cmp_eq_u32 s5, 0
  s_cbranch_scc1 L_t409
  buffer_load_dwordx4 v31, s[16:19], s36 offen offset:0 nt lds
L_t409:
  ds_read_b64_tr_b16 v[248:249], v16 offset:24576
  v_mfma_f32_16x16x32_bf16 v[120:123], v[252:255], v[212:215], v[120:123]
  ds_read_b64_tr_b16 v[250:251], v16 offset:25088
  s_waitcnt lgkmcnt(6)
  v_mfma_f32_16x16x32_bf16 v[116:119], v[6:9], v[208:211], v[116:119]
  ds_read_b64_tr_b16 v[252:253], v17 offset:24576
  v_mfma_f32_16x16x32_bf16 v[124:127], v[6:9], v[212:215], v[124:127]
  ds_read_b64_tr_b16 v[254:255], v17 offset:25088
  s_waitcnt lgkmcnt(6)
  v_mfma_f32_16x16x32_bf16 v[112:115], v[240:243], v[216:219], v[112:115]
  s_cmp_eq_u32 s5, 0
  s_cbranch_scc1 L_t410
  buffer_load_dwordx4 v22, s[16:19], s36 offen offset:1024 nt lds
L_t410:
  ds_read_b64_tr_b16 v[6:7], v16 offset:28672
  v_mfma_f32_16x16x32_bf16 v[120:123], v[240:243], v[220:223], v[120:123]
  ds_read_b64_tr_b16 v[8:9], v16 offset:29184
  s_waitcnt lgkmcnt(6)
  v_mfma_f32_16x16x32_bf16 v[116:119], v[244:247], v[216:219], v[116:119]
  ds_read_b64_tr_b16 v[240:241], v17 offset:28672
  v_mfma_f32_16x16x32_bf16 v[124:127], v[244:247], v[220:223], v[124:127]
  ds_read_b64_tr_b16 v[242:243], v17 offset:29184
  s_waitcnt lgkmcnt(6)
  v_mfma_f32_16x16x32_bf16 v[112:115], v[248:251], v[224:227], v[112:115]
  v_mfma_f32_16x16x32_bf16 v[120:123], v[248:251], v[228:231], v[120:123]
  s_waitcnt lgkmcnt(4)
  v_mfma_f32_16x16x32_bf16 v[116:119], v[252:255], v[224:227], v[116:119]
  v_mfma_f32_16x16x32_bf16 v[124:127], v[252:255], v[228:231], v[124:127]
  s_waitcnt lgkmcnt(2)
  v_mfma_f32_16x16x32_bf16 v[112:115], v[6:9], v[232:235], v[112:115]
  v_mfma_f32_16x16x32_bf16 v[120:123], v[6:9], v[236:239], v[120:123]
  s_waitcnt lgkmcnt(0)
  v_mfma_f32_16x16x32_bf16 v[116:119], v[240:243], v[232:235], v[116:119]
  v_mfma_f32_16x16x32_bf16 v[124:127], v[240:243], v[236:239], v[124:127]
  s_cmp_eq_u32 s3, 7
  s_cbranch_scc0 L_cp411
  s_mul_i32 s37, s6, 3072
  v_lshlrev_b32 v2, 7, v1
  s_mov_b32 exec_hi, 0
  buffer_load_dword v0, v2, s[64:67], s37 offen
  s_mov_b32 exec_hi, -1
L_cp411:
  s_waitcnt vmcnt(8)
  s_cmp_eq_u32 s5, 0
  s_cbranch_scc0 L_w412
  s_waitcnt vmcnt(4)
L_w412:
  s_barrier
  ds_read_b64_tr_b16 v[240:241], v16 offset:32768
  ds_read_b64_tr_b16 v[242:243], v16 offset:33280
  ds_read_b64_tr_b16 v[244:245], v17 offset:32768
  ds_read_b64_tr_b16 v[246:247], v17 offset:33280
  ds_read_b64_tr_b16 v[248:249], v16 offset:36864
  ds_read_b64_tr_b16 v[250:251], v16 offset:37376
  ds_read_b64_tr_b16 v[252:253], v17 offset:36864
  ds_read_b64_tr_b16 v[254:255], v17 offset:37376
  s_add_u32 s36, s69, 98304
  s_and_b32 s36, s36, 0x1ffff
  s_add_u32 s36, s36, s68
  s_add_u32 m0, s49, 49152
  s_nop 0
  buffer_load_dwordx4 v29, s[12:15], s36 offen offset:0 nt lds
  buffer_load_dwordx4 v30, s[12:15], s36 offen offset:1024 nt lds
  s_waitcnt lgkmcnt(6)
  v_mfma_f32_16x16x32_bf16 v[128:131], v[240:243], v[176:179], 0
  s_add_u32 s36, s69, 114688
  s_and_b32 s36, s36, 0x1ffff
  s_add_u32 s36, s36, s68
  s_add_u32 m0, s49, 57344
  s_add_u32 s36, s36, 131072
  s_cmp_eq_u32 s5, 0
  s_cbranch_scc1 L_t413
  buffer_load_dwordx4 v29, s[12:15], s36 offen offset:0 nt lds
L_t413:
  ds_read_b64_tr_b16 v[6:7], v16 offset:40960
  v_mfma_f32_16x16x32_bf16 v[136:139], v[240:243], v[180:183], 0
  ds_read_b64_tr_b16 v[8:9], v16 offset:41472
  s_waitcnt lgkmcnt(6)
  v_mfma_f32_16x16x32_bf16 v[132:135], v[244:247], v[176:179], 0
  ds_read_b64_tr_b16 v[240:241], v17 offset:40960
  v_mfma_f32_16x16x32_bf16 v[140:143], v[244:247], v[180:183], 0
  ds_read_b64_tr_b16 v[242:243], v17 offset:41472
  s_waitcnt lgkmcnt(6)
  v_mfma_f32_16x16x32_bf16 v[128:131], v[248:251], v[184:187], v[128:131]
  s_cmp_eq_u32 s5, 0
  s_cbranch_scc1 L_t414
  buffer_load_dwordx4 v30, s[12:15], s36 offen offset:1024 nt lds
L_t414:
  ds_read_b64_tr_b16 v[244:245], v16 offset:45056
  v_mfma_f32_16x16x32_bf16 v[136:139], v[248:251], v[188:191], v[136:139]
  ds_read_b64_tr_b16 v[246:247], v16 offset:45568
  s_waitcnt lgkmcnt(6)
  v_mfma_f32_16x16x32_bf16 v[132:135], v[252:255], v[184:187], v[132:135]
  ds_read_b64_tr_b16 v[248:249], v17 offset:45056
  v_mfma_f32_16x16x32_bf16 v[140:143], v[252:255], v[188:191], v[140:143]
  ds_read_b64_tr_b16 v[250:251], v17 offset:45568
  s_waitcnt lgkmcnt(6)
  v_mfma_f32_16x16x32_bf16 v[128:131], v[6:9], v[192:195], v[128:131]
  v_mfma_f32_16x16x32_bf16 v[136:139], v[6:9], v[196:199], v[136:139]
  s_waitcnt lgkmcnt(4)
  v_mfma_f32_16x16x32_bf16 v[132:135], v[240:243], v[192:195], v[132:135]
  v_mfma_f32_16x16x32_bf16 v[140:143], v[240:243], v[196:199], v[140:143]
  s_waitcnt lgkmcnt(2)
  v_mfma_f32_16x16x32_bf16 v[128:131], v[244:247], v[200:203], v[128:131]
  v_mfma_f32_16x16x32_bf16 v[136:139], v[244:247], v[204:207], v[136:139]
  s_waitcnt lgkmcnt(0)
  v_mfma_f32_16x16x32_bf16 v[132:135], v[248:251], v[200:203], v[132:135]
  v_mfma_f32_16x16x32_bf16 v[140:143], v[248:251], v[204:207], v[140:143]
  s_waitcnt vmcnt(8)
  s_cmp_eq_u32 s5, 0
  s_cbranch_scc0 L_w415
  s_waitcnt vmcnt(4)
L_w415:
  s_barrier
  s_add_u32 m0, s44, 65536
  s_add_u32 s36, s42, s47
  buffer_load_dwordx4 v10, s[24:27], s36 offen offset:0  lds
  buffer_load_dwordx4 v11, s[24:27], s36 offen offset:1024  lds
  buffer_load_dwordx4 v12, s[24:27], s36 offen offset:2048  lds
  buffer_load_dwordx4 v13, s[24:27], s36 offen offset:3072  lds
  s_add_u32 m0, s44, 81920
  s_add_u32 s36, s42, s47
  s_add_u32 s36, s36, 147456
  buffer_load_dwordx4 v10, s[24:27], s36 offen offset:0  lds
  buffer_load_dwordx4 v11, s[24:27], s36 offen offset:1024  lds
  buffer_load_dwordx4 v12, s[24:27], s36 offen offset:2048  lds
  buffer_load_dwordx4 v13, s[24:27], s36 offen offset:3072  lds
  s_add_u32 s42, s42, 128
  s_cmp_eq_u32 s42, 1152
  s_cselect_b32 s42, 0, s42
  s_add_u32 m0, s44, 98304
  s_add_u32 s36, s42, s47
  buffer_load_dwordx4 v10, s[24:27], s36 offen offset:0  lds
  buffer_load_dwordx4 v11, s[24:27], s36 offen offset:1024  lds
  buffer_load_dwordx4 v12, s[24:27], s36 offen offset:2048  lds
  buffer_load_dwordx4 v13, s[24:27], s36 offen offset:3072  lds
  s_add_u32 s36, s69, 90112
  s_and_b32 s36, s36, 0x1ffff
  s_add_u32 s36, s36, s68
  s_add_u32 m0, s49, 0
  s_nop 0
  buffer_load_dwordx4 v31, s[16:19], s36 offen offset:0 nt lds
  buffer_load_dwordx4 v22, s[16:19], s36 offen offset:1024 nt lds
  s_add_u32 s36, s69, 106496
  s_and_b32 s36, s36, 0x1ffff
  s_add_u32 s36, s36, s68
  s_add_u32 m0, s49, 8192
  s_add_u32 s36, s36, 131072
  s_cmp_eq_u32 s5, 0
  s_cbranch_scc1 L_t416
  buffer_load_dwordx4 v31, s[16:19], s36 offen offset:0 nt lds
L_t416:
  s_cmp_eq_u32 s5, 0
  s_cbranch_scc1 L_t417
  buffer_load_dwordx4 v22, s[16:19], s36 offen offset:1024 nt lds
L_t417:
  s_waitcnt vmcnt(20)
  s_cmp_eq_u32 s5, 0
  s_cbranch_scc0 L_w418
  s_waitcnt vmcnt(16)
L_w418:
  s_barrier
  s_add_u32 s36, s69, 106496
  s_and_b32 s36, s36, 0x1ffff
  s_add_u32 s36, s36, s68
  s_add_u32 m0, s49, 16384
  s_nop 0
  buffer_load_dwordx4 v29, s[12:15], s36 offen offset:0 nt lds
  buffer_load_dwordx4 v30, s[12:15], s36 offen offset:1024 nt lds
  s_add_u32 s36, s69, 122880
  s_and_b32 s36, s36, 0x1ffff
  s_add_u32 s36, s36, s68
  s_add_u32 m0, s49, 24576
  s_add_u32 s36, s36, 131072
  s_cmp_eq_u32 s5, 0
  s_cbranch_scc1 L_t419
  buffer_load_dwordx4 v29, s[12:15], s36 offen offset:0 nt lds
L_t419:
  s_cmp_eq_u32 s5, 0
  s_cbranch_scc1 L_t420
  buffer_load_dwordx4 v30, s[12:15], s36 offen offset:1024 nt lds
L_t420:
  s_waitcnt vmcnt(8)
  s_cmp_eq_u32 s5, 0
  s_cbranch_scc0 L_w421
  s_waitcnt vmcnt(2)
L_w421:
  s_barrier
  ds_read_b64_tr_b16 v[252:253], v16 offset:49152
  ds_read_b64_tr_b16 v[254:255], v16 offset:49664
  ds_read_b64_tr_b16 v[6:7], v17 offset:49152
  ds_read_b64_tr_b16 v[8:9], v17 offset:49664
  ds_read_b64_tr_b16 v[240:241], v16 offset:53248
  ds_read_b64_tr_b16 v[242:243], v16 offset:53760
  ds_read_b64_tr_b16 v[244:245], v17 offset:53248
  ds_read_b64_tr_b16 v[246:247], v17 offset:53760
  s_add_u32 s36, s69, 98304
  s_and_b32 s36, s36, 0x1ffff
  s_add_u32 s36, s36, s68
  s_add_u32 m0, s49, 32768
  s_nop 0
  buffer_load_dwordx4 v31, s[16:19], s36 offen offset:0 nt lds
  buffer_load_dwordx4 v22, s[16:19], s36 offen offset:1024 nt lds
  s_waitcnt lgkmcnt(6)
  v_mfma_f32_16x16x32_bf16 v[128:131], v[252:255], v[208:211], v[128:131]
  s_add_u32 s36, s69, 114688
  s_and_b32 s36, s36, 0x1ffff
  s_add_u32 s36, s36, s68
  s_add_u32 m0, s49, 40960
  s_add_u32 s36, s36, 131072
  s_cmp_eq_u32 s5, 0
  s_cbranch_scc1 L_t422
  buffer_load_dwordx4 v31, s[16:19], s36 offen offset:0 nt lds
L_t422:
  ds_read_b64_tr_b16 v[248:249], v16 offset:57344
  v_mfma_f32_16x16x32_bf16 v[136:139], v[252:255], v[212:215], v[136:139]
  ds_read_b64_tr_b16 v[250:251], v16 offset:57856
  s_waitcnt lgkmcnt(6)
  v_mfma_f32_16x16x32_bf16 v[132:135], v[6:9], v[208:211], v[132:135]
  ds_read_b64_tr_b16 v[252:253], v17 offset:57344
  v_mfma_f32_16x16x32_bf16 v[140:143], v[6:9], v[212:215], v[140:143]
  ds_read_b64_tr_b16 v[254:255], v17 offset:57856
  s_waitcnt lgkmcnt(6)
  v_mfma_f32_16x16x32_bf16 v[128:131], v[240:243], v[216:219], v[128:131]
  s_cmp_eq_u32 s5, 0
  s_cbranch_scc1 L_t423
  buffer_load_dwordx4 v22, s[16:19], s36 offen offset:1024 nt lds
L_t423:
  ds_read_b64_tr_b16 v[6:7], v16 offset:61440
  v_mfma_f32_16x16x32_bf16 v[136:139], v[240:243], v[220:223], v[136:139]
  ds_read_b64_tr_b16 v[8:9], v16 offset:61952
  s_waitcnt lgkmcnt(6)
  v_mfma_f32_16x16x32_bf16 v[132:135], v[244:247], v[216:219], v[132:135]
  ds_read_b64_tr_b16 v[240:241], v17 offset:61440
  v_mfma_f32_16x16x32_bf16 v[140:143], v[244:247], v[220:223], v[140:143]
  ds_read_b64_tr_b16 v[242:243], v17 offset:61952
  s_waitcnt lgkmcnt(6)
  v_mfma_f32_16x16x32_bf16 v[128:131], v[248:251], v[224:227], v[128:131]
  v_mfma_f32_16x16x32_bf16 v[136:139], v[248:251], v[228:231], v[136:139]
  s_waitcnt lgkmcnt(4)
  v_mfma_f32_16x16x32_bf16 v[132:135], v[252:255], v[224:227], v[132:135]
  v_mfma_f32_16x16x32_bf16 v[140:143], v[252:255], v[228:231], v[140:143]
  s_waitcnt lgkmcnt(2)
  v_mfma_f32_16x16x32_bf16 v[128:131], v[6:9], v[232:235], v[128:131]
  v_mfma_f32_16x16x32_bf16 v[136:139], v[6:9], v[236:239], v[136:139]
  s_waitcnt lgkmcnt(0)
  v_mfma_f32_16x16x32_bf16 v[132:135], v[240:243], v[232:235], v[132:135]
  v_mfma_f32_16x16x32_bf16 v[140:143], v[240:243], v[236:239], v[140:143]
  s_cmp_eq_u32 s5, 1
  s_cbranch_scc0 L_w424
  s_waitcnt vmcnt(8)
L_w424:
  s_barrier
  ds_read_b64_tr_b16 v[240:241], v16 offset:0
  ds_read_b64_tr_b16 v[242:243], v16 offset:512
  ds_read_b64_tr_b16 v[244:245], v17 offset:0
  ds_read_b64_tr_b16 v[246:247], v17 offset:512
  ds_read_b64_tr_b16 v[248:249], v16 offset:4096
  ds_read_b64_tr_b16 v[250:251], v16 offset:4608
  ds_read_b64_tr_b16 v[252:253], v17 offset:4096
  ds_read_b64_tr_b16 v[254:255], v17 offset:4608
  s_add_u32 s36, s69, 114688
  s_and_b32 s36, s36, 0x1ffff
  s_add_u32 s36, s36, s68
  s_add_u32 m0, s49, 49152
  s_nop 0
  buffer_load_dwordx4 v29, s[12:15], s36 offen offset:0 nt lds
  buffer_load_dwordx4 v30, s[12:15], s36 offen offset:1024 nt lds
  s_waitcnt lgkmcnt(6)
  v_mfma_f32_16x16x32_bf16 v[144:147], v[240:243], v[176:179], 0
  s_add_u32 s36, s69, 131072
  s_and_b32 s36, s36, 0x1ffff
  s_add_u32 s36, s36, s68
  s_add_u32 m0, s49, 57344
  s_add_u32 s36, s36, 131072
  s_cmp_eq_u32 s5, 0
  s_cbranch_scc1 L_t425
  buffer_load_dwordx4 v29, s[12:15], s36 offen offset:0 nt lds
L_t425:
  ds_read_b64_tr_b16 v[6:7], v16 offset:8192
  v_mfma_f32_16x16x32_bf16 v[152:155], v[240:243], v[180:183], 0
  ds_read_b64_tr_b16 v[8:9], v16 offset:8704
  s_waitcnt lgkmcnt(6)
  v_mfma_f32_16x16x32_bf16 v[148:151], v[244:247], v[176:179], 0
  ds_read_b64_tr_b16 v[240:241], v17 offset:8192
  v_mfma_f32_16x16x32_bf16 v[156:159], v[244:247], v[180:183], 0
  ds_read_b64_tr_b16 v[242:243], v17 offset:8704
  s_waitcnt lgkmcnt(6)
  v_mfma_f32_16x16x32_bf16 v[144:147], v[248:251], v[184:187], v[144:147]
  s_cmp_eq_u32 s5, 0
  s_cbranch_scc1 L_t426
  buffer_load_dwordx4 v30, s[12:15], s36 offen offset:1024 nt lds
L_t426:
  ds_read_b64_tr_b16 v[244:245], v16 offset:12288
  v_mfma_f32_16x16x32_bf16 v[152:155], v[248:251], v[188:191], v[152:155]
  ds_read_b64_tr_b16 v[246:247], v16 offset:12800
  s_waitcnt lgkmcnt(6)
  v_mfma_f32_16x16x32_bf16 v[148:151], v[252:255], v[184:187], v[148:151]
  ds_read_b64_tr_b16 v[248:249], v17 offset:12288
  v_mfma_f32_16x16x32_bf16 v[156:159], v[252:255], v[188:191], v[156:159]
  ds_read_b64_tr_b16 v[250:251], v17 offset:12800
  s_waitcnt lgkmcnt(6)
  v_mfma_f32_16x16x32_bf16 v[144:147], v[6:9], v[192:195], v[144:147]
  v_mfma_f32_16x16x32_bf16 v[152:155], v[6:9], v[196:199], v[152:155]
  s_waitcnt lgkmcnt(4)
  v_mfma_f32_16x16x32_bf16 v[148:151], v[240:243], v[192:195], v[148:151]
  v_mfma_f32_16x16x32_bf16 v[156:159], v[240:243], v[196:199], v[156:159]
  s_waitcnt lgkmcnt(2)
  v_mfma_f32_16x16x32_bf16 v[144:147], v[244:247], v[200:203], v[144:147]
  v_mfma_f32_16x16x32_bf16 v[152:155], v[244:247], v[204:207], v[152:155]
  s_waitcnt lgkmcnt(0)
  v_mfma_f32_16x16x32_bf16 v[148:151], v[248:251], v[200:203], v[148:151]
  v_mfma_f32_16x16x32_bf16 v[156:159], v[248:251], v[204:207], v[156:159]
  s_waitcnt vmcnt(8)
  s_cmp_eq_u32 s5, 0
  s_cbranch_scc0 L_w427
  s_waitcnt vmcnt(4)
L_w427:
  s_barrier
  s_add_u32 m0, s44, 114688
  s_add_u32 s36, s42, s47
  s_add_u32 s36, s36, 147456
  buffer_load_dwordx4 v10, s[24:27], s36 offen offset:0  lds
  buffer_load_dwordx4 v11, s[24:27], s36 offen offset:1024  lds
  buffer_load_dwordx4 v12, s[24:27], s36 offen offset:2048  lds
  buffer_load_dwordx4 v13, s[24:27], s36 offen offset:3072  lds
  s_add_u32 s42, s42, 128
  s_cmp_eq_u32 s42, 1152
  s_cselect_b32 s42, 0, s42
  s_mov_b32 s47, 294912
  s_add_u32 m0, s44, 65536
  s_add_u32 s36, s42, s47
  buffer_load_dwordx4 v10, s[24:27], s36 offen offset:0  lds
  buffer_load_dwordx4 v11, s[24:27], s36 offen offset:1024  lds
  buffer_load_dwordx4 v12, s[24:27], s36 offen offset:2048  lds
  buffer_load_dwordx4 v13, s[24:27], s36 offen offset:3072  lds
  s_add_u32 s36, s69, 106496
  s_and_b32 s36, s36, 0x1ffff
  s_add_u32 s36, s36, s68
  s_add_u32 m0, s49, 0
  s_nop 0
  buffer_load_dwordx4 v31, s[16:19], s36 offen offset:0 nt lds
  buffer_load_dwordx4 v22, s[16:19], s36 offen offset:1024 nt lds
  s_add_u32 s36, s69, 122880
  s_and_b32 s36, s36, 0x1ffff
  s_add_u32 s36, s36, s68
  s_add_u32 m0, s49, 8192
  s_add_u32 s36, s36, 131072
  s_cmp_eq_u32 s5, 0
  s_cbranch_scc1 L_t428
  buffer_load_dwordx4 v31, s[16:19], s36 offen offset:0 nt lds
L_t428:
  s_cmp_eq_u32 s5, 0
  s_cbranch_scc1 L_t429
  buffer_load_dwordx4 v22, s[16:19], s36 offen offset:1024 nt lds
L_t429:
  s_waitcnt vmcnt(16)
  s_cmp_eq_u32 s5, 0
  s_cbranch_scc0 L_w430
  s_waitcnt vmcnt(12)
L_w430:
  s_barrier
  ds_read_b64_tr_b16 v[252:253], v16 offset:16384
  ds_read_b64_tr_b16 v[254:255], v16 offset:16896
  ds_read_b64_tr_b16 v[6:7], v17 offset:16384
  ds_read_b64_tr_b16 v[8:9], v17 offset:16896
  ds_read_b64_tr_b16 v[240:241], v16 offset:20480
  ds_read_b64_tr_b16 v[242:243], v16 offset:20992
  ds_read_b64_tr_b16 v[244:245], v17 offset:20480
  ds_read_b64_tr_b16 v[246:247], v17 offset:20992
  s_add_u32 s36, s69, 122880
  s_and_b32 s36, s36, 0x1ffff
  s_add_u32 s36, s36, s68
  s_add_u32 m0, s49, 16384
  s_nop 0
  buffer_load_dwordx4 v29, s[12:15], s36 offen offset:0 nt lds
  buffer_load_dwordx4 v30, s[12:15], s36 offen offset:1024 nt lds
  s_waitcnt lgkmcnt(6)
  v_mfma_f32_16x16x32_bf16 v[144:147], v[252:255], v[208:211], v[144:147]
  s_add_u32 s36, s69, 139264
  s_and_b32 s36, s36, 0x1ffff
  s_add_u32 s36, s36, s68
  s_add_u32 m0, s49, 24576
  s_add_u32 s36, s36, 131072
  s_cmp_eq_u32 s5, 0
  s_cbranch_scc1 L_t431
  buffer_load_dwordx4 v29, s[12:15], s36 offen offset:0 nt lds
L_t431:
  ds_read_b64_tr_b16 v[248:249], v16 offset:24576
  v_mfma_f32_16x16x32_bf16 v[152:155], v[252:255], v[212:215], v[152:155]
  ds_read_b64_tr_b16 v[250:251], v16 offset:25088
  s_waitcnt lgkmcnt(6)
  v_mfma_f32_16x16x32_bf16 v[148:151], v[6:9], v[208:211], v[148:151]
  ds_read_b64_tr_b16 v[252:253], v17 offset:24576
  v_mfma_f32_16x16x32_bf16 v[156:159], v[6:9], v[212:215], v[156:159]
  ds_read_b64_tr_b16 v[254:255], v17 offset:25088
  s_waitcnt lgkmcnt(6)
  v_mfma_f32_16x16x32_bf16 v[144:147], v[240:243], v[216:219], v[144:147]
  s_cmp_eq_u32 s5, 0
  s_cbranch_scc1 L_t432
  buffer_load_dwordx4 v30, s[12:15], s36 offen offset:1024 nt lds
L_t432:
  ds_read_b64_tr_b16 v[6:7], v16 offset:28672
  v_mfma_f32_16x16x32_bf16 v[152:155], v[240:243], v[220:223], v[152:155]
  ds_read_b64_tr_b16 v[8:9], v16 offset:29184
  s_waitcnt lgkmcnt(6)
  v_mfma_f32_16x16x32_bf16 v[148:151], v[244:247], v[216:219], v[148:151]
  ds_read_b64_tr_b16 v[240:241], v17 offset:28672
  v_mfma_f32_16x16x32_bf16 v[156:159], v[244:247], v[220:223], v[156:159]
  ds_read_b64_tr_b16 v[242:243], v17 offset:29184
  s_waitcnt lgkmcnt(6)
  v_mfma_f32_16x16x32_bf16 v[144:147], v[248:251], v[224:227], v[144:147]
  v_mfma_f32_16x16x32_bf16 v[152:155], v[248:251], v[228:231], v[152:155]
  s_waitcnt lgkmcnt(4)
  v_mfma_f32_16x16x32_bf16 v[148:151], v[252:255], v[224:227], v[148:151]
  v_mfma_f32_16x16x32_bf16 v[156:159], v[252:255], v[228:231], v[156:159]
  s_waitcnt lgkmcnt(2)
  v_mfma_f32_16x16x32_bf16 v[144:147], v[6:9], v[232:235], v[144:147]
  v_mfma_f32_16x16x32_bf16 v[152:155], v[6:9], v[236:239], v[152:155]
  s_waitcnt lgkmcnt(0)
  v_mfma_f32_16x16x32_bf16 v[148:151], v[240:243], v[232:235], v[148:151]
  v_mfma_f32_16x16x32_bf16 v[156:159], v[240:243], v[236:239], v[156:159]
  s_waitcnt vmcnt(8)
  s_cmp_eq_u32 s5, 0
  s_cbranch_scc0 L_w433
  s_waitcnt vmcnt(4)
L_w433:
  s_barrier
  ds_read_b64_tr_b16 v[240:241], v16 offset:32768
  ds_read_b64_tr_b16 v[242:243], v16 offset:33280
  ds_read_b64_tr_b16 v[244:245], v17 offset:32768
  ds_read_b64_tr_b16 v[246:247], v17 offset:33280
  ds_read_b64_tr_b16 v[248:249], v16 offset:36864
  ds_read_b64_tr_b16 v[250:251], v16 offset:37376
  ds_read_b64_tr_b16 v[252:253], v17 offset:36864
  ds_read_b64_tr_b16 v[254:255], v17 offset:37376
  s_add_u32 s36, s69, 114688
  s_and_b32 s36, s36, 0x1ffff
  s_add_u32 s36, s36, s68
  s_add_u32 m0, s49, 32768
  s_nop 0
  buffer_load_dwordx4 v31, s[16:19], s36 offen offset:0 nt lds
  buffer_load_dwordx4 v22, s[16:19], s36 offen offset:1024 nt lds
  s_waitcnt lgkmcnt(6)
  v_mfma_f32_16x16x32_bf16 v[160:163], v[240:243], v[176:179], 0
  s_add_u32 s36, s69, 131072
  s_and_b32 s36, s36, 0x1ffff
  s_add_u32 s36, s36, s68
  s_add_u32 m0, s49, 40960
  s_add_u32 s36, s36, 131072
  s_cmp_eq_u32 s5, 0
  s_cbranch_scc1 L_t434
  buffer_load_dwordx4 v31, s[16:19], s36 offen offset:0 nt lds
L_t434:
  ds_read_b64_tr_b16 v[6:7], v16 offset:40960
  v_mfma_f32_16x16x32_bf16 v[168:171], v[240:243], v[180:183], 0
  ds_read_b64_tr_b16 v[8:9], v16 offset:41472
  s_waitcnt lgkmcnt(6)
  v_mfma_f32_16x16x32_bf16 v[164:167], v[244:247], v[176:179], 0
  ds_read_b64_tr_b16 v[240:241], v17 offset:40960
  v_mfma_f32_16x16x32_bf16 v[172:175], v[244:247], v[180:183], 0
  ds_read_b64_tr_b16 v[242:243], v17 offset:41472
  s_waitcnt lgkmcnt(6)
  v_mfma_f32_16x16x32_bf16 v[160:163], v[248:251], v[184:187], v[160:163]
  s_cmp_eq_u32 s5, 0
  s_cbranch_scc1 L_t435
  buffer_load_dwordx4 v22, s[16:19], s36 offen offset:1024 nt lds
L_t435:
  ds_read_b64_tr_b16 v[244:245], v16 offset:45056
  v_mfma_f32_16x16x32_bf16 v[168:171], v[248:251], v[188:191], v[168:171]
  ds_read_b64_tr_b16 v[246:247], v16 offset:45568
  s_waitcnt lgkmcnt(6)
  v_mfma_f32_16x16x32_bf16 v[164:167], v[252:255], v[184:187], v[164:167]
  ds_read_b64_tr_b16 v[248:249], v17 offset:45056
  v_mfma_f32_16x16x32_bf16 v[172:175], v[252:255], v[188:191], v[172:175]
  ds_read_b64_tr_b16 v[250:251], v17 offset:45568
  s_waitcnt lgkmcnt(6)
  v_mfma_f32_16x16x32_bf16 v[160:163], v[6:9], v[192:195], v[160:163]
  v_mfma_f32_16x16x32_bf16 v[168:171], v[6:9], v[196:199], v[168:171]
  s_waitcnt lgkmcnt(4)
  v_mfma_f32_16x16x32_bf16 v[164:167], v[240:243], v[192:195], v[164:167]
  v_mfma_f32_16x16x32_bf16 v[172:175], v[240:243], v[196:199], v[172:175]
  s_waitcnt lgkmcnt(2)
  v_mfma_f32_16x16x32_bf16 v[160:163], v[244:247], v[200:203], v[160:163]
  v_mfma_f32_16x16x32_bf16 v[168:171], v[244:247], v[204:207], v[168:171]
  s_waitcnt lgkmcnt(0)
  v_mfma_f32_16x16x32_bf16 v[164:167], v[248:251], v[200:203], v[164:167]
  v_mfma_f32_16x16x32_bf16 v[172:175], v[248:251], v[204:207], v[172:175]
  s_waitcnt vmcnt(8)
  s_cmp_eq_u32 s5, 0
  s_cbranch_scc0 L_w436
  s_waitcnt vmcnt(4)
L_w436:
  s_barrier
  ds_read_b64_tr_b16 v[252:253], v16 offset:49152
  ds_read_b64_tr_b16 v[254:255], v16 offset:49664
  ds_read_b64_tr_b16 v[6:7], v17 offset:49152
  ds_read_b64_tr_b16 v[8:9], v17 offset:49664
  ds_read_b64_tr_b16 v[240:241], v16 offset:53248
  ds_read_b64_tr_b16 v[242:243], v16 offset:53760
  ds_read_b64_tr_b16 v[244:245], v17 offset:53248
  ds_read_b64_tr_b16 v[246:247], v17 offset:53760
  s_add_u32 s36, s69, 122880
  s_and_b32 s36, s36, 0x1ffff
  s_add_u32 s36, s36, s68
  s_add_u32 m0, s49, 49152
  s_nop 0
  buffer_load_dwordx4 v31, s[16:19], s36 offen offset:0 nt lds
  buffer_load_dwordx4 v22, s[16:19], s36 offen offset:1024 nt lds
  s_waitcnt lgkmcnt(6)
  v_mfma_f32_16x16x32_bf16 v[160:163], v[252:255], v[208:211], v[160:163]
  s_add_u32 s36, s69, 139264
  s_and_b32 s36, s36, 0x1ffff
  s_add_u32 s36, s36, s68
  s_add_u32 m0, s49, 57344
  s_add_u32 s36, s36, 131072
  s_cmp_eq_u32 s5, 0
  s_cbranch_scc1 L_t437
  buffer_load_dwordx4 v31, s[16:19], s36 offen offset:0 nt lds
L_t437:
  ds_read_b64_tr_b16 v[248:249], v16 offset:57344
  v_mfma_f32_16x16x32_bf16 v[168:171], v[252:255], v[212:215], v[168:171]
  ds_read_b64_tr_b16 v[250:251], v16 offset:57856
  s_waitcnt lgkmcnt(6)
  v_mfma_f32_16x16x32_bf16 v[164:167], v[6:9], v[208:211], v[164:167]
  ds_read_b64_tr_b16 v[252:253], v17 offset:57344
  v_mfma_f32_16x16x32_bf16 v[172:175], v[6:9], v[212:215], v[172:175]
  ds_read_b64_tr_b16 v[254:255], v17 offset:57856
  s_waitcnt lgkmcnt(6)
  v_mfma_f32_16x16x32_bf16 v[160:163], v[240:243], v[216:219], v[160:163]
  s_cmp_eq_u32 s5, 0
  s_cbranch_scc1 L_t438
  buffer_load_dwordx4 v22, s[16:19], s36 offen offset:1024 nt lds
L_t438:
  ds_read_b64_tr_b16 v[6:7], v16 offset:61440
  v_mfma_f32_16x16x32_bf16 v[168:171], v[240:243], v[220:223], v[168:171]
  ds_read_b64_tr_b16 v[8:9], v16 offset:61952
  s_waitcnt lgkmcnt(6)
  v_mfma_f32_16x16x32_bf16 v[164:167], v[244:247], v[216:219], v[164:167]
  ds_read_b64_tr_b16 v[240:241], v17 offset:61440
  v_mfma_f32_16x16x32_bf16 v[172:175], v[244:247], v[220:223], v[172:175]
  ds_read_b64_tr_b16 v[242:243], v17 offset:61952
  s_waitcnt lgkmcnt(6)
  v_mfma_f32_16x16x32_bf16 v[160:163], v[248:251], v[224:227], v[160:163]
  v_mfma_f32_16x16x32_bf16 v[168:171], v[248:251], v[228:231], v[168:171]
  s_waitcnt lgkmcnt(4)
  v_mfma_f32_16x16x32_bf16 v[164:167], v[252:255], v[224:227], v[164:167]
  v_mfma_f32_16x16x32_bf16 v[172:175], v[252:255], v[228:231], v[172:175]
  s_waitcnt lgkmcnt(2)
  v_mfma_f32_16x16x32_bf16 v[160:163], v[6:9], v[232:235], v[160:163]
  v_mfma_f32_16x16x32_bf16 v[168:171], v[6:9], v[236:239], v[168:171]
  s_waitcnt lgkmcnt(0)
  v_mfma_f32_16x16x32_bf16 v[164:167], v[240:243], v[232:235], v[164:167]
  v_mfma_f32_16x16x32_bf16 v[172:175], v[240:243], v[236:239], v[172:175]
  s_waitcnt vmcnt(8)
  s_cmp_eq_u32 s5, 0
  s_cbranch_scc0 L_w439
  s_waitcnt vmcnt(4)
L_w439:
  s_barrier
  s_add_u32 m0, s44, 81920
  s_add_u32 s36, s42, s47
  s_add_u32 s36, s36, 147456
  buffer_load_dwordx4 v10, s[24:27], s36 offen offset:0  lds
  buffer_load_dwordx4 v11, s[24:27], s36 offen offset:1024  lds
  buffer_load_dwordx4 v12, s[24:27], s36 offen offset:2048  lds
  buffer_load_dwordx4 v13, s[24:27], s36 offen offset:3072  lds
  s_add_u32 s42, s42, 128
  s_cmp_eq_u32 s42, 1152
  s_cselect_b32 s42, 0, s42
  s_add_u32 m0, s44, 98304
  s_add_u32 s36, s42, s47
  buffer_load_dwordx4 v10, s[24:27], s36 offen offset:0  lds
  buffer_load_dwordx4 v11, s[24:27], s36 offen offset:1024  lds
  buffer_load_dwordx4 v12, s[24:27], s36 offen offset:2048  lds
  buffer_load_dwordx4 v13, s[24:27], s36 offen offset:3072  lds
  s_add_u32 m0, s44, 114688
  s_add_u32 s36, s42, s47
  s_add_u32 s36, s36, 147456
  buffer_load_dwordx4 v10, s[24:27], s36 offen offset:0  lds
  buffer_load_dwordx4 v11, s[24:27], s36 offen offset:1024  lds
  buffer_load_dwordx4 v12, s[24:27], s36 offen offset:2048  lds
  buffer_load_dwordx4 v13, s[24:27], s36 offen offset:3072  lds
  s_add_u32 s42, s42, 128
  s_cmp_eq_u32 s42, 1152
  s_cselect_b32 s42, 0, s42
  s_add_u32 m0, s44, 0
  s_add_u32 s36, s42, s47
  buffer_load_dwordx4 v10, s[24:27], s36 offen offset:0  lds
  buffer_load_dwordx4 v11, s[24:27], s36 offen offset:1024  lds
  buffer_load_dwordx4 v12, s[24:27], s36 offen offset:2048  lds
  buffer_load_dwordx4 v13, s[24:27], s36 offen offset:3072  lds
  s_waitcnt vmcnt(20)
  s_cmp_eq_u32 s5, 0
  s_cbranch_scc0 L_w440
  s_waitcnt vmcnt(18)
L_w440:
  s_barrier
  s_add_u32 m0, s44, 16384
  s_add_u32 s36, s42, s47
  s_add_u32 s36, s36, 147456
  buffer_load_dwordx4 v10, s[24:27], s36 offen offset:0  lds
  buffer_load_dwordx4 v11, s[24:27], s36 offen offset:1024  lds
  buffer_load_dwordx4 v12, s[24:27], s36 offen offset:2048  lds
  buffer_load_dwordx4 v13, s[24:27], s36 offen offset:3072  lds
  s_add_u32 s42, s42, 128
  s_cmp_eq_u32 s42, 1152
  s_cselect_b32 s42, 0, s42
  s_waitcnt vmcnt(4)
  s_barrier
  s_add_u32 m0, s44, 32768
  s_add_u32 s36, s42, s47
  buffer_load_dwordx4 v10, s[24:27], s36 offen offset:0  lds
  buffer_load_dwordx4 v11, s[24:27], s36 offen offset:1024  lds
  buffer_load_dwordx4 v12, s[24:27], s36 offen offset:2048  lds
  buffer_load_dwordx4 v13, s[24:27], s36 offen offset:3072  lds
  s_load_dwordx2 s[52:53], s[0:1], 80
  s_load_dwordx2 s[56:57], s[0:1], 96
  s_lshr_b32 s36, s2, 3
  s_mul_i32 s37, s36, 589824
  s_mul_i32 s38, s6, 147456
  s_lshl_b32 s36, s36, 2
  v_mov_b32 v4, s36
  v_lshlrev_b32 v2, 4, v1
  v_and_b32 v3, 15, v1
  v_mul_u32_u24 v3, 2304, v3
  v_lshrrev_b32 v5, 5, v1
  v_lshl_add_u32 v3, v5, 4, v3
  v_bfe_u32 v5, v1, 4, 1
  v_lshl_add_u32 v3, v5, 5, v3
  s_lshl_b32 s36, s2, 7
  v_lshl_add_u32 v5, v1, 2, s36
  s_waitcnt lgkmcnt(0)
  s_add_u32 s12, s56, s37
  s_addc_u32 s13, s57, 0
  s_mov_b32 s14, 589824
  s_mov_b32 s15, 0x20000
  s_add_u32 s16, s52, s38
  s_addc_u32 s17, s53, 0
  s_mov_b32 s18, 147456
  s_mov_b32 s19, 0x20000
  s_mul_i32 s39, s7, 9
  s_add_u32 s39, s39, s3
  s_lshl_b32 s60, s39, 10
  s_lshr_b32 s36, s39, 3
  s_lshl_b32 s36, s36, 7
  s_bfe_u32 s37, s39, 0x10002
  s_mul_i32 s37, s37, 73728
  s_add_u32 s36, s36, s37
  s_and_b32 s37, s39, 2
  s_lshl_b32 s37, s37, 5
  s_add_u32 s36, s36, s37
  s_and_b32 s37, s39, 1
  s_mul_i32 s37, s37, 36864
  s_add_u32 s36, s36, s37
  s_mul_i32 s37, s5, 1152
  s_add_u32 s64, s36, s37
  s_mov_b32 s63, 0xffff0000
  s_lshl_b32 s36, s7, 2
  s_lshl_b32 s58, 1, s36
  v_add_u32 v20, 131072, v2
  s_and_b32 s36, s4, 1
  s_lshl_b32 s36, s36, 12
  s_lshr_b32 s37, s4, 1
  s_lshl_b32 s37, s37, 11
  s_add_u32 s36, s36, s37
  s_mul_i32 s55, s7, 9216
  s_sub_u32 s55, s55, s36
  s_lshl_b32 s48, s8, 7
  s_mov_b32 s54, s48
  ds_read_b64_tr_b16 v[240:241], v16 offset:0
  ds_read_b64_tr_b16 v[242:243], v16 offset:512
  ds_read_b64_tr_b16 v[244:245], v17 offset:0
  ds_read_b64_tr_b16 v[246:247], v17 offset:512
  ds_read_b64_tr_b16 v[248:249], v16 offset:4096
  ds_read_b64_tr_b16 v[250:251], v16 offset:4608
  ds_read_b64_tr_b16 v[252:253], v17 offset:4096
  ds_read_b64_tr_b16 v[254:255], v17 offset:4608
  s_waitcnt vmcnt(0)
  s_waitcnt vmcnt(4)
  s_barrier
  v_xor_b32 v25, 0, v21
  v_xor_b32 v26, 64, v21
  v_xor_b32 v27, 128, v21
  v_xor_b32 v28, 192, v21
  ds_read_b128 v[176:179], v25 offset:0
  ds_read_b128 v[180:183], v25 offset:4096
  ds_read_b128 v[184:187], v26 offset:0
  ds_read_b128 v[188:191], v26 offset:4096
  ds_read_b128 v[192:195], v27 offset:0
  ds_read_b128 v[196:199], v27 offset:4096
  ds_read_b128 v[200:203], v28 offset:0
  ds_read_b128 v[204:207], v28 offset:4096
  ds_read_b128 v[208:211], v25 offset:16384
  ds_read_b128 v[212:215], v25 offset:20480
  ds_read_b128 v[216:219], v26 offset:16384
  ds_read_b128 v[220:223], v26 offset:20480
  ds_read_b128 v[224:227], v27 offset:16384
  ds_read_b128 v[228:231], v27 offset:20480
  ds_read_b128 v[232:235], v28 offset:16384
  s_waitcnt lgkmcnt(14)
  ds_read_b128 v[236:239], v28 offset:20480
  s_waitcnt lgkmcnt(0)
  s_barrier
  s_waitcnt lgkmcnt(6)
  v_mfma_f32_16x16x32_bf16 v[32:35], v[240:243], v[176:179], v[32:35]
  ds_read_b64_tr_b16 v[6:7], v16 offset:8192
  v_mfma_f32_16x16x32_bf16 v[40:43], v[240:243], v[180:183], v[40:43]
  ds_read_b64_tr_b16 v[8:9], v16 offset:8704
  s_waitcnt lgkmcnt(6)
  v_mfma_f32_16x16x32_bf16 v[36:39], v[244:247], v[176:179], v[36:39]
  ds_read_b64_tr_b16 v[240:241], v17 offset:8192
  v_mfma_f32_16x16x32_bf16 v[44:47], v[244:247], v[180:183], v[44:47]
  ds_read_b64_tr_b16 v[242:243], v17 offset:8704
  s_waitcnt lgkmcnt(6)
  v_mfma_f32_16x16x32_bf16 v[32:35], v[248:251], v[184:187], v[32:35]
  ds_read_b64_tr_b16 v[244:245], v16 offset:12288
  v_mfma_f32_16x16x32_bf16 v[40:43], v[248:251], v[188:191], v[40:43]
  ds_read_b64_tr_b16 v[246:247], v16 offset:12800
  s_waitcnt lgkmcnt(6)
  v_mfma_f32_16x16x32_bf16 v[36:39], v[252:255], v[184:187], v[36:39]
  ds_read_b64_tr_b16 v[248:249], v17 offset:12288
  v_mfma_f32_16x16x32_bf16 v[44:47], v[252:255], v[188:191], v[44:47]
  ds_read_b64_tr_b16 v[250:251], v17 offset:12800
  s_waitcnt lgkmcnt(6)
  v_mfma_f32_16x16x32_bf16 v[32:35], v[6:9], v[192:195], v[32:35]
  ds_read_b64_tr_b16 v[252:253], v16 offset:16384
  v_mfma_f32_16x16x32_bf16 v[40:43], v[6:9], v[196:199], v[40:43]
  ds_read_b64_tr_b16 v[254:255], v16 offset:16896
  s_waitcnt lgkmcnt(6)
  v_mfma_f32_16x16x32_bf16 v[36:39], v[240:243], v[192:195], v[36:39]
  ds_read_b64_tr_b16 v[6:7], v17 offset:16384
  v_mfma_f32_16x16x32_bf16 v[44:47], v[240:243], v[196:199], v[44:47]
  ds_read_b64_tr_b16 v[8:9], v17 offset:16896
  s_waitcnt lgkmcnt(6)
  v_mfma_f32_16x16x32_bf16 v[32:35], v[244:247], v[200:203], v[32:35]
  ds_read_b64_tr_b16 v[240:241], v16 offset:20480
  v_mfma_f32_16x16x32_bf16 v[40:43], v[244:247], v[204:207], v[40:43]
  ds_read_b64_tr_b16 v[242:243], v16 offset:20992
  s_waitcnt lgkmcnt(6)
  v_mfma_f32_16x16x32_bf16 v[36:39], v[248:251], v[200:203], v[36:39]
  ds_read_b64_tr_b16 v[244:245], v17 offset:20480
  v_mfma_f32_16x16x32_bf16 v[44:47], v[248:251], v[204:207], v[44:47]
  ds_read_b64_tr_b16 v[246:247], v17 offset:20992
  s_waitcnt lgkmcnt(6)
  v_mfma_f32_16x16x32_bf16 v[32:35], v[252:255], v[208:211], v[32:35]
  ds_read_b64_tr_b16 v[248:249], v16 offset:24576
  v_mfma_f32_16x16x32_bf16 v[40:43], v[252:255], v[212:215], v[40:43]
  ds_read_b64_tr_b16 v[250:251], v16 offset:25088
  s_waitcnt lgkmcnt(6)
  v_mfma_f32_16x16x32_bf16 v[36:39], v[6:9], v[208:211], v[36:39]
  ds_read_b64_tr_b16 v[252:253], v17 offset:24576
  v_mfma_f32_16x16x32_bf16 v[44:47], v[6:9], v[212:215], v[44:47]
  ds_read_b64_tr_b16 v[254:255], v17 offset:25088
  s_waitcnt lgkmcnt(6)
  v_mfma_f32_16x16x32_bf16 v[32:35], v[240:243], v[216:219], v[32:35]
  ds_read_b64_tr_b16 v[6:7], v16 offset:28672
  v_mfma_f32_16x16x32_bf16 v[40:43], v[240:243], v[220:223], v[40:43]
  ds_read_b64_tr_b16 v[8:9], v16 offset:29184
  s_waitcnt lgkmcnt(6)
  v_mfma_f32_16x16x32_bf16 v[36:39], v[244:247], v[216:219], v[36:39]
  ds_read_b64_tr_b16 v[240:241], v17 offset:28672
  v_mfma_f32_16x16x32_bf16 v[44:47], v[244:247], v[220:223], v[44:47]
  ds_read_b64_tr_b16 v[242:243], v17 offset:29184
  s_waitcnt lgkmcnt(6)
  v_mfma_f32_16x16x32_bf16 v[32:35], v[248:251], v[224:227], v[32:35]
  ds_read_b64_tr_b16 v[244:245], v16 offset:32768
  v_mfma_f32_16x16x32_bf16 v[40:43], v[248:251], v[228:231], v[40:43]
  ds_read_b64_tr_b16 v[246:247], v16 offset:33280
  s_waitcnt lgkmcnt(6)
  v_mfma_f32_16x16x32_bf16 v[36:39], v[252:255], v[224:227], v[36:39]
  ds_read_b64_tr_b16 v[248:249], v17 offset:32768
  v_mfma_f32_16x16x32_bf16 v[44:47], v[252:255], v[228:231], v[44:47]
  ds_read_b64_tr_b16 v[250:251], v17 offset:33280
  s_waitcnt lgkmcnt(6)
  v_mfma_f32_16x16x32_bf16 v[32:35], v[6:9], v[232:235], v[32:35]
  ds_read_b64_tr_b16 v[252:253], v16 offset:36864
  v_mfma_f32_16x16x32_bf16 v[40:43], v[6:9], v[236:239], v[40:43]
  ds_read_b64_tr_b16 v[254:255], v16 offset:37376
  s_waitcnt lgkmcnt(6)
  v_mfma_f32_16x16x32_bf16 v[36:39], v[240:243], v[232:235], v[36:39]
  ds_read_b64_tr_b16 v[6:7], v17 offset:36864
  v_mfma_f32_16x16x32_bf16 v[44:47], v[240:243], v[236:239], v[44:47]
  ds_read_b64_tr_b16 v[8:9], v17 offset:37376
  s_barrier
  s_waitcnt lgkmcnt(6)
  v_mfma_f32_16x16x32_bf16 v[48:51], v[244:247], v[176:179], v[48:51]
  ds_read_b64_tr_b16 v[240:241], v16 offset:40960
  v_mfma_f32_16x16x32_bf16 v[56:59], v[244:247], v[180:183], v[56:59]
  ds_read_b64_tr_b16 v[242:243], v16 offset:41472
  s_waitcnt lgkmcnt(6)
  v_mfma_f32_16x16x32_bf16 v[52:55], v[248:251], v[176:179], v[52:55]
  ds_read_b64_tr_b16 v[244:245], v17 offset:40960
  v_mfma_f32_16x16x32_bf16 v[60:63], v[248:251], v[180:183], v[60:63]
  ds_read_b64_tr_b16 v[246:247], v17 offset:41472
  s_waitcnt lgkmcnt(6)
  v_mfma_f32_16x16x32_bf16 v[48:51], v[252:255], v[184:187], v[48:51]
  ds_read_b64_tr_b16 v[248:249], v16 offset:45056
  v_mfma_f32_16x16x32_bf16 v[56:59], v[252:255], v[188:191], v[56:59]
  ds_read_b64_tr_b16 v[250:251], v16 offset:45568
  s_waitcnt lgkmcnt(6)
  v_mfma_f32_16x16x32_bf16 v[52:55], v[6:9], v[184:187], v[52:55]
  ds_read_b64_tr_b16 v[252:253], v17 offset:45056
  v_mfma_f32_16x16x32_bf16 v[60:63], v[6:9], v[188:191], v[60:63]
  ds_read_b64_tr_b16 v[254:255], v17 offset:45568
  s_waitcnt lgkmcnt(6)
  v_mfma_f32_16x16x32_bf16 v[48:51], v[240:243], v[192:195], v[48:51]
  ds_read_b64_tr_b16 v[6:7], v16 offset:49152
  v_mfma_f32_16x16x32_bf16 v[56:59], v[240:243], v[196:199], v[56:59]
  ds_read_b64_tr_b16 v[8:9], v16 offset:49664
  s_waitcnt lgkmcnt(6)
  v_mfma_f32_16x16x32_bf16 v[52:55], v[244:247], v[192:195], v[52:55]
  ds_read_b64_tr_b16 v[240:241], v17 offset:49152
  v_mfma_f32_16x16x32_bf16 v[60:63], v[244:247], v[196:199], v[60:63]
  ds_read_b64_tr_b16 v[242:243], v17 offset:49664
  s_waitcnt lgkmcnt(6)
  v_mfma_f32_16x16x32_bf16 v[48:51], v[248:251], v[200:203], v[48:51]
  ds_read_b64_tr_b16 v[244:245], v16 offset:53248
  v_mfma_f32_16x16x32_bf16 v[56:59], v[248:251], v[204:207], v[56:59]
  ds_read_b64_tr_b16 v[246:247], v16 offset:53760
  s_waitcnt lgkmcnt(6)
  v_mfma_f32_16x16x32_bf16 v[52:55], v[252:255], v[200:203], v[52:55]
  ds_read_b64_tr_b16 v[248:249], v17 offset:53248
  v_mfma_f32_16x16x32_bf16 v[60:63], v[252:255], v[204:207], v[60:63]
  ds_read_b64_tr_b16 v[250:251], v17 offset:53760
  s_waitcnt lgkmcnt(6)
  v_mfma_f32_16x16x32_bf16 v[48:51], v[6:9], v[208:211], v[48:51]
  ds_read_b64_tr_b16 v[252:253], v16 offset:57344
  v_mfma_f32_16x16x32_bf16 v[56:59], v[6:9], v[212:215], v[56:59]
  ds_read_b64_tr_b16 v[254:255], v16 offset:57856
  s_waitcnt lgkmcnt(6)
  v_mfma_f32_16x16x32_bf16 v[52:55], v[240:243], v[208:211], v[52:55]
  ds_read_b64_tr_b16 v[6:7], v17 offset:57344
  v_mfma_f32_16x16x32_bf16 v[60:63], v[240:243], v[212:215], v[60:63]
  ds_read_b64_tr_b16 v[8:9], v17 offset:57856
  s_waitcnt lgkmcnt(6)
  v_mfma_f32_16x16x32_bf16 v[48:51], v[244:247], v[216:219], v[48:51]
  ds_read_b64_tr_b16 v[240:241], v16 offset:61440
  v_mfma_f32_16x16x32_bf16 v[56:59], v[244:247], v[220:223], v[56:59]
  ds_read_b64_tr_b16 v[242:243], v16 offset:61952
  s_waitcnt lgkmcnt(6)
  v_mfma_f32_16x16x32_bf16 v[52:55], v[248:251], v[216:219], v[52:55]
  ds_read_b64_tr_b16 v[244:245], v17 offset:61440
  v_mfma_f32_16x16x32_bf16 v[60:63], v[248:251], v[220:223], v[60:63]
  ds_read_b64_tr_b16 v[246:247], v17 offset:61952
  s_waitcnt lgkmcnt(6)
  v_mfma_f32_16x16x32_bf16 v[48:51], v[252:255], v[224:227], v[48:51]
  ds_read_b64_tr_b16 v[248:249], v14 offset:0
  v_mfma_f32_16x16x32_bf16 v[56:59], v[252:255], v[228:231], v[56:59]
  ds_read_b64_tr_b16 v[250:251], v14 offset:512
  v_cvt_pk_bf16_f32 v32, v32, v33
  v_cvt_pk_bf16_f32 v33, v34, v35
  v_cvt_pk_bf16_f32 v34, v36, v37
  v_cvt_pk_bf16_f32 v35, v38, v39
  v_cvt_pk_bf16_f32 v36, v40, v41
  v_cvt_pk_bf16_f32 v37, v42, v43
  v_cvt_pk_bf16_f32 v38, v44, v45
  v_cvt_pk_bf16_f32 v39, v46, v47
  s_lshl_b32 s37, s48, 6
  s_sub_u32 s38, s37, s55
  s_cmp_lt_u32 s38, 9216
  s_cbranch_scc1 L_s441
  buffer_store_dwordx4 v[32:35], v24, s[32:35], s37 offen offset:0 sc1
L_s441:
  s_add_u32 s38, s38, 1024
  s_cmp_lt_u32 s38, 9216
  s_cbranch_scc1 L_s442
  buffer_store_dwordx4 v[36:39], v24, s[32:35], s37 offen offset:1024 sc1
L_s442:
  s_add_u32 s48, s48, 128
  s_cmp_eq_u32 s48, 1152
  s_cselect_b32 s48, 0, s48
  s_waitcnt lgkmcnt(6)
  v_mfma_f32_16x16x32_bf16 v[52:55], v[6:9], v[224:227], v[52:55]
  ds_read_b64_tr_b16 v[252:253], v15 offset:0
  v_mfma_f32_16x16x32_bf16 v[60:63], v[6:9], v[228:231], v[60:63]
  ds_read_b64_tr_b16 v[254:255], v15 offset:512
  s_waitcnt lgkmcnt(6)
  v_mfma_f32_16x16x32_bf16 v[48:51], v[240:243], v[232:235], v[48:51]
  ds_read_b64_tr_b16 v[6:7], v14 offset:4096
  v_mfma_f32_16x16x32_bf16 v[56:59], v[240:243], v[236:239], v[56:59]
  ds_read_b64_tr_b16 v[8:9], v14 offset:4608
  s_waitcnt lgkmcnt(6)
  v_mfma_f32_16x16x32_bf16 v[52:55], v[244:247], v[232:235], v[52:55]
  ds_read_b64_tr_b16 v[240:241], v15 offset:4096
  v_mfma_f32_16x16x32_bf16 v[60:63], v[244:247], v[236:239], v[60:63]
  ds_read_b64_tr_b16 v[242:243], v15 offset:4608
  s_barrier
  s_waitcnt lgkmcnt(6)
  v_mfma_f32_16x16x32_bf16 v[64:67], v[248:251], v[176:179], v[64:67]
  ds_read_b64_tr_b16 v[244:245], v14 offset:8192
  v_mfma_f32_16x16x32_bf16 v[72:75], v[248:251], v[180:183], v[72:75]
  ds_read_b64_tr_b16 v[246:247], v14 offset:8704
  s_waitcnt lgkmcnt(6)
  v_mfma_f32_16x16x32_bf16 v[68:71], v[252:255], v[176:179], v[68:71]
  ds_read_b64_tr_b16 v[248:249], v15 offset:8192
  v_mfma_f32_16x16x32_bf16 v[76:79], v[252:255], v[180:183], v[76:79]
  ds_read_b64_tr_b16 v[250:251], v15 offset:8704
  s_waitcnt lgkmcnt(6)
  v_mfma_f32_16x16x32_bf16 v[64:67], v[6:9], v[184:187], v[64:67]
  ds_read_b64_tr_b16 v[252:253], v14 offset:12288
  v_mfma_f32_16x16x32_bf16 v[72:75], v[6:9], v[188:191], v[72:75]
  ds_read_b64_tr_b16 v[254:255], v14 offset:12800
  s_waitcnt lgkmcnt(6)
  v_mfma_f32_16x16x32_bf16 v[68:71], v[240:243], v[184:187], v[68:71]
  ds_read_b64_tr_b16 v[6:7], v15 offset:12288
  v_mfma_f32_16x16x32_bf16 v[76:79], v[240:243], v[188:191], v[76:79]
  ds_read_b64_tr_b16 v[8:9], v15 offset:12800
  s_waitcnt lgkmcnt(6)
  v_mfma_f32_16x16x32_bf16 v[64:67], v[244:247], v[192:195], v[64:67]
  ds_read_b64_tr_b16 v[240:241], v14 offset:16384
  v_mfma_f32_16x16x32_bf16 v[72:75], v[244:247], v[196:199], v[72:75]
  ds_read_b64_tr_b16 v[242:243], v14 offset:16896
  s_waitcnt lgkmcnt(6)
  v_mfma_f32_16x16x32_bf16 v[68:71], v[248:251], v[192:195], v[68:71]
  ds_read_b64_tr_b16 v[244:245], v15 offset:16384
  v_mfma_f32_16x16x32_bf16 v[76:79], v[248:251], v[196:199], v[76:79]
  ds_read_b64_tr_b16 v[246:247], v15 offset:16896
  s_waitcnt lgkmcnt(6)
  v_mfma_f32_16x16x32_bf16 v[64:67], v[252:255], v[200:203], v[64:67]
  ds_read_b64_tr_b16 v[248:249], v14 offset:20480
  v_mfma_f32_16x16x32_bf16 v[72:75], v[252:255], v[204:207], v[72:75]
  ds_read_b64_tr_b16 v[250:251], v14 offset:20992
  s_waitcnt lgkmcnt(6)
  v_mfma_f32_16x16x32_bf16 v[68:71], v[6:9], v[200:203], v[68:71]
  ds_read_b64_tr_b16 v[252:253], v15 offset:20480
  v_mfma_f32_16x16x32_bf16 v[76:79], v[6:9], v[204:207], v[76:79]
  ds_read_b64_tr_b16 v[254:255], v15 offset:20992
  s_waitcnt lgkmcnt(6)
  v_mfma_f32_16x16x32_bf16 v[64:67], v[240:243], v[208:211], v[64:67]
  ds_read_b64_tr_b16 v[6:7], v14 offset:24576
  v_mfma_f32_16x16x32_bf16 v[72:75], v[240:243], v[212:215], v[72:75]
  ds_read_b64_tr_b16 v[8:9], v14 offset:25088
  s_waitcnt lgkmcnt(6)
  v_mfma_f32_16x16x32_bf16 v[68:71], v[244:247], v[208:211], v[68:71]
  ds_read_b64_tr_b16 v[240:241], v15 offset:24576
  v_mfma_f32_16x16x32_bf16 v[76:79], v[244:247], v[212:215], v[76:79]
  ds_read_b64_tr_b16 v[242:243], v15 offset:25088
  s_waitcnt lgkmcnt(6)
  v_mfma_f32_16x16x32_bf16 v[64:67], v[248:251], v[216:219], v[64:67]
  ds_read_b64_tr_b16 v[244:245], v14 offset:28672
  v_mfma_f32_16x16x32_bf16 v[72:75], v[248:251], v[220:223], v[72:75]
  ds_read_b64_tr_b16 v[246:247], v14 offset:29184
  s_waitcnt lgkmcnt(6)
  v_mfma_f32_16x16x32_bf16 v[68:71], v[252:255], v[216:219], v[68:71]
  ds_read_b64_tr_b16 v[248:249], v15 offset:28672
  v_mfma_f32_16x16x32_bf16 v[76:79], v[252:255], v[220:223], v[76:79]
  ds_read_b64_tr_b16 v[250:251], v15 offset:29184
  s_waitcnt lgkmcnt(6)
  v_mfma_f32_16x16x32_bf16 v[64:67], v[6:9], v[224:227], v[64:67]
  ds_read_b64_tr_b16 v[252:253], v14 offset:32768
  v_mfma_f32_16x16x32_bf16 v[72:75], v[6:9], v[228:231], v[72:75]
  ds_read_b64_tr_b16 v[254:255], v14 offset:33280
  v_cvt_pk_bf16_f32 v48, v48, v49
  v_cvt_pk_bf16_f32 v49, v50, v51
  v_cvt_pk_bf16_f32 v50, v52, v53
  v_cvt_pk_bf16_f32 v51, v54, v55
  v_cvt_pk_bf16_f32 v52, v56, v57
  v_cvt_pk_bf16_f32 v53, v58, v59
  v_cvt_pk_bf16_f32 v54, v60, v61
  v_cvt_pk_bf16_f32 v55, v62, v63
  s_lshl_b32 s37, s48, 6
  s_sub_u32 s38, s37, s55
  s_cmp_lt_u32 s38, 9216
  s_cbranch_scc1 L_s443
  buffer_store_dwordx4 v[48:51], v24, s[32:35], s37 offen offset:0 sc1
L_s443:
  s_add_u32 s38, s38, 1024
  s_cmp_lt_u32 s38, 9216
  s_cbranch_scc1 L_s444
  buffer_store_dwordx4 v[52:55], v24, s[32:35], s37 offen offset:1024 sc1
L_s444:
  s_add_u32 s48, s48, 128
  s_cmp_eq_u32 s48, 1152
  s_cselect_b32 s48, 0, s48
  s_waitcnt lgkmcnt(6)
  v_mfma_f32_16x16x32_bf16 v[68:71], v[240:243], v[224:227], v[68:71]
  ds_read_b64_tr_b16 v[6:7], v15 offset:32768
  v_mfma_f32_16x16x32_bf16 v[76:79], v[240:243], v[228:231], v[76:79]
  ds_read_b64_tr_b16 v[8:9], v15 offset:33280
  s_waitcnt lgkmcnt(6)
  v_mfma_f32_16x16x32_bf16 v[64:67], v[244:247], v[232:235], v[64:67]
  ds_read_b64_tr_b16 v[240:241], v14 offset:36864
  v_mfma_f32_16x16x32_bf16 v[72:75], v[244:247], v[236:239], v[72:75]
  ds_read_b64_tr_b16 v[242:243], v14 offset:37376
  s_waitcnt lgkmcnt(6)
  v_mfma_f32_16x16x32_bf16 v[68:71], v[248:251], v[232:235], v[68:71]
  ds_read_b64_tr_b16 v[244:245], v15 offset:36864
  v_mfma_f32_16x16x32_bf16 v[76:79], v[248:251], v[236:239], v[76:79]
  ds_read_b64_tr_b16 v[246:247], v15 offset:37376
  s_barrier
  s_waitcnt lgkmcnt(6)
  v_mfma_f32_16x16x32_bf16 v[80:83], v[252:255], v[176:179], v[80:83]
  ds_read_b64_tr_b16 v[248:249], v14 offset:40960
  v_mfma_f32_16x16x32_bf16 v[88:91], v[252:255], v[180:183], v[88:91]
  ds_read_b64_tr_b16 v[250:251], v14 offset:41472
  s_waitcnt lgkmcnt(6)
  v_mfma_f32_16x16x32_bf16 v[84:87], v[6:9], v[176:179], v[84:87]
  ds_read_b64_tr_b16 v[252:253], v15 offset:40960
  v_mfma_f32_16x16x32_bf16 v[92:95], v[6:9], v[180:183], v[92:95]
  ds_read_b64_tr_b16 v[254:255], v15 offset:41472
  s_waitcnt lgkmcnt(6)
  v_mfma_f32_16x16x32_bf16 v[80:83], v[240:243], v[184:187], v[80:83]
  ds_read_b64_tr_b16 v[6:7], v14 offset:45056
  v_mfma_f32_16x16x32_bf16 v[88:91], v[240:243], v[188:191], v[88:91]
  ds_read_b64_tr_b16 v[8:9], v14 offset:45568
  s_waitcnt lgkmcnt(6)
  v_mfma_f32_16x16x32_bf16 v[84:87], v[244:247], v[184:187], v[84:87]
  ds_read_b64_tr_b16 v[240:241], v15 offset:45056
  v_mfma_f32_16x16x32_bf16 v[92:95], v[244:247], v[188:191], v[92:95]
  ds_read_b64_tr_b16 v[242:243], v15 offset:45568
  s_waitcnt lgkmcnt(6)
  v_mfma_f32_16x16x32_bf16 v[80:83], v[248:251], v[192:195], v[80:83]
  ds_read_b64_tr_b16 v[244:245], v14 offset:49152
  v_mfma_f32_16x16x32_bf16 v[88:91], v[248:251], v[196:199], v[88:91]
  ds_read_b64_tr_b16 v[246:247], v14 offset:49664
  s_waitcnt lgkmcnt(6)
  v_mfma_f32_16x16x32_bf16 v[84:87], v[252:255], v[192:195], v[84:87]
  ds_read_b64_tr_b16 v[248:249], v15 offset:49152
  v_mfma_f32_16x16x32_bf16 v[92:95], v[252:255], v[196:199], v[92:95]
  ds_read_b64_tr_b16 v[250:251], v15 offset:49664
  s_waitcnt lgkmcnt(6)
  v_mfma_f32_16x16x32_bf16 v[80:83], v[6:9], v[200:203], v[80:83]
  ds_read_b64_tr_b16 v[252:253], v14 offset:53248
  v_mfma_f32_16x16x32_bf16 v[88:91], v[6:9], v[204:207], v[88:91]
  ds_read_b64_tr_b16 v[254:255], v14 offset:53760
  s_waitcnt lgkmcnt(6)
  v_mfma_f32_16x16x32_bf16 v[84:87], v[240:243], v[200:203], v[84:87]
  ds_read_b64_tr_b16 v[6:7], v15 offset:53248
  v_mfma_f32_16x16x32_bf16 v[92:95], v[240:243], v[204:207], v[92:95]
  ds_read_b64_tr_b16 v[8:9], v15 offset:53760
  s_waitcnt lgkmcnt(6)
  v_mfma_f32_16x16x32_bf16 v[80:83], v[244:247], v[208:211], v[80:83]
  ds_read_b64_tr_b16 v[240:241], v14 offset:57344
  v_mfma_f32_16x16x32_bf16 v[88:91], v[244:247], v[212:215], v[88:91]
  ds_read_b64_tr_b16 v[242:243], v14 offset:57856
  s_waitcnt lgkmcnt(6)
  v_mfma_f32_16x16x32_bf16 v[84:87], v[248:251], v[208:211], v[84:87]
  ds_read_b64_tr_b16 v[244:245], v15 offset:57344
  v_mfma_f32_16x16x32_bf16 v[92:95], v[248:251], v[212:215], v[92:95]
  ds_read_b64_tr_b16 v[246:247], v15 offset:57856
  s_waitcnt lgkmcnt(6)
  v_mfma_f32_16x16x32_bf16 v[80:83], v[252:255], v[216:219], v[80:83]
  ds_read_b64_tr_b16 v[248:249], v14 offset:61440
  v_mfma_f32_16x16x32_bf16 v[88:91], v[252:255], v[220:223], v[88:91]
  ds_read_b64_tr_b16 v[250:251], v14 offset:61952
  s_waitcnt lgkmcnt(6)
  v_mfma_f32_16x16x32_bf16 v[84:87], v[6:9], v[216:219], v[84:87]
  ds_read_b64_tr_b16 v[252:253], v15 offset:61440
  v_mfma_f32_16x16x32_bf16 v[92:95], v[6:9], v[220:223], v[92:95]
  ds_read_b64_tr_b16 v[254:255], v15 offset:61952
  s_waitcnt lgkmcnt(6)
  v_mfma_f32_16x16x32_bf16 v[80:83], v[240:243], v[224:227], v[80:83]
  ds_read_b64_tr_b16 v[6:7], v18 offset:0
  v_mfma_f32_16x16x32_bf16 v[88:91], v[240:243], v[228:231], v[88:91]
  ds_read_b64_tr_b16 v[8:9], v18 offset:512
  v_cvt_pk_bf16_f32 v64, v64, v65
  v_cvt_pk_bf16_f32 v65, v66, v67
  v_cvt_pk_bf16_f32 v66, v68, v69
  v_cvt_pk_bf16_f32 v67, v70, v71
  v_cvt_pk_bf16_f32 v68, v72, v73
  v_cvt_pk_bf16_f32 v69, v74, v75
  v_cvt_pk_bf16_f32 v70, v76, v77
  v_cvt_pk_bf16_f32 v71, v78, v79
  s_lshl_b32 s37, s48, 6
  s_sub_u32 s38, s37, s55
  s_cmp_lt_u32 s38, 9216
  s_cbranch_scc1 L_s445
  buffer_store_dwordx4 v[64:67], v24, s[32:35], s37 offen offset:0 sc1
L_s445:
  s_add_u32 s38, s38, 1024
  s_cmp_lt_u32 s38, 9216
  s_cbranch_scc1 L_s446
  buffer_store_dwordx4 v[68:71], v24, s[32:35], s37 offen offset:1024 sc1
L_s446:
  s_add_u32 s48, s48, 128
  s_cmp_eq_u32 s48, 1152
  s_cselect_b32 s48, 0, s48
  s_waitcnt lgkmcnt(6)
  v_mfma_f32_16x16x32_bf16 v[84:87], v[244:247], v[224:227], v[84:87]
  ds_read_b64_tr_b16 v[240:241], v19 offset:0
  v_mfma_f32_16x16x32_bf16 v[92:95], v[244:247], v[228:231], v[92:95]
  ds_read_b64_tr_b16 v[242:243], v19 offset:512
  s_waitcnt lgkmcnt(6)
  v_mfma_f32_16x16x32_bf16 v[80:83], v[248:251], v[232:235], v[80:83]
  ds_read_b64_tr_b16 v[244:245], v18 offset:4096
  v_mfma_f32_16x16x32_bf16 v[88:91], v[248:251], v[236:239], v[88:91]
  ds_read_b64_tr_b16 v[246:247], v18 offset:4608
  s_waitcnt lgkmcnt(6)
  v_mfma_f32_16x16x32_bf16 v[84:87], v[252:255], v[232:235], v[84:87]
  ds_read_b64_tr_b16 v[248:249], v19 offset:4096
  v_mfma_f32_16x16x32_bf16 v[92:95], v[252:255], v[236:239], v[92:95]
  ds_read_b64_tr_b16 v[250:251], v19 offset:4608
  s_barrier
  s_waitcnt lgkmcnt(6)
  v_mfma_f32_16x16x32_bf16 v[96:99], v[6:9], v[176:179], v[96:99]
  ds_read_b64_tr_b16 v[252:253], v18 offset:8192
  v_mfma_f32_16x16x32_bf16 v[104:107], v[6:9], v[180:183], v[104:107]
  ds_read_b64_tr_b16 v[254:255], v18 offset:8704
  s_waitcnt lgkmcnt(6)
  v_mfma_f32_16x16x32_bf16 v[100:103], v[240:243], v[176:179], v[100:103]
  ds_read_b64_tr_b16 v[6:7], v19 offset:8192
  v_mfma_f32_16x16x32_bf16 v[108:111], v[240:243], v[180:183], v[108:111]
  ds_read_b64_tr_b16 v[8:9], v19 offset:8704
  s_waitcnt lgkmcnt(6)
  v_mfma_f32_16x16x32_bf16 v[96:99], v[244:247], v[184:187], v[96:99]
  ds_read_b64_tr_b16 v[240:241], v18 offset:12288
  v_mfma_f32_16x16x32_bf16 v[104:107], v[244:247], v[188:191], v[104:107]
  ds_read_b64_tr_b16 v[242:243], v18 offset:12800
  s_waitcnt lgkmcnt(6)
  v_mfma_f32_16x16x32_bf16 v[100:103], v[248:251], v[184:187], v[100:103]
  ds_read_b64_tr_b16 v[244:245], v19 offset:12288
  v_mfma_f32_16x16x32_bf16 v[108:111], v[248:251], v[188:191], v[108:111]
  ds_read_b64_tr_b16 v[246:247], v19 offset:12800
  s_waitcnt lgkmcnt(6)
  v_mfma_f32_16x16x32_bf16 v[96:99], v[252:255], v[192:195], v[96:99]
  ds_read_b64_tr_b16 v[248:249], v18 offset:16384
  v_mfma_f32_16x16x32_bf16 v[104:107], v[252:255], v[196:199], v[104:107]
  ds_read_b64_tr_b16 v[250:251], v18 offset:16896
  s_waitcnt lgkmcnt(6)
  v_mfma_f32_16x16x32_bf16 v[100:103], v[6:9], v[192:195], v[100:103]
  ds_read_b64_tr_b16 v[252:253], v19 offset:16384
  v_mfma_f32_16x16x32_bf16 v[108:111], v[6:9], v[196:199], v[108:111]
  ds_read_b64_tr_b16 v[254:255], v19 offset:16896
  s_waitcnt lgkmcnt(6)
  v_mfma_f32_16x16x32_bf16 v[96:99], v[240:243], v[200:203], v[96:99]
  ds_read_b64_tr_b16 v[6:7], v18 offset:20480
  v_mfma_f32_16x16x32_bf16 v[104:107], v[240:243], v[204:207], v[104:107]
  ds_read_b64_tr_b16 v[8:9], v18 offset:20992
  s_waitcnt lgkmcnt(6)
  v_mfma_f32_16x16x32_bf16 v[100:103], v[244:247], v[200:203], v[100:103]
  ds_read_b64_tr_b16 v[240:241], v19 offset:20480
  v_mfma_f32_16x16x32_bf16 v[108:111], v[244:247], v[204:207], v[108:111]
  ds_read_b64_tr_b16 v[242:243], v19 offset:20992
  s_waitcnt lgkmcnt(6)
  v_mfma_f32_16x16x32_bf16 v[96:99], v[248:251], v[208:211], v[96:99]
  ds_read_b64_tr_b16 v[244:245], v18 offset:24576
  v_mfma_f32_16x16x32_bf16 v[104:107], v[248:251], v[212:215], v[104:107]
  ds_read_b64_tr_b16 v[246:247], v18 offset:25088
  s_waitcnt lgkmcnt(6)
  v_mfma_f32_16x16x32_bf16 v[100:103], v[252:255], v[208:211], v[100:103]
  ds_read_b64_tr_b16 v[248:249], v19 offset:24576
  v_mfma_f32_16x16x32_bf16 v[108:111], v[252:255], v[212:215], v[108:111]
  ds_read_b64_tr_b16 v[250:251], v19 offset:25088
  s_waitcnt lgkmcnt(6)
  v_mfma_f32_16x16x32_bf16 v[96:99], v[6:9], v[216:219], v[96:99]
  ds_read_b64_tr_b16 v[252:253], v18 offset:28672
  v_mfma_f32_16x16x32_bf16 v[104:107], v[6:9], v[220:223], v[104:107]
  ds_read_b64_tr_b16 v[254:255], v18 offset:29184
  s_waitcnt lgkmcnt(6)
  v_mfma_f32_16x16x32_bf16 v[100:103], v[240:243], v[216:219], v[100:103]
  ds_read_b64_tr_b16 v[6:7], v19 offset:28672
  v_mfma_f32_16x16x32_bf16 v[108:111], v[240:243], v[220:223], v[108:111]
  ds_read_b64_tr_b16 v[8:9], v19 offset:29184
  s_waitcnt lgkmcnt(6)
  v_mfma_f32_16x16x32_bf16 v[96:99], v[244:247], v[224:227], v[96:99]
  ds_read_b64_tr_b16 v[240:241], v16 offset:0
  v_mfma_f32_16x16x32_bf16 v[104:107], v[244:247], v[228:231], v[104:107]
  ds_read_b64_tr_b16 v[242:243], v16 offset:512
  v_cvt_pk_bf16_f32 v80, v80, v81
  v_cvt_pk_bf16_f32 v81, v82, v83
  v_cvt_pk_bf16_f32 v82, v84, v85
  v_cvt_pk_bf16_f32 v83, v86, v87
  v_cvt_pk_bf16_f32 v84, v88, v89
  v_cvt_pk_bf16_f32 v85, v90, v91
  v_cvt_pk_bf16_f32 v86, v92, v93
  v_cvt_pk_bf16_f32 v87, v94, v95
  s_lshl_b32 s37, s48, 6
  s_sub_u32 s38, s37, s55
  s_cmp_lt_u32 s38, 9216
  s_cbranch_scc1 L_s447
  buffer_store_dwordx4 v[80:83], v24, s[32:35], s37 offen offset:0 sc1
L_s447:
  s_add_u32 s38, s38, 1024
  s_cmp_lt_u32 s38, 9216
  s_cbranch_scc1 L_s448
  buffer_store_dwordx4 v[84:87], v24, s[32:35], s37 offen offset:1024 sc1
L_s448:
  s_add_u32 s48, s48, 128
  s_cmp_eq_u32 s48, 1152
  s_cselect_b32 s48, 0, s48
  s_waitcnt lgkmcnt(6)
  v_mfma_f32_16x16x32_bf16 v[100:103], v[248:251], v[224:227], v[100:103]
  ds_read_b64_tr_b16 v[244:245], v17 offset:0
  v_mfma_f32_16x16x32_bf16 v[108:111], v[248:251], v[228:231], v[108:111]
  ds_read_b64_tr_b16 v[246:247], v17 offset:512
  s_waitcnt lgkmcnt(6)
  v_mfma_f32_16x16x32_bf16 v[96:99], v[252:255], v[232:235], v[96:99]
  ds_read_b64_tr_b16 v[248:249], v16 offset:4096
  v_mfma_f32_16x16x32_bf16 v[104:107], v[252:255], v[236:239], v[104:107]
  ds_read_b64_tr_b16 v[250:251], v16 offset:4608
  s_waitcnt lgkmcnt(6)
  v_mfma_f32_16x16x32_bf16 v[100:103], v[6:9], v[232:235], v[100:103]
  ds_read_b64_tr_b16 v[252:253], v17 offset:4096
  v_mfma_f32_16x16x32_bf16 v[108:111], v[6:9], v[236:239], v[108:111]
  ds_read_b64_tr_b16 v[254:255], v17 offset:4608
  s_barrier
  s_waitcnt lgkmcnt(6)
  v_mfma_f32_16x16x32_bf16 v[112:115], v[240:243], v[176:179], v[112:115]
  ds_read_b64_tr_b16 v[6:7], v16 offset:8192
  v_mfma_f32_16x16x32_bf16 v[120:123], v[240:243], v[180:183], v[120:123]
  ds_read_b64_tr_b16 v[8:9], v16 offset:8704
  s_waitcnt lgkmcnt(6)
  v_mfma_f32_16x16x32_bf16 v[116:119], v[244:247], v[176:179], v[116:119]
  ds_read_b64_tr_b16 v[240:241], v17 offset:8192
  v_mfma_f32_16x16x32_bf16 v[124:127], v[244:247], v[180:183], v[124:127]
  ds_read_b64_tr_b16 v[242:243], v17 offset:8704
  s_lshl_b32 s37, s54, 6
  s_sub_u32 s38, s37, s55
  s_cmp_lt_u32 s38, 9216
  s_cbranch_scc0 L_s449
  v_add_u32 v25, s38, v20
  ds_write_b128 v25, v[32:35]
L_s449:
  s_add_u32 s38, s38, 1024
  s_cmp_lt_u32 s38, 9216
  s_cbranch_scc0 L_s450
  v_add_u32 v25, s38, v20
  ds_write_b128 v25, v[36:39]
L_s450:
  s_add_u32 s54, s54, 128
  s_cmp_eq_u32 s54, 1152
  s_cselect_b32 s54, 0, s54
  s_waitcnt lgkmcnt(6)
  v_mfma_f32_16x16x32_bf16 v[112:115], v[248:251], v[184:187], v[112:115]
  ds_read_b64_tr_b16 v[244:245], v16 offset:12288
  v_mfma_f32_16x16x32_bf16 v[120:123], v[248:251], v[188:191], v[120:123]
  ds_read_b64_tr_b16 v[246:247], v16 offset:12800
  s_waitcnt lgkmcnt(6)
  v_mfma_f32_16x16x32_bf16 v[116:119], v[252:255], v[184:187], v[116:119]
  ds_read_b64_tr_b16 v[248:249], v17 offset:12288
  v_mfma_f32_16x16x32_bf16 v[124:127], v[252:255], v[188:191], v[124:127]
  ds_read_b64_tr_b16 v[250:251], v17 offset:12800
  s_waitcnt lgkmcnt(6)
  v_mfma_f32_16x16x32_bf16 v[112:115], v[6:9], v[192:195], v[112:115]
  ds_read_b64_tr_b16 v[252:253], v16 offset:16384
  v_mfma_f32_16x16x32_bf16 v[120:123], v[6:9], v[196:199], v[120:123]
  ds_read_b64_tr_b16 v[254:255], v16 offset:16896
  s_waitcnt lgkmcnt(6)
  v_mfma_f32_16x16x32_bf16 v[116:119], v[240:243], v[192:195], v[116:119]
  ds_read_b64_tr_b16 v[6:7], v17 offset:16384
  v_mfma_f32_16x16x32_bf16 v[124:127], v[240:243], v[196:199], v[124:127]
  ds_read_b64_tr_b16 v[8:9], v17 offset:16896
  s_waitcnt lgkmcnt(6)
  v_mfma_f32_16x16x32_bf16 v[112:115], v[244:247], v[200:203], v[112:115]
  ds_read_b64_tr_b16 v[240:241], v16 offset:20480
  v_mfma_f32_16x16x32_bf16 v[120:123], v[244:247], v[204:207], v[120:123]
  ds_read_b64_tr_b16 v[242:243], v16 offset:20992
  s_waitcnt lgkmcnt(6)
  v_mfma_f32_16x16x32_bf16 v[116:119], v[248:251], v[200:203], v[116:119]
  ds_read_b64_tr_b16 v[244:245], v17 offset:20480
  v_mfma_f32_16x16x32_bf16 v[124:127], v[248:251], v[204:207], v[124:127]
  ds_read_b64_tr_b16 v[246:247], v17 offset:20992
  s_waitcnt lgkmcnt(6)
  v_mfma_f32_16x16x32_bf16 v[112:115], v[252:255], v[208:211], v[112:115]
  ds_read_b64_tr_b16 v[248:249], v16 offset:24576
  v_mfma_f32_16x16x32_bf16 v[120:123], v[252:255], v[212:215], v[120:123]
  ds_read_b64_tr_b16 v[250:251], v16 offset:25088
  s_waitcnt lgkmcnt(6)
  v_mfma_f32_16x16x32_bf16 v[116:119], v[6:9], v[208:211], v[116:119]
  ds_read_b64_tr_b16 v[252:253], v17 offset:24576
  v_mfma_f32_16x16x32_bf16 v[124:127], v[6:9], v[212:215], v[124:127]
  ds_read_b64_tr_b16 v[254:255], v17 offset:25088
  s_lshl_b32 s37, s54, 6
  s_sub_u32 s38, s37, s55
  s_cmp_lt_u32 s38, 9216
  s_cbranch_scc0 L_s451
  v_add_u32 v25, s38, v20
  ds_write_b128 v25, v[48:51]
L_s451:
  s_add_u32 s38, s38, 1024
  s_cmp_lt_u32 s38, 9216
  s_cbranch_scc0 L_s452
  v_add_u32 v25, s38, v20
  ds_write_b128 v25, v[52:55]
L_s452:
  s_add_u32 s54, s54, 128
  s_cmp_eq_u32 s54, 1152
  s_cselect_b32 s54, 0, s54
  s_waitcnt lgkmcnt(6)
  v_mfma_f32_16x16x32_bf16 v[112:115], v[240:243], v[216:219], v[112:115]
  ds_read_b64_tr_b16 v[6:7], v16 offset:28672
  v_mfma_f32_16x16x32_bf16 v[120:123], v[240:243], v[220:223], v[120:123]
  ds_read_b64_tr_b16 v[8:9], v16 offset:29184
  s_waitcnt lgkmcnt(6)
  v_mfma_f32_16x16x32_bf16 v[116:119], v[244:247], v[216:219], v[116:119]
  ds_read_b64_tr_b16 v[240:241], v17 offset:28672
  v_mfma_f32_16x16x32_bf16 v[124:127], v[244:247], v[220:223], v[124:127]
  ds_read_b64_tr_b16 v[242:243], v17 offset:29184
  s_waitcnt lgkmcnt(6)
  v_mfma_f32_16x16x32_bf16 v[112:115], v[248:251], v[224:227], v[112:115]
  ds_read_b64_tr_b16 v[244:245], v16 offset:32768
  v_mfma_f32_16x16x32_bf16 v[120:123], v[248:251], v[228:231], v[120:123]
  ds_read_b64_tr_b16 v[246:247], v16 offset:33280
  v_cvt_pk_bf16_f32 v96, v96, v97
  v_cvt_pk_bf16_f32 v97, v98, v99
  v_cvt_pk_bf16_f32 v98, v100, v101
  v_cvt_pk_bf16_f32 v99, v102, v103
  v_cvt_pk_bf16_f32 v100, v104, v105
  v_cvt_pk_bf16_f32 v101, v106, v107
  v_cvt_pk_bf16_f32 v102, v108, v109
  v_cvt_pk_bf16_f32 v103, v110, v111
  s_lshl_b32 s37, s48, 6
  s_sub_u32 s38, s37, s55
  s_cmp_lt_u32 s38, 9216
  s_cbranch_scc1 L_s453o
  buffer_store_dwordx4 v[96:99], v24, s[32:35], s37 offen offset:0 sc1
  s_branch L_s453
L_s453o:
  v_add_u32 v25, s38, v20
  ds_write_b128 v25, v[96:99]
L_s453:
  s_add_u32 s38, s38, 1024
  s_cmp_lt_u32 s38, 9216
  s_cbranch_scc1 L_s454o
  buffer_store_dwordx4 v[100:103], v24, s[32:35], s37 offen offset:1024 sc1
  s_branch L_s454
L_s454o:
  v_add_u32 v25, s38, v20
  ds_write_b128 v25, v[100:103]
L_s454:
  s_add_u32 s48, s48, 128
  s_cmp_eq_u32 s48, 1152
  s_cselect_b32 s48, 0, s48
  s_waitcnt lgkmcnt(6)
  v_mfma_f32_16x16x32_bf16 v[116:119], v[252:255], v[224:227], v[116:119]
  ds_read_b64_tr_b16 v[248:249], v17 offset:32768
  v_mfma_f32_16x16x32_bf16 v[124:127], v[252:255], v[228:231], v[124:127]
  ds_read_b64_tr_b16 v[250:251], v17 offset:33280
  s_waitcnt lgkmcnt(6)
  v_mfma_f32_16x16x32_bf16 v[112:115], v[6:9], v[232:235], v[112:115]
  ds_read_b64_tr_b16 v[252:253], v16 offset:36864
  v_mfma_f32_16x16x32_bf16 v[120:123], v[6:9], v[236:239], v[120:123]
  ds_read_b64_tr_b16 v[254:255], v16 offset:37376
  s_waitcnt lgkmcnt(6)
  v_mfma_f32_16x16x32_bf16 v[116:119], v[240:243], v[232:235], v[116:119]
  ds_read_b64_tr_b16 v[6:7], v17 offset:36864
  v_mfma_f32_16x16x32_bf16 v[124:127], v[240:243], v[236:239], v[124:127]
  ds_read_b64_tr_b16 v[8:9], v17 offset:37376
  s_barrier
  s_waitcnt lgkmcnt(6)
  v_mfma_f32_16x16x32_bf16 v[128:131], v[244:247], v[176:179], v[128:131]
  ds_read_b64_tr_b16 v[240:241], v16 offset:40960
  v_mfma_f32_16x16x32_bf16 v[136:139], v[244:247], v[180:183], v[136:139]
  ds_read_b64_tr_b16 v[242:243], v16 offset:41472
  s_waitcnt lgkmcnt(6)
  v_mfma_f32_16x16x32_bf16 v[132:135], v[248:251], v[176:179], v[132:135]
  ds_read_b64_tr_b16 v[244:245], v17 offset:40960
  v_mfma_f32_16x16x32_bf16 v[140:143], v[248:251], v[180:183], v[140:143]
  ds_read_b64_tr_b16 v[246:247], v17 offset:41472
  s_lshl_b32 s37, s54, 6
  s_sub_u32 s38, s37, s55
  s_cmp_lt_u32 s38, 9216
  s_cbranch_scc0 L_s455
  v_add_u32 v25, s38, v20
  ds_write_b128 v25, v[64:67]
L_s455:
  s_add_u32 s38, s38, 1024
  s_cmp_lt_u32 s38, 9216
  s_cbranch_scc0 L_s456
  v_add_u32 v25, s38, v20
  ds_write_b128 v25, v[68:71]
L_s456:
  s_add_u32 s54, s54, 128
  s_cmp_eq_u32 s54, 1152
  s_cselect_b32 s54, 0, s54
  s_waitcnt lgkmcnt(6)
  v_mfma_f32_16x16x32_bf16 v[128:131], v[252:255], v[184:187], v[128:131]
  ds_read_b64_tr_b16 v[248:249], v16 offset:45056
  v_mfma_f32_16x16x32_bf16 v[136:139], v[252:255], v[188:191], v[136:139]
  ds_read_b64_tr_b16 v[250:251], v16 offset:45568
  s_waitcnt lgkmcnt(6)
  v_mfma_f32_16x16x32_bf16 v[132:135], v[6:9], v[184:187], v[132:135]
  ds_read_b64_tr_b16 v[252:253], v17 offset:45056
  v_mfma_f32_16x16x32_bf16 v[140:143], v[6:9], v[188:191], v[140:143]
  ds_read_b64_tr_b16 v[254:255], v17 offset:45568
  s_waitcnt lgkmcnt(6)
  v_mfma_f32_16x16x32_bf16 v[128:131], v[240:243], v[192:195], v[128:131]
  ds_read_b64_tr_b16 v[6:7], v16 offset:49152
  v_mfma_f32_16x16x32_bf16 v[136:139], v[240:243], v[196:199], v[136:139]
  ds_read_b64_tr_b16 v[8:9], v16 offset:49664
  s_waitcnt lgkmcnt(6)
  v_mfma_f32_16x16x32_bf16 v[132:135], v[244:247], v[192:195], v[132:135]
  ds_read_b64_tr_b16 v[240:241], v17 offset:49152
  v_mfma_f32_16x16x32_bf16 v[140:143], v[244:247], v[196:199], v[140:143]
  ds_read_b64_tr_b16 v[242:243], v17 offset:49664
  s_waitcnt lgkmcnt(6)
  v_mfma_f32_16x16x32_bf16 v[128:131], v[248:251], v[200:203], v[128:131]
  ds_read_b64_tr_b16 v[244:245], v16 offset:53248
  v_mfma_f32_16x16x32_bf16 v[136:139], v[248:251], v[204:207], v[136:139]
  ds_read_b64_tr_b16 v[246:247], v16 offset:53760
  s_waitcnt lgkmcnt(6)
  v_mfma_f32_16x16x32_bf16 v[132:135], v[252:255], v[200:203], v[132:135]
  ds_read_b64_tr_b16 v[248:249], v17 offset:53248
  v_mfma_f32_16x16x32_bf16 v[140:143], v[252:255], v[204:207], v[140:143]
  ds_read_b64_tr_b16 v[250:251], v17 offset:53760
  s_waitcnt lgkmcnt(6)
  v_mfma_f32_16x16x32_bf16 v[128:131], v[6:9], v[208:211], v[128:131]
  ds_read_b64_tr_b16 v[252:253], v16 offset:57344
  v_mfma_f32_16x16x32_bf16 v[136:139], v[6:9], v[212:215], v[136:139]
  ds_read_b64_tr_b16 v[254:255], v16 offset:57856
  s_waitcnt lgkmcnt(6)
  v_mfma_f32_16x16x32_bf16 v[132:135], v[240:243], v[208:211], v[132:135]
  ds_read_b64_tr_b16 v[6:7], v17 offset:57344
  v_mfma_f32_16x16x32_bf16 v[140:143], v[240:243], v[212:215], v[140:143]
  ds_read_b64_tr_b16 v[8:9], v17 offset:57856
  s_lshl_b32 s37, s54, 6
  s_sub_u32 s38, s37, s55
  s_cmp_lt_u32 s38, 9216
  s_cbranch_scc0 L_s457
  v_add_u32 v25, s38, v20
  ds_write_b128 v25, v[80:83]
L_s457:
  s_add_u32 s38, s38, 1024
  s_cmp_lt_u32 s38, 9216
  s_cbranch_scc0 L_s458
  v_add_u32 v25, s38, v20
  ds_write_b128 v25, v[84:87]
L_s458:
  s_add_u32 s54, s54, 128
  s_cmp_eq_u32 s54, 1152
  s_cselect_b32 s54, 0, s54
  s_waitcnt lgkmcnt(6)
  v_mfma_f32_16x16x32_bf16 v[128:131], v[244:247], v[216:219], v[128:131]
  ds_read_b64_tr_b16 v[240:241], v16 offset:61440
  v_mfma_f32_16x16x32_bf16 v[136:139], v[244:247], v[220:223], v[136:139]
  ds_read_b64_tr_b16 v[242:243], v16 offset:61952
  s_waitcnt lgkmcnt(6)
  v_mfma_f32_16x16x32_bf16 v[132:135], v[248:251], v[216:219], v[132:135]
  ds_read_b64_tr_b16 v[244:245], v17 offset:61440
  v_mfma_f32_16x16x32_bf16 v[140:143], v[248:251], v[220:223], v[140:143]
  ds_read_b64_tr_b16 v[246:247], v17 offset:61952
  s_waitcnt lgkmcnt(6)
  v_mfma_f32_16x16x32_bf16 v[128:131], v[252:255], v[224:227], v[128:131]
  ds_read_b64_tr_b16 v[248:249], v14 offset:0
  v_mfma_f32_16x16x32_bf16 v[136:139], v[252:255], v[228:231], v[136:139]
  ds_read_b64_tr_b16 v[250:251], v14 offset:512
  v_cvt_pk_bf16_f32 v112, v112, v113
  v_cvt_pk_bf16_f32 v113, v114, v115
  v_cvt_pk_bf16_f32 v114, v116, v117
  v_cvt_pk_bf16_f32 v115, v118, v119
  v_cvt_pk_bf16_f32 v116, v120, v121
  v_cvt_pk_bf16_f32 v117, v122, v123
  v_cvt_pk_bf16_f32 v118, v124, v125
  v_cvt_pk_bf16_f32 v119, v126, v127
  s_lshl_b32 s37, s48, 6
  s_sub_u32 s38, s37, s55
  s_cmp_lt_u32 s38, 9216
  s_cbranch_scc1 L_s459o
  buffer_store_dwordx4 v[112:115], v24, s[32:35], s37 offen offset:0 sc1
  s_branch L_s459
L_s459o:
  v_add_u32 v25, s38, v20
  ds_write_b128 v25, v[112:115]
L_s459:
  s_add_u32 s38, s38, 1024
  s_cmp_lt_u32 s38, 9216
  s_cbranch_scc1 L_s460o
  buffer_store_dwordx4 v[116:119], v24, s[32:35], s37 offen offset:1024 sc1
  s_branch L_s460
L_s460o:
  v_add_u32 v25, s38, v20
  ds_write_b128 v25, v[116:119]
L_s460:
  s_add_u32 s48, s48, 128
  s_cmp_eq_u32 s48, 1152
  s_cselect_b32 s48, 0, s48
  s_waitcnt lgkmcnt(6)
  v_mfma_f32_16x16x32_bf16 v[132:135], v[6:9], v[224:227], v[132:135]
  ds_read_b64_tr_b16 v[252:253], v15 offset:0
  v_mfma_f32_16x16x32_bf16 v[140:143], v[6:9], v[228:231], v[140:143]
  ds_read_b64_tr_b16 v[254:255], v15 offset:512
  s_waitcnt lgkmcnt(6)
  v_mfma_f32_16x16x32_bf16 v[128:131], v[240:243], v[232:235], v[128:131]
  ds_read_b64_tr_b16 v[6:7], v14 offset:4096
  v_mfma_f32_16x16x32_bf16 v[136:139], v[240:243], v[236:239], v[136:139]
  ds_read_b64_tr_b16 v[8:9], v14 offset:4608
  s_waitcnt lgkmcnt(6)
  v_mfma_f32_16x16x32_bf16 v[132:135], v[244:247], v[232:235], v[132:135]
  ds_read_b64_tr_b16 v[240:241], v15 offset:4096
  v_mfma_f32_16x16x32_bf16 v[140:143], v[244:247], v[236:239], v[140:143]
  ds_read_b64_tr_b16 v[242:243], v15 offset:4608
  s_barrier
  s_waitcnt lgkmcnt(6)
  v_mfma_f32_16x16x32_bf16 v[144:147], v[248:251], v[176:179], v[144:147]
  ds_read_b64_tr_b16 v[244:245], v14 offset:8192
  v_mfma_f32_16x16x32_bf16 v[152:155], v[248:251], v[180:183], v[152:155]
  ds_read_b64_tr_b16 v[246:247], v14 offset:8704
  s_waitcnt lgkmcnt(6)
  v_mfma_f32_16x16x32_bf16 v[148:151], v[252:255], v[176:179], v[148:151]
  ds_read_b64_tr_b16 v[248:249], v15 offset:8192
  v_mfma_f32_16x16x32_bf16 v[156:159], v[252:255], v[180:183], v[156:159]
  ds_read_b64_tr_b16 v[250:251], v15 offset:8704
  s_waitcnt lgkmcnt(6)
  v_mfma_f32_16x16x32_bf16 v[144:147], v[6:9], v[184:187], v[144:147]
  ds_read_b64_tr_b16 v[252:253], v14 offset:12288
  v_mfma_f32_16x16x32_bf16 v[152:155], v[6:9], v[188:191], v[152:155]
  ds_read_b64_tr_b16 v[254:255], v14 offset:12800
  s_waitcnt lgkmcnt(6)
  v_mfma_f32_16x16x32_bf16 v[148:151], v[240:243], v[184:187], v[148:151]
  ds_read_b64_tr_b16 v[6:7], v15 offset:12288
  v_mfma_f32_16x16x32_bf16 v[156:159], v[240:243], v[188:191], v[156:159]
  ds_read_b64_tr_b16 v[8:9], v15 offset:12800
  s_waitcnt lgkmcnt(6)
  v_mfma_f32_16x16x32_bf16 v[144:147], v[244:247], v[192:195], v[144:147]
  ds_read_b64_tr_b16 v[240:241], v14 offset:16384
  v_mfma_f32_16x16x32_bf16 v[152:155], v[244:247], v[196:199], v[152:155]
  ds_read_b64_tr_b16 v[242:243], v14 offset:16896
  s_waitcnt lgkmcnt(6)
  v_mfma_f32_16x16x32_bf16 v[148:151], v[248:251], v[192:195], v[148:151]
  ds_read_b64_tr_b16 v[244:245], v15 offset:16384
  v_mfma_f32_16x16x32_bf16 v[156:159], v[248:251], v[196:199], v[156:159]
  ds_read_b64_tr_b16 v[246:247], v15 offset:16896
  s_waitcnt lgkmcnt(6)
  v_mfma_f32_16x16x32_bf16 v[144:147], v[252:255], v[200:203], v[144:147]
  ds_read_b64_tr_b16 v[248:249], v14 offset:20480
  v_mfma_f32_16x16x32_bf16 v[152:155], v[252:255], v[204:207], v[152:155]
  ds_read_b64_tr_b16 v[250:251], v14 offset:20992
  s_waitcnt lgkmcnt(6)
  v_mfma_f32_16x16x32_bf16 v[148:151], v[6:9], v[200:203], v[148:151]
  ds_read_b64_tr_b16 v[252:253], v15 offset:20480
  v_mfma_f32_16x16x32_bf16 v[156:159], v[6:9], v[204:207], v[156:159]
  ds_read_b64_tr_b16 v[254:255], v15 offset:20992
  s_waitcnt lgkmcnt(6)
  v_mfma_f32_16x16x32_bf16 v[144:147], v[240:243], v[208:211], v[144:147]
  ds_read_b64_tr_b16 v[6:7], v14 offset:24576
  v_mfma_f32_16x16x32_bf16 v[152:155], v[240:243], v[212:215], v[152:155]
  ds_read_b64_tr_b16 v[8:9], v14 offset:25088
  s_waitcnt lgkmcnt(6)
  v_mfma_f32_16x16x32_bf16 v[148:151], v[244:247], v[208:211], v[148:151]
  ds_read_b64_tr_b16 v[240:241], v15 offset:24576
  v_mfma_f32_16x16x32_bf16 v[156:159], v[244:247], v[212:215], v[156:159]
  ds_read_b64_tr_b16 v[242:243], v15 offset:25088
  s_waitcnt lgkmcnt(6)
  v_mfma_f32_16x16x32_bf16 v[144:147], v[248:251], v[216:219], v[144:147]
  ds_read_b64_tr_b16 v[244:245], v14 offset:28672
  v_mfma_f32_16x16x32_bf16 v[152:155], v[248:251], v[220:223], v[152:155]
  ds_read_b64_tr_b16 v[246:247], v14 offset:29184
  s_waitcnt lgkmcnt(6)
  v_mfma_f32_16x16x32_bf16 v[148:151], v[252:255], v[216:219], v[148:151]
  ds_read_b64_tr_b16 v[248:249], v15 offset:28672
  v_mfma_f32_16x16x32_bf16 v[156:159], v[252:255], v[220:223], v[156:159]
  ds_read_b64_tr_b16 v[250:251], v15 offset:29184
  s_waitcnt lgkmcnt(6)
  v_mfma_f32_16x16x32_bf16 v[144:147], v[6:9], v[224:227], v[144:147]
  ds_read_b64_tr_b16 v[252:253], v14 offset:32768
  v_mfma_f32_16x16x32_bf16 v[152:155], v[6:9], v[228:231], v[152:155]
  ds_read_b64_tr_b16 v[254:255], v14 offset:33280
  v_cvt_pk_bf16_f32 v128, v128, v129
  v_cvt_pk_bf16_f32 v129, v130, v131
  v_cvt_pk_bf16_f32 v130, v132, v133
  v_cvt_pk_bf16_f32 v131, v134, v135
  v_cvt_pk_bf16_f32 v132, v136, v137
  v_cvt_pk_bf16_f32 v133, v138, v139
  v_cvt_pk_bf16_f32 v134, v140, v141
  v_cvt_pk_bf16_f32 v135, v142, v143
  s_lshl_b32 s37, s48, 6
  s_sub_u32 s38, s37, s55
  s_cmp_lt_u32 s38, 9216
  s_cbranch_scc1 L_s461o
  buffer_store_dwordx4 v[128:131], v24, s[32:35], s37 offen offset:0 sc1
  s_branch L_s461
L_s461o:
  v_add_u32 v25, s38, v20
  ds_write_b128 v25, v[128:131]
L_s461:
  s_add_u32 s38, s38, 1024
  s_cmp_lt_u32 s38, 9216
  s_cbranch_scc1 L_s462o
  buffer_store_dwordx4 v[132:135], v24, s[32:35], s37 offen offset:1024 sc1
  s_branch L_s462
L_s462o:
  v_add_u32 v25, s38, v20
  ds_write_b128 v25, v[132:135]
L_s462:
  s_add_u32 s48, s48, 128
  s_cmp_eq_u32 s48, 1152
  s_cselect_b32 s48, 0, s48
  s_waitcnt lgkmcnt(6)
  v_mfma_f32_16x16x32_bf16 v[148:151], v[240:243], v[224:227], v[148:151]
  ds_read_b64_tr_b16 v[6:7], v15 offset:32768
  v_mfma_f32_16x16x32_bf16 v[156:159], v[240:243], v[228:231], v[156:159]
  ds_read_b64_tr_b16 v[8:9], v15 offset:33280
  s_waitcnt lgkmcnt(6)
  v_mfma_f32_16x16x32_bf16 v[144:147], v[244:247], v[232:235], v[144:147]
  ds_read_b64_tr_b16 v[240:241], v14 offset:36864
  v_mfma_f32_16x16x32_bf16 v[152:155], v[244:247], v[236:239], v[152:155]
  ds_read_b64_tr_b16 v[242:243], v14 offset:37376
  s_waitcnt lgkmcnt(6)
  v_mfma_f32_16x16x32_bf16 v[148:151], v[248:251], v[232:235], v[148:151]
  ds_read_b64_tr_b16 v[244:245], v15 offset:36864
  v_mfma_f32_16x16x32_bf16 v[156:159], v[248:251], v[236:239], v[156:159]
  ds_read_b64_tr_b16 v[246:247], v15 offset:37376
  s_barrier
  s_waitcnt lgkmcnt(6)
  v_mfma_f32_16x16x32_bf16 v[160:163], v[252:255], v[176:179], v[160:163]
  ds_read_b64_tr_b16 v[248:249], v14 offset:40960
  v_mfma_f32_16x16x32_bf16 v[168:171], v[252:255], v[180:183], v[168:171]
  ds_read_b64_tr_b16 v[250:251], v14 offset:41472
  s_waitcnt lgkmcnt(6)
  v_mfma_f32_16x16x32_bf16 v[164:167], v[6:9], v[176:179], v[164:167]
  ds_read_b64_tr_b16 v[252:253], v15 offset:40960
  v_mfma_f32_16x16x32_bf16 v[172:175], v[6:9], v[180:183], v[172:175]
  ds_read_b64_tr_b16 v[254:255], v15 offset:41472
  s_waitcnt lgkmcnt(6)
  v_mfma_f32_16x16x32_bf16 v[160:163], v[240:243], v[184:187], v[160:163]
  ds_read_b64_tr_b16 v[6:7], v14 offset:45056
  v_mfma_f32_16x16x32_bf16 v[168:171], v[240:243], v[188:191], v[168:171]
  ds_read_b64_tr_b16 v[8:9], v14 offset:45568
  s_waitcnt lgkmcnt(6)
  v_mfma_f32_16x16x32_bf16 v[164:167], v[244:247], v[184:187], v[164:167]
  ds_read_b64_tr_b16 v[240:241], v15 offset:45056
  v_mfma_f32_16x16x32_bf16 v[172:175], v[244:247], v[188:191], v[172:175]
  ds_read_b64_tr_b16 v[242:243], v15 offset:45568
  s_waitcnt lgkmcnt(6)
  v_mfma_f32_16x16x32_bf16 v[160:163], v[248:251], v[192:195], v[160:163]
  ds_read_b64_tr_b16 v[244:245], v14 offset:49152
  v_mfma_f32_16x16x32_bf16 v[168:171], v[248:251], v[196:199], v[168:171]
  ds_read_b64_tr_b16 v[246:247], v14 offset:49664
  s_waitcnt lgkmcnt(6)
  v_mfma_f32_16x16x32_bf16 v[164:167], v[252:255], v[192:195], v[164:167]
  ds_read_b64_tr_b16 v[248:249], v15 offset:49152
  v_mfma_f32_16x16x32_bf16 v[172:175], v[252:255], v[196:199], v[172:175]
  ds_read_b64_tr_b16 v[250:251], v15 offset:49664
  s_waitcnt lgkmcnt(6)
  v_mfma_f32_16x16x32_bf16 v[160:163], v[6:9], v[200:203], v[160:163]
  ds_read_b64_tr_b16 v[252:253], v14 offset:53248
  v_mfma_f32_16x16x32_bf16 v[168:171], v[6:9], v[204:207], v[168:171]
  ds_read_b64_tr_b16 v[254:255], v14 offset:53760
  s_waitcnt lgkmcnt(6)
  v_mfma_f32_16x16x32_bf16 v[164:167], v[240:243], v[200:203], v[164:167]
  ds_read_b64_tr_b16 v[6:7], v15 offset:53248
  v_mfma_f32_16x16x32_bf16 v[172:175], v[240:243], v[204:207], v[172:175]
  ds_read_b64_tr_b16 v[8:9], v15 offset:53760
  s_waitcnt lgkmcnt(6)
  v_mfma_f32_16x16x32_bf16 v[160:163], v[244:247], v[208:211], v[160:163]
  ds_read_b64_tr_b16 v[240:241], v14 offset:57344
  v_mfma_f32_16x16x32_bf16 v[168:171], v[244:247], v[212:215], v[168:171]
  ds_read_b64_tr_b16 v[242:243], v14 offset:57856
  s_waitcnt lgkmcnt(6)
  v_mfma_f32_16x16x32_bf16 v[164:167], v[248:251], v[208:211], v[164:167]
  ds_read_b64_tr_b16 v[244:245], v15 offset:57344
  v_mfma_f32_16x16x32_bf16 v[172:175], v[248:251], v[212:215], v[172:175]
  ds_read_b64_tr_b16 v[246:247], v15 offset:57856
  s_waitcnt lgkmcnt(6)
  v_mfma_f32_16x16x32_bf16 v[160:163], v[252:255], v[216:219], v[160:163]
  ds_read_b64_tr_b16 v[248:249], v14 offset:61440
  v_mfma_f32_16x16x32_bf16 v[168:171], v[252:255], v[220:223], v[168:171]
  ds_read_b64_tr_b16 v[250:251], v14 offset:61952
  s_waitcnt lgkmcnt(6)
  v_mfma_f32_16x16x32_bf16 v[164:167], v[6:9], v[216:219], v[164:167]
  ds_read_b64_tr_b16 v[252:253], v15 offset:61440
  v_mfma_f32_16x16x32_bf16 v[172:175], v[6:9], v[220:223], v[172:175]
  ds_read_b64_tr_b16 v[254:255], v15 offset:61952
  s_waitcnt lgkmcnt(6)
  v_mfma_f32_16x16x32_bf16 v[160:163], v[240:243], v[224:227], v[160:163]
  v_mfma_f32_16x16x32_bf16 v[168:171], v[240:243], v[228:231], v[168:171]
  v_cvt_pk_bf16_f32 v144, v144, v145
  v_cvt_pk_bf16_f32 v145, v146, v147
  v_cvt_pk_bf16_f32 v146, v148, v149
  v_cvt_pk_bf16_f32 v147, v150, v151
  v_cvt_pk_bf16_f32 v148, v152, v153
  v_cvt_pk_bf16_f32 v149, v154, v155
  v_cvt_pk_bf16_f32 v150, v156, v157
  v_cvt_pk_bf16_f32 v151, v158, v159
  s_lshl_b32 s37, s48, 6
  s_sub_u32 s38, s37, s55
  s_cmp_lt_u32 s38, 9216
  s_cbranch_scc1 L_s463o
  buffer_store_dwordx4 v[144:147], v24, s[32:35], s37 offen offset:0 sc1
  s_branch L_s463
L_s463o:
  v_add_u32 v25, s38, v20
  ds_write_b128 v25, v[144:147]
L_s463:
  s_add_u32 s38, s38, 1024
  s_cmp_lt_u32 s38, 9216
  s_cbranch_scc1 L_s464o
  buffer_store_dwordx4 v[148:151], v24, s[32:35], s37 offen offset:1024 sc1
  s_branch L_s464
L_s464o:
  v_add_u32 v25, s38, v20
  ds_write_b128 v25, v[148:151]
L_s464:
  s_add_u32 s48, s48, 128
  s_cmp_eq_u32 s48, 1152
  s_cselect_b32 s48, 0, s48
  s_waitcnt lgkmcnt(4)
  v_mfma_f32_16x16x32_bf16 v[164:167], v[244:247], v[224:227], v[164:167]
  v_mfma_f32_16x16x32_bf16 v[172:175], v[244:247], v[228:231], v[172:175]
  s_waitcnt lgkmcnt(2)
  v_mfma_f32_16x16x32_bf16 v[160:163], v[248:251], v[232:235], v[160:163]
  v_mfma_f32_16x16x32_bf16 v[168:171], v[248:251], v[236:239], v[168:171]
  s_waitcnt lgkmcnt(0)
  v_mfma_f32_16x16x32_bf16 v[164:167], v[252:255], v[232:235], v[164:167]
  v_mfma_f32_16x16x32_bf16 v[172:175], v[252:255], v[236:239], v[172:175]
  s_nop 7
  v_cvt_pk_bf16_f32 v160, v160, v161
  v_cvt_pk_bf16_f32 v161, v162, v163
  v_cvt_pk_bf16_f32 v162, v164, v165
  v_cvt_pk_bf16_f32 v163, v166, v167
  v_cvt_pk_bf16_f32 v164, v168, v169
  v_cvt_pk_bf16_f32 v165, v170, v171
  v_cvt_pk_bf16_f32 v166, v172, v173
  v_cvt_pk_bf16_f32 v167, v174, v175
  s_lshl_b32 s37, s48, 6
  s_sub_u32 s38, s37, s55
  s_cmp_lt_u32 s38, 9216
  s_cbranch_scc1 L_s465o
  buffer_store_dwordx4 v[160:163], v24, s[32:35], s37 offen offset:0 sc1
  s_branch L_s465
L_s465o:
  v_add_u32 v25, s38, v20
  ds_write_b128 v25, v[160:163]
L_s465:
  s_add_u32 s38, s38, 1024
  s_cmp_lt_u32 s38, 9216
  s_cbranch_scc1 L_s466o
  buffer_store_dwordx4 v[164:167], v24, s[32:35], s37 offen offset:1024 sc1
  s_branch L_s466
L_s466o:
  v_add_u32 v25, s38, v20
  ds_write_b128 v25, v[164:167]
L_s466:
  s_add_u32 s48, s48, 128
  s_cmp_eq_u32 s48, 1152
  s_cselect_b32 s48, 0, s48
  s_and_b32 s36, s2, 0xf8
  v_add_u32 v6, s36, v1
  v_lshlrev_b32 v6, 7, v6
  s_lshl_b32 s36, s7, 2
  s_add_u32 s36, s36, s4
  s_lshl_b32 s36, s36, 2
  v_add_u32 v6, s36, v6
  v_mov_b32 v8, 1
  s_mov_b32 exec_hi, 0
  global_load_dword v7, v5, s[98:99] sc1
  s_mov_b64 exec, 0xff
  s_waitcnt vmcnt(0) lgkmcnt(0)
  global_store_dword v6, v8, s[98:99] sc1
  s_mov_b64 exec, -1
  s_barrier
  s_branch L_own1
L_exit:
  s_endpgm
L_code_end:
.section .rodata,"a"
.p2align 6
.amdhsa_kernel concat_heads__gqa_block_cached__mha_block_cached__near_ridge_kernel
  .amdhsa_next_free_vgpr 256
  .amdhsa_next_free_sgpr 102
  .amdhsa_accum_offset 256
  .amdhsa_group_segment_fixed_size 0
  .amdhsa_kernarg_size 104
  .amdhsa_user_sgpr_count 2
  .amdhsa_user_sgpr_kernarg_segment_ptr 1
  .amdhsa_system_sgpr_workgroup_id_x 1
.end_amdhsa_kernel
```
